```python
import torch

def _softmax(x, axis=-1):
    return torch.softmax(x, dim=axis)
def _gelu(x):
    return torch.nn.functional.gelu(x, approximate="tanh")
def _silu(x):
    return torch.nn.functional.silu(x)
def _sigmoid(x):
    return torch.sigmoid(x)
def _layernorm(x, axis=-1, eps=1e-5):
    m = x.mean(dim=axis, keepdim=True)
    v = x.var(dim=axis, keepdim=True, unbiased=False)
    return (x - m) / torch.sqrt(v + eps)
def _scatter_add(tgt, idx, src, axis=0):
    return tgt.clone().index_add_(axis, idx, src)
def _segment_sum(src, seg, n):
    out = torch.zeros((n,) + src.shape[1:], dtype=src.dtype)
    return out.index_add_(0, seg, src)
def _pad(x, pw):
    flat = tuple(v for pair in reversed(pw) for v in pair)
    return torch.nn.functional.pad(x, flat)

kernel_name = 'sequential_preLN__linear_kernel_hedgehog__dense_activation_silu__prompt'

def setup_inputs():

    _w = (lambda a: (lambda t: t.to(torch.bfloat16) if t.is_floating_point() else t)(torch.as_tensor(a)))
    def _A_setup():
        B, S, D, H = 1, 2048, 640, 32
        Dh = D // H
        return {
            "x": _w((lambda *s: torch.randn(*s, dtype=torch.bfloat16) * 0.05)(B, S, D)),
            "wqkv": _w((lambda *s: torch.randn(*s, dtype=torch.bfloat16) * 0.2)(D, 3 * D)),
            "w_phi": _w((lambda *s: torch.randn(*s, dtype=torch.bfloat16) * 0.2)(H, Dh, Dh) * (Dh ** -0.5)),
            "wo": _w((lambda *s: torch.randn(*s, dtype=torch.bfloat16) * 0.05)(D, D)),
        }
    _A_in = _A_setup()

    def _B_setup():
        B, S, D, F = 1, 2048, 640, 1728
        return {
            "x": _w((lambda *s: torch.randn(*s, dtype=torch.bfloat16) * 0.05)(B, S, D)),
            "w1": _w((lambda *s: torch.randn(*s, dtype=torch.bfloat16) * 1.6)(D, F) * (D ** -0.5)),
            "w2": _w((lambda *s: torch.randn(*s, dtype=torch.bfloat16) * 0.2)(F, D) * (F ** -0.5)),
        }
    _B_in = _B_setup()

    return {
        "A_x": _A_in["x"],
        "A_wqkv": _A_in["wqkv"],
        "A_w_phi": _A_in["w_phi"],
        "A_wo": _A_in["wo"],
        "B_x": _B_in["x"],
        "B_w1": _B_in["w1"],
        "B_w2": _B_in["w2"],
    }

def reference(A_x, A_wqkv, A_w_phi, A_wo, B_x, B_w1, B_w2):
    def _A_ref(x, wqkv, w_phi, wo):
        B, S, D = x.shape
        H = 32; Dh = D // H
        qkv = (lambda x, *d: x.permute(*d))((x @ wqkv).reshape(B, S, 3, H, Dh), 2, 0, 3, 1, 4)
        q, k, v = qkv[0], qkv[1], qkv[2]
        pq = torch.einsum("bhsd,hdf->bhsf", q, w_phi)
        pk = torch.einsum("bhsd,hdf->bhsf", k, w_phi)
        phi_q = torch.concatenate([_softmax(pq, axis=-1), _softmax(-pq, axis=-1)], axis=-1)
        phi_k = torch.concatenate([_softmax(pk, axis=-1), _softmax(-pk, axis=-1)], axis=-1)
        kv = torch.einsum("bhsf,bhsd->bhfd", phi_k, v)
        z  = torch.einsum("bhsf->bhf", phi_k)
        num = torch.einsum("bhqf,bhfd->bhqd", phi_q, kv)
        den = torch.einsum("bhqf,bhf->bhq", phi_q, z)[..., None] + 1e-6
        o = num / den
        return (lambda x, *d: x.permute(*d))(o, 0, 2, 1, 3).reshape(B, S, D) @ wo

    def _B_ref(x, w1, w2):
        h = torch.einsum("bsd,df->bsf", x, w1)
        h = _silu(h)
        out = torch.einsum("bsf,fd->bsd", h, w2)
        return out

    x = A_x
    h = x + _A_ref(_layernorm(x, axis=-1), A_wqkv, A_w_phi, A_wo)
    h2 = h + _B_ref(_layernorm(h, axis=-1), B_w1, B_w2)
    return h2
```

```asm
; @launch kernel=hh_k1_kernel grid=(256,1,1) block=(512,1,1) lds=160768
; @launch kernel=hh_kr_kernel grid=(256,1,1) block=(256,1,1) lds=5120
; @launch kernel=hh_k2_kernel grid=(256,1,1) block=(256,1,1) lds=147456
; @launch kernel=hh_k3_kernel grid=(256,1,1) block=(512,1,1) lds=160768
; @launch kernel=hh_k4_kernel grid=(256,1,1) block=(256,1,1) lds=147456
.amdgcn_target "amdgcn-amd-amdhsa--gfx950"
.text
.globl hh_k1_kernel
.p2align 8
.type hh_k1_kernel,@function
hh_k1_kernel:
    s_cmp_ge_u32 s2, 256
    s_cbranch_scc1 L_k1_end
    s_load_dwordx4 s[4:7], s[0:1], 0
    s_load_dwordx2 s[38:39], s[0:1], 16
    s_load_dwordx2 s[40:41], s[0:1], 72
    s_lshr_b32 s28, s2, 3
    s_and_b32 s29, s2, 7
    v_and_b32 v1, 63, v0
    v_lshrrev_b32 v2, 4, v1
    v_and_b32 v3, 15, v1
    v_lshrrev_b32 v4, 6, v0
    s_nop 0
    v_readfirstlane_b32 s30, v4
    s_waitcnt lgkmcnt(0)
    s_mov_b32 s8, s4
    s_mov_b32 s9, s5
    s_mov_b32 s10, 0x280000
    s_mov_b32 s11, 0x00020000
    s_mov_b32 s12, s6
    s_mov_b32 s13, s7
    s_mov_b32 s14, 0x258000
    s_mov_b32 s15, 0x00020000
    s_mov_b32 s16, s38
    s_mov_b32 s17, s39
    s_mov_b32 s18, 0x6400
    s_mov_b32 s19, 0x00020000
    s_mov_b32 s20, s40
    s_mov_b32 s21, s41
    s_mov_b32 s22, 0x500000
    s_mov_b32 s23, 0x00020000
    s_add_u32 s24, s40, 0x600000
    s_addc_u32 s25, s41, 0
    s_mov_b32 s26, 0x348000
    s_mov_b32 s27, 0x00020000
    s_lshl_b32 s42, s28, 6
    v_lshrrev_b32 v5, 3, v0
    v_and_b32 v6, 7, v0
    v_add_u32 v7, s42, v5
    v_mul_u32_u24 v7, 1280, v7
    v_lshl_add_u32 v7, v6, 4, v7
    buffer_load_dwordx4 v[16:19], v7, s[8:11], 0 offen offset:0
    buffer_load_dwordx4 v[20:23], v7, s[8:11], 0 offen offset:128
    buffer_load_dwordx4 v[24:27], v7, s[8:11], 0 offen offset:256
    buffer_load_dwordx4 v[28:31], v7, s[8:11], 0 offen offset:384
    buffer_load_dwordx4 v[32:35], v7, s[8:11], 0 offen offset:512
    buffer_load_dwordx4 v[36:39], v7, s[8:11], 0 offen offset:640
    buffer_load_dwordx4 v[40:43], v7, s[8:11], 0 offen offset:768
    buffer_load_dwordx4 v[44:47], v7, s[8:11], 0 offen offset:896
    buffer_load_dwordx4 v[48:51], v7, s[8:11], 0 offen offset:1024
    buffer_load_dwordx4 v[52:55], v7, s[8:11], 0 offen offset:1152
    s_mul_i32 s35, s30, 1920
    s_mul_i32 s33, s30, 120
    s_mul_i32 s34, s29, 160
    s_mov_b32 s36, -1
    s_mov_b32 s37, 0x00ffffff
    v_add_u32 v12, s33, v1
    v_mul_u32_u24 v13, 2185, v12
    v_lshrrev_b32 v13, 16, v13
    v_mul_u32_u24 v14, 30, v13
    v_sub_u32 v14, v12, v14
    v_mul_u32_u24 v15, 6554, v14
    v_lshrrev_b32 v15, 16, v15
    v_mul_u32_u24 v8, 3840, v13
    v_mul_u32_u24 v13, 1280, v15
    v_add_u32 v8, v8, v13
    v_mul_u32_u24 v15, 10, v15
    v_sub_u32 v14, v14, v15
    v_lshl_add_u32 v8, v14, 4, v8
    v_add_u32 v8, s34, v8
    v_add_u32 v12, s33, v1
    v_add_u32 v12, 64, v12
    v_mul_u32_u24 v13, 2185, v12
    v_lshrrev_b32 v13, 16, v13
    v_mul_u32_u24 v14, 30, v13
    v_sub_u32 v14, v12, v14
    v_mul_u32_u24 v15, 6554, v14
    v_lshrrev_b32 v15, 16, v15
    v_mul_u32_u24 v9, 3840, v13
    v_mul_u32_u24 v13, 1280, v15
    v_add_u32 v9, v9, v13
    v_mul_u32_u24 v15, 10, v15
    v_sub_u32 v14, v14, v15
    v_lshl_add_u32 v9, v14, 4, v9
    v_add_u32 v9, s34, v9
    s_mul_i32 s33, s29, 3200
    v_lshlrev_b32 v81, 3, v0
    v_add_u32 v81, s33, v81
    v_cmp_gt_u32 vcc, 400, v0
    s_and_saveexec_b64 s[44:45], vcc
    buffer_load_dwordx2 v[240:241], v81, s[16:19], 0 offen
    s_mov_b64 exec, s[44:45]
    s_mov_b32 s33, 0x0
    s_add_u32 s34, s35, 0x14800
    s_mov_b32 m0, s34
    s_nop 0
    buffer_load_dwordx4 v8, s[12:15], s33 offen lds
    s_add_u32 s34, s34, 1024
    s_mov_b32 m0, s34
    s_mov_b64 exec, s[36:37]
    buffer_load_dwordx4 v9, s[12:15], s33 offen lds
    s_mov_b64 exec, -1
    s_mov_b32 s33, 0x1e000
    s_add_u32 s34, s35, 0x18400
    s_mov_b32 m0, s34
    s_nop 0
    buffer_load_dwordx4 v8, s[12:15], s33 offen lds
    s_add_u32 s34, s34, 1024
    s_mov_b32 m0, s34
    s_mov_b64 exec, s[36:37]
    buffer_load_dwordx4 v9, s[12:15], s33 offen lds
    s_mov_b64 exec, -1
    s_mov_b32 s33, 0x3c000
    s_add_u32 s34, s35, 0x1c000
    s_mov_b32 m0, s34
    s_nop 0
    buffer_load_dwordx4 v8, s[12:15], s33 offen lds
    s_add_u32 s34, s34, 1024
    s_mov_b32 m0, s34
    s_mov_b64 exec, s[36:37]
    buffer_load_dwordx4 v9, s[12:15], s33 offen lds
    s_mov_b64 exec, -1
    s_mov_b32 s33, 0x5a000
    s_add_u32 s34, s35, 0x1fc00
    s_mov_b32 m0, s34
    s_nop 0
    buffer_load_dwordx4 v8, s[12:15], s33 offen lds
    s_add_u32 s34, s34, 1024
    s_mov_b32 m0, s34
    s_mov_b64 exec, s[36:37]
    buffer_load_dwordx4 v9, s[12:15], s33 offen lds
    s_mov_b64 exec, -1
    s_mov_b32 s33, 0x78000
    s_add_u32 s34, s35, 0x23800
    s_mov_b32 m0, s34
    s_nop 0
    buffer_load_dwordx4 v8, s[12:15], s33 offen lds
    s_add_u32 s34, s34, 1024
    s_mov_b32 m0, s34
    s_mov_b64 exec, s[36:37]
    buffer_load_dwordx4 v9, s[12:15], s33 offen lds
    s_mov_b64 exec, -1
    s_waitcnt vmcnt(11)
    v_mov_b32 v56, 0x3f803f80
    v_mov_b32 v57, 0
    v_mov_b32 v58, 0
    v_mov_b32 v59, 0
    v_mov_b32 v60, 0
    v_dot2_f32_bf16 v57, v16, v56, v57
    v_lshlrev_b32 v160, 16, v16
    v_and_b32 v161, 0xffff0000, v16
    v_dot2_f32_bf16 v58, v17, v56, v58
    v_lshlrev_b32 v162, 16, v17
    v_and_b32 v163, 0xffff0000, v17
    v_dot2_f32_bf16 v59, v18, v56, v59
    v_lshlrev_b32 v164, 16, v18
    v_and_b32 v165, 0xffff0000, v18
    v_dot2_f32_bf16 v60, v19, v56, v60
    v_lshlrev_b32 v166, 16, v19
    v_and_b32 v167, 0xffff0000, v19
    v_dot2_f32_bf16 v57, v20, v56, v57
    v_lshlrev_b32 v168, 16, v20
    v_and_b32 v169, 0xffff0000, v20
    v_dot2_f32_bf16 v58, v21, v56, v58
    v_lshlrev_b32 v170, 16, v21
    v_and_b32 v171, 0xffff0000, v21
    v_dot2_f32_bf16 v59, v22, v56, v59
    v_lshlrev_b32 v172, 16, v22
    v_and_b32 v173, 0xffff0000, v22
    v_dot2_f32_bf16 v60, v23, v56, v60
    v_lshlrev_b32 v174, 16, v23
    v_and_b32 v175, 0xffff0000, v23
    v_dot2_f32_bf16 v57, v24, v56, v57
    v_lshlrev_b32 v176, 16, v24
    v_and_b32 v177, 0xffff0000, v24
    v_dot2_f32_bf16 v58, v25, v56, v58
    v_lshlrev_b32 v178, 16, v25
    v_and_b32 v179, 0xffff0000, v25
    v_dot2_f32_bf16 v59, v26, v56, v59
    v_lshlrev_b32 v180, 16, v26
    v_and_b32 v181, 0xffff0000, v26
    v_dot2_f32_bf16 v60, v27, v56, v60
    v_lshlrev_b32 v182, 16, v27
    v_and_b32 v183, 0xffff0000, v27
    v_dot2_f32_bf16 v57, v28, v56, v57
    v_lshlrev_b32 v184, 16, v28
    v_and_b32 v185, 0xffff0000, v28
    v_dot2_f32_bf16 v58, v29, v56, v58
    v_lshlrev_b32 v186, 16, v29
    v_and_b32 v187, 0xffff0000, v29
    v_dot2_f32_bf16 v59, v30, v56, v59
    v_lshlrev_b32 v188, 16, v30
    v_and_b32 v189, 0xffff0000, v30
    v_dot2_f32_bf16 v60, v31, v56, v60
    v_lshlrev_b32 v190, 16, v31
    v_and_b32 v191, 0xffff0000, v31
    v_dot2_f32_bf16 v57, v32, v56, v57
    v_lshlrev_b32 v192, 16, v32
    v_and_b32 v193, 0xffff0000, v32
    v_dot2_f32_bf16 v58, v33, v56, v58
    v_lshlrev_b32 v194, 16, v33
    v_and_b32 v195, 0xffff0000, v33
    v_dot2_f32_bf16 v59, v34, v56, v59
    v_lshlrev_b32 v196, 16, v34
    v_and_b32 v197, 0xffff0000, v34
    v_dot2_f32_bf16 v60, v35, v56, v60
    v_lshlrev_b32 v198, 16, v35
    v_and_b32 v199, 0xffff0000, v35
    v_dot2_f32_bf16 v57, v36, v56, v57
    v_lshlrev_b32 v200, 16, v36
    v_and_b32 v201, 0xffff0000, v36
    v_dot2_f32_bf16 v58, v37, v56, v58
    v_lshlrev_b32 v202, 16, v37
    v_and_b32 v203, 0xffff0000, v37
    v_dot2_f32_bf16 v59, v38, v56, v59
    v_lshlrev_b32 v204, 16, v38
    v_and_b32 v205, 0xffff0000, v38
    v_dot2_f32_bf16 v60, v39, v56, v60
    v_lshlrev_b32 v206, 16, v39
    v_and_b32 v207, 0xffff0000, v39
    v_dot2_f32_bf16 v57, v40, v56, v57
    v_lshlrev_b32 v208, 16, v40
    v_and_b32 v209, 0xffff0000, v40
    v_dot2_f32_bf16 v58, v41, v56, v58
    v_lshlrev_b32 v210, 16, v41
    v_and_b32 v211, 0xffff0000, v41
    v_dot2_f32_bf16 v59, v42, v56, v59
    v_lshlrev_b32 v212, 16, v42
    v_and_b32 v213, 0xffff0000, v42
    v_dot2_f32_bf16 v60, v43, v56, v60
    v_lshlrev_b32 v214, 16, v43
    v_and_b32 v215, 0xffff0000, v43
    v_dot2_f32_bf16 v57, v44, v56, v57
    v_lshlrev_b32 v216, 16, v44
    v_and_b32 v217, 0xffff0000, v44
    v_dot2_f32_bf16 v58, v45, v56, v58
    v_lshlrev_b32 v218, 16, v45
    v_and_b32 v219, 0xffff0000, v45
    v_dot2_f32_bf16 v59, v46, v56, v59
    v_lshlrev_b32 v220, 16, v46
    v_and_b32 v221, 0xffff0000, v46
    v_dot2_f32_bf16 v60, v47, v56, v60
    v_lshlrev_b32 v222, 16, v47
    v_and_b32 v223, 0xffff0000, v47
    v_dot2_f32_bf16 v57, v48, v56, v57
    v_lshlrev_b32 v224, 16, v48
    v_and_b32 v225, 0xffff0000, v48
    v_dot2_f32_bf16 v58, v49, v56, v58
    v_lshlrev_b32 v226, 16, v49
    v_and_b32 v227, 0xffff0000, v49
    v_dot2_f32_bf16 v59, v50, v56, v59
    v_lshlrev_b32 v228, 16, v50
    v_and_b32 v229, 0xffff0000, v50
    v_dot2_f32_bf16 v60, v51, v56, v60
    v_lshlrev_b32 v230, 16, v51
    v_and_b32 v231, 0xffff0000, v51
    v_dot2_f32_bf16 v57, v52, v56, v57
    v_lshlrev_b32 v232, 16, v52
    v_and_b32 v233, 0xffff0000, v52
    v_dot2_f32_bf16 v58, v53, v56, v58
    v_lshlrev_b32 v234, 16, v53
    v_and_b32 v235, 0xffff0000, v53
    v_dot2_f32_bf16 v59, v54, v56, v59
    v_lshlrev_b32 v236, 16, v54
    v_and_b32 v237, 0xffff0000, v54
    v_dot2_f32_bf16 v60, v55, v56, v60
    v_lshlrev_b32 v238, 16, v55
    v_and_b32 v239, 0xffff0000, v55
    v_add_f32 v57, v57, v58
    v_add_f32 v59, v59, v60
    v_add_f32 v57, v57, v59
    s_nop 1
    v_add_f32_dpp v61, v57, v57 quad_perm:[1,0,3,2] row_mask:0xf bank_mask:0xf
    s_nop 1
    v_add_f32_dpp v57, v61, v61 quad_perm:[2,3,0,1] row_mask:0xf bank_mask:0xf
    s_nop 1
    v_add_f32_dpp v61, v57, v57 row_half_mirror row_mask:0xf bank_mask:0xf
    v_mov_b32 v57, v61
    v_mul_f32 v57, 0x3acccccd, v57
    v_mov_b32 v62, v57
    v_mov_b32 v63, v57
    v_mov_b32 v64, 0
    v_mov_b32 v65, 0
    v_mov_b32 v66, 0
    v_mov_b32 v67, 0
    v_mov_b32 v68, 0
    v_mov_b32 v69, 0
    v_mov_b32 v70, 0
    v_mov_b32 v71, 0
    v_pk_add_f32 v[72:73], v[160:161], v[62:63] neg_lo:[0,1] neg_hi:[0,1]
    v_pk_fma_f32 v[64:65], v[72:73], v[72:73], v[64:65]
    v_pk_add_f32 v[74:75], v[162:163], v[62:63] neg_lo:[0,1] neg_hi:[0,1]
    v_pk_fma_f32 v[66:67], v[74:75], v[74:75], v[66:67]
    v_pk_add_f32 v[76:77], v[164:165], v[62:63] neg_lo:[0,1] neg_hi:[0,1]
    v_pk_fma_f32 v[68:69], v[76:77], v[76:77], v[68:69]
    v_pk_add_f32 v[78:79], v[166:167], v[62:63] neg_lo:[0,1] neg_hi:[0,1]
    v_pk_fma_f32 v[70:71], v[78:79], v[78:79], v[70:71]
    v_pk_add_f32 v[72:73], v[168:169], v[62:63] neg_lo:[0,1] neg_hi:[0,1]
    v_pk_fma_f32 v[64:65], v[72:73], v[72:73], v[64:65]
    v_pk_add_f32 v[74:75], v[170:171], v[62:63] neg_lo:[0,1] neg_hi:[0,1]
    v_pk_fma_f32 v[66:67], v[74:75], v[74:75], v[66:67]
    v_pk_add_f32 v[76:77], v[172:173], v[62:63] neg_lo:[0,1] neg_hi:[0,1]
    v_pk_fma_f32 v[68:69], v[76:77], v[76:77], v[68:69]
    v_pk_add_f32 v[78:79], v[174:175], v[62:63] neg_lo:[0,1] neg_hi:[0,1]
    v_pk_fma_f32 v[70:71], v[78:79], v[78:79], v[70:71]
    v_pk_add_f32 v[72:73], v[176:177], v[62:63] neg_lo:[0,1] neg_hi:[0,1]
    v_pk_fma_f32 v[64:65], v[72:73], v[72:73], v[64:65]
    v_pk_add_f32 v[74:75], v[178:179], v[62:63] neg_lo:[0,1] neg_hi:[0,1]
    v_pk_fma_f32 v[66:67], v[74:75], v[74:75], v[66:67]
    v_pk_add_f32 v[76:77], v[180:181], v[62:63] neg_lo:[0,1] neg_hi:[0,1]
    v_pk_fma_f32 v[68:69], v[76:77], v[76:77], v[68:69]
    v_pk_add_f32 v[78:79], v[182:183], v[62:63] neg_lo:[0,1] neg_hi:[0,1]
    v_pk_fma_f32 v[70:71], v[78:79], v[78:79], v[70:71]
    v_pk_add_f32 v[72:73], v[184:185], v[62:63] neg_lo:[0,1] neg_hi:[0,1]
    v_pk_fma_f32 v[64:65], v[72:73], v[72:73], v[64:65]
    v_pk_add_f32 v[74:75], v[186:187], v[62:63] neg_lo:[0,1] neg_hi:[0,1]
    v_pk_fma_f32 v[66:67], v[74:75], v[74:75], v[66:67]
    v_pk_add_f32 v[76:77], v[188:189], v[62:63] neg_lo:[0,1] neg_hi:[0,1]
    v_pk_fma_f32 v[68:69], v[76:77], v[76:77], v[68:69]
    v_pk_add_f32 v[78:79], v[190:191], v[62:63] neg_lo:[0,1] neg_hi:[0,1]
    v_pk_fma_f32 v[70:71], v[78:79], v[78:79], v[70:71]
    v_pk_add_f32 v[72:73], v[192:193], v[62:63] neg_lo:[0,1] neg_hi:[0,1]
    v_pk_fma_f32 v[64:65], v[72:73], v[72:73], v[64:65]
    v_pk_add_f32 v[74:75], v[194:195], v[62:63] neg_lo:[0,1] neg_hi:[0,1]
    v_pk_fma_f32 v[66:67], v[74:75], v[74:75], v[66:67]
    v_pk_add_f32 v[76:77], v[196:197], v[62:63] neg_lo:[0,1] neg_hi:[0,1]
    v_pk_fma_f32 v[68:69], v[76:77], v[76:77], v[68:69]
    v_pk_add_f32 v[78:79], v[198:199], v[62:63] neg_lo:[0,1] neg_hi:[0,1]
    v_pk_fma_f32 v[70:71], v[78:79], v[78:79], v[70:71]
    v_pk_add_f32 v[72:73], v[200:201], v[62:63] neg_lo:[0,1] neg_hi:[0,1]
    v_pk_fma_f32 v[64:65], v[72:73], v[72:73], v[64:65]
    v_pk_add_f32 v[74:75], v[202:203], v[62:63] neg_lo:[0,1] neg_hi:[0,1]
    v_pk_fma_f32 v[66:67], v[74:75], v[74:75], v[66:67]
    v_pk_add_f32 v[76:77], v[204:205], v[62:63] neg_lo:[0,1] neg_hi:[0,1]
    v_pk_fma_f32 v[68:69], v[76:77], v[76:77], v[68:69]
    v_pk_add_f32 v[78:79], v[206:207], v[62:63] neg_lo:[0,1] neg_hi:[0,1]
    v_pk_fma_f32 v[70:71], v[78:79], v[78:79], v[70:71]
    v_pk_add_f32 v[72:73], v[208:209], v[62:63] neg_lo:[0,1] neg_hi:[0,1]
    v_pk_fma_f32 v[64:65], v[72:73], v[72:73], v[64:65]
    v_pk_add_f32 v[74:75], v[210:211], v[62:63] neg_lo:[0,1] neg_hi:[0,1]
    v_pk_fma_f32 v[66:67], v[74:75], v[74:75], v[66:67]
    v_pk_add_f32 v[76:77], v[212:213], v[62:63] neg_lo:[0,1] neg_hi:[0,1]
    v_pk_fma_f32 v[68:69], v[76:77], v[76:77], v[68:69]
    v_pk_add_f32 v[78:79], v[214:215], v[62:63] neg_lo:[0,1] neg_hi:[0,1]
    v_pk_fma_f32 v[70:71], v[78:79], v[78:79], v[70:71]
    v_pk_add_f32 v[72:73], v[216:217], v[62:63] neg_lo:[0,1] neg_hi:[0,1]
    v_pk_fma_f32 v[64:65], v[72:73], v[72:73], v[64:65]
    v_pk_add_f32 v[74:75], v[218:219], v[62:63] neg_lo:[0,1] neg_hi:[0,1]
    v_pk_fma_f32 v[66:67], v[74:75], v[74:75], v[66:67]
    v_pk_add_f32 v[76:77], v[220:221], v[62:63] neg_lo:[0,1] neg_hi:[0,1]
    v_pk_fma_f32 v[68:69], v[76:77], v[76:77], v[68:69]
    v_pk_add_f32 v[78:79], v[222:223], v[62:63] neg_lo:[0,1] neg_hi:[0,1]
    v_pk_fma_f32 v[70:71], v[78:79], v[78:79], v[70:71]
    v_pk_add_f32 v[72:73], v[224:225], v[62:63] neg_lo:[0,1] neg_hi:[0,1]
    v_pk_fma_f32 v[64:65], v[72:73], v[72:73], v[64:65]
    v_pk_add_f32 v[74:75], v[226:227], v[62:63] neg_lo:[0,1] neg_hi:[0,1]
    v_pk_fma_f32 v[66:67], v[74:75], v[74:75], v[66:67]
    v_pk_add_f32 v[76:77], v[228:229], v[62:63] neg_lo:[0,1] neg_hi:[0,1]
    v_pk_fma_f32 v[68:69], v[76:77], v[76:77], v[68:69]
    v_pk_add_f32 v[78:79], v[230:231], v[62:63] neg_lo:[0,1] neg_hi:[0,1]
    v_pk_fma_f32 v[70:71], v[78:79], v[78:79], v[70:71]
    v_pk_add_f32 v[72:73], v[232:233], v[62:63] neg_lo:[0,1] neg_hi:[0,1]
    v_pk_fma_f32 v[64:65], v[72:73], v[72:73], v[64:65]
    v_pk_add_f32 v[74:75], v[234:235], v[62:63] neg_lo:[0,1] neg_hi:[0,1]
    v_pk_fma_f32 v[66:67], v[74:75], v[74:75], v[66:67]
    v_pk_add_f32 v[76:77], v[236:237], v[62:63] neg_lo:[0,1] neg_hi:[0,1]
    v_pk_fma_f32 v[68:69], v[76:77], v[76:77], v[68:69]
    v_pk_add_f32 v[78:79], v[238:239], v[62:63] neg_lo:[0,1] neg_hi:[0,1]
    v_pk_fma_f32 v[70:71], v[78:79], v[78:79], v[70:71]
    v_pk_add_f32 v[64:65], v[64:65], v[66:67]
    v_pk_add_f32 v[68:69], v[68:69], v[70:71]
    v_pk_add_f32 v[64:65], v[64:65], v[68:69]
    v_add_f32 v60, v64, v65
    s_nop 1
    v_add_f32_dpp v61, v60, v60 quad_perm:[1,0,3,2] row_mask:0xf bank_mask:0xf
    s_nop 1
    v_add_f32_dpp v60, v61, v61 quad_perm:[2,3,0,1] row_mask:0xf bank_mask:0xf
    s_nop 1
    v_add_f32_dpp v61, v60, v60 row_half_mirror row_mask:0xf bank_mask:0xf
    v_mov_b32 v60, v61
    v_mul_f32 v60, 0x3acccccd, v60
    v_cvt_pk_bf16_f32 v61, v57, v60
    v_lshlrev_b32 v62, 16, v61
    v_and_b32 v63, 0xffff0000, v61
    v_add_f32 v63, 0x3727c5ac, v63
    v_cvt_pk_bf16_f32 v63, v63, v63
    v_and_b32 v63, 0xffff0000, v63
    v_sqrt_f32 v63, v63
    s_nop 0
    v_cvt_pk_bf16_f32 v63, v63, v63
    v_and_b32 v63, 0xffff0000, v63
    v_rcp_f32 v66, v63
    s_nop 0
    v_mov_b32 v67, v66
    v_mov_b32 v63, v62
    v_mul_u32_u24 v68, 1312, v5
    v_lshrrev_b32 v69, 2, v6
    v_lshl_add_u32 v68, v69, 6, v68
    v_and_b32 v69, 1, v6
    v_lshl_add_u32 v68, v69, 5, v68
    v_bfe_u32 v69, v6, 1, 1
    v_lshl_add_u32 v68, v69, 3, v68
    v_pk_add_f32 v[72:73], v[160:161], v[62:63] neg_lo:[0,1] neg_hi:[0,1]
    v_pk_add_f32 v[74:75], v[162:163], v[62:63] neg_lo:[0,1] neg_hi:[0,1]
    v_pk_add_f32 v[76:77], v[164:165], v[62:63] neg_lo:[0,1] neg_hi:[0,1]
    v_pk_add_f32 v[78:79], v[166:167], v[62:63] neg_lo:[0,1] neg_hi:[0,1]
    v_cvt_pk_bf16_f32 v80, v72, v73
    v_cvt_pk_bf16_f32 v81, v74, v75
    v_cvt_pk_bf16_f32 v82, v76, v77
    v_cvt_pk_bf16_f32 v83, v78, v79
    v_lshlrev_b32 v72, 16, v80
    v_and_b32 v73, 0xffff0000, v80
    v_lshlrev_b32 v74, 16, v81
    v_and_b32 v75, 0xffff0000, v81
    v_lshlrev_b32 v76, 16, v82
    v_and_b32 v77, 0xffff0000, v82
    v_lshlrev_b32 v78, 16, v83
    v_and_b32 v79, 0xffff0000, v83
    v_pk_mul_f32 v[72:73], v[72:73], v[66:67]
    v_pk_mul_f32 v[74:75], v[74:75], v[66:67]
    v_pk_mul_f32 v[76:77], v[76:77], v[66:67]
    v_pk_mul_f32 v[78:79], v[78:79], v[66:67]
    v_cvt_pk_bf16_f32 v84, v72, v73
    v_cvt_pk_bf16_f32 v85, v74, v75
    v_cvt_pk_bf16_f32 v86, v76, v77
    v_cvt_pk_bf16_f32 v87, v78, v79
    ds_write_b64 v68, v[84:85] offset:0
    ds_write_b64 v68, v[86:87] offset:16
    v_pk_add_f32 v[72:73], v[168:169], v[62:63] neg_lo:[0,1] neg_hi:[0,1]
    v_pk_add_f32 v[74:75], v[170:171], v[62:63] neg_lo:[0,1] neg_hi:[0,1]
    v_pk_add_f32 v[76:77], v[172:173], v[62:63] neg_lo:[0,1] neg_hi:[0,1]
    v_pk_add_f32 v[78:79], v[174:175], v[62:63] neg_lo:[0,1] neg_hi:[0,1]
    v_cvt_pk_bf16_f32 v80, v72, v73
    v_cvt_pk_bf16_f32 v81, v74, v75
    v_cvt_pk_bf16_f32 v82, v76, v77
    v_cvt_pk_bf16_f32 v83, v78, v79
    v_lshlrev_b32 v72, 16, v80
    v_and_b32 v73, 0xffff0000, v80
    v_lshlrev_b32 v74, 16, v81
    v_and_b32 v75, 0xffff0000, v81
    v_lshlrev_b32 v76, 16, v82
    v_and_b32 v77, 0xffff0000, v82
    v_lshlrev_b32 v78, 16, v83
    v_and_b32 v79, 0xffff0000, v83
    v_pk_mul_f32 v[72:73], v[72:73], v[66:67]
    v_pk_mul_f32 v[74:75], v[74:75], v[66:67]
    v_pk_mul_f32 v[76:77], v[76:77], v[66:67]
    v_pk_mul_f32 v[78:79], v[78:79], v[66:67]
    v_cvt_pk_bf16_f32 v84, v72, v73
    v_cvt_pk_bf16_f32 v85, v74, v75
    v_cvt_pk_bf16_f32 v86, v76, v77
    v_cvt_pk_bf16_f32 v87, v78, v79
    ds_write_b64 v68, v[84:85] offset:128
    ds_write_b64 v68, v[86:87] offset:144
    v_pk_add_f32 v[72:73], v[176:177], v[62:63] neg_lo:[0,1] neg_hi:[0,1]
    v_pk_add_f32 v[74:75], v[178:179], v[62:63] neg_lo:[0,1] neg_hi:[0,1]
    v_pk_add_f32 v[76:77], v[180:181], v[62:63] neg_lo:[0,1] neg_hi:[0,1]
    v_pk_add_f32 v[78:79], v[182:183], v[62:63] neg_lo:[0,1] neg_hi:[0,1]
    v_cvt_pk_bf16_f32 v80, v72, v73
    v_cvt_pk_bf16_f32 v81, v74, v75
    v_cvt_pk_bf16_f32 v82, v76, v77
    v_cvt_pk_bf16_f32 v83, v78, v79
    v_lshlrev_b32 v72, 16, v80
    v_and_b32 v73, 0xffff0000, v80
    v_lshlrev_b32 v74, 16, v81
    v_and_b32 v75, 0xffff0000, v81
    v_lshlrev_b32 v76, 16, v82
    v_and_b32 v77, 0xffff0000, v82
    v_lshlrev_b32 v78, 16, v83
    v_and_b32 v79, 0xffff0000, v83
    v_pk_mul_f32 v[72:73], v[72:73], v[66:67]
    v_pk_mul_f32 v[74:75], v[74:75], v[66:67]
    v_pk_mul_f32 v[76:77], v[76:77], v[66:67]
    v_pk_mul_f32 v[78:79], v[78:79], v[66:67]
    v_cvt_pk_bf16_f32 v84, v72, v73
    v_cvt_pk_bf16_f32 v85, v74, v75
    v_cvt_pk_bf16_f32 v86, v76, v77
    v_cvt_pk_bf16_f32 v87, v78, v79
    ds_write_b64 v68, v[84:85] offset:256
    ds_write_b64 v68, v[86:87] offset:272
    v_pk_add_f32 v[72:73], v[184:185], v[62:63] neg_lo:[0,1] neg_hi:[0,1]
    v_pk_add_f32 v[74:75], v[186:187], v[62:63] neg_lo:[0,1] neg_hi:[0,1]
    v_pk_add_f32 v[76:77], v[188:189], v[62:63] neg_lo:[0,1] neg_hi:[0,1]
    v_pk_add_f32 v[78:79], v[190:191], v[62:63] neg_lo:[0,1] neg_hi:[0,1]
    v_cvt_pk_bf16_f32 v80, v72, v73
    v_cvt_pk_bf16_f32 v81, v74, v75
    v_cvt_pk_bf16_f32 v82, v76, v77
    v_cvt_pk_bf16_f32 v83, v78, v79
    v_lshlrev_b32 v72, 16, v80
    v_and_b32 v73, 0xffff0000, v80
    v_lshlrev_b32 v74, 16, v81
    v_and_b32 v75, 0xffff0000, v81
    v_lshlrev_b32 v76, 16, v82
    v_and_b32 v77, 0xffff0000, v82
    v_lshlrev_b32 v78, 16, v83
    v_and_b32 v79, 0xffff0000, v83
    v_pk_mul_f32 v[72:73], v[72:73], v[66:67]
    v_pk_mul_f32 v[74:75], v[74:75], v[66:67]
    v_pk_mul_f32 v[76:77], v[76:77], v[66:67]
    v_pk_mul_f32 v[78:79], v[78:79], v[66:67]
    v_cvt_pk_bf16_f32 v84, v72, v73
    v_cvt_pk_bf16_f32 v85, v74, v75
    v_cvt_pk_bf16_f32 v86, v76, v77
    v_cvt_pk_bf16_f32 v87, v78, v79
    ds_write_b64 v68, v[84:85] offset:384
    ds_write_b64 v68, v[86:87] offset:400
    v_pk_add_f32 v[72:73], v[192:193], v[62:63] neg_lo:[0,1] neg_hi:[0,1]
    v_pk_add_f32 v[74:75], v[194:195], v[62:63] neg_lo:[0,1] neg_hi:[0,1]
    v_pk_add_f32 v[76:77], v[196:197], v[62:63] neg_lo:[0,1] neg_hi:[0,1]
    v_pk_add_f32 v[78:79], v[198:199], v[62:63] neg_lo:[0,1] neg_hi:[0,1]
    v_cvt_pk_bf16_f32 v80, v72, v73
    v_cvt_pk_bf16_f32 v81, v74, v75
    v_cvt_pk_bf16_f32 v82, v76, v77
    v_cvt_pk_bf16_f32 v83, v78, v79
    v_lshlrev_b32 v72, 16, v80
    v_and_b32 v73, 0xffff0000, v80
    v_lshlrev_b32 v74, 16, v81
    v_and_b32 v75, 0xffff0000, v81
    v_lshlrev_b32 v76, 16, v82
    v_and_b32 v77, 0xffff0000, v82
    v_lshlrev_b32 v78, 16, v83
    v_and_b32 v79, 0xffff0000, v83
    v_pk_mul_f32 v[72:73], v[72:73], v[66:67]
    v_pk_mul_f32 v[74:75], v[74:75], v[66:67]
    v_pk_mul_f32 v[76:77], v[76:77], v[66:67]
    v_pk_mul_f32 v[78:79], v[78:79], v[66:67]
    v_cvt_pk_bf16_f32 v84, v72, v73
    v_cvt_pk_bf16_f32 v85, v74, v75
    v_cvt_pk_bf16_f32 v86, v76, v77
    v_cvt_pk_bf16_f32 v87, v78, v79
    ds_write_b64 v68, v[84:85] offset:512
    ds_write_b64 v68, v[86:87] offset:528
    v_pk_add_f32 v[72:73], v[200:201], v[62:63] neg_lo:[0,1] neg_hi:[0,1]
    v_pk_add_f32 v[74:75], v[202:203], v[62:63] neg_lo:[0,1] neg_hi:[0,1]
    v_pk_add_f32 v[76:77], v[204:205], v[62:63] neg_lo:[0,1] neg_hi:[0,1]
    v_pk_add_f32 v[78:79], v[206:207], v[62:63] neg_lo:[0,1] neg_hi:[0,1]
    v_cvt_pk_bf16_f32 v80, v72, v73
    v_cvt_pk_bf16_f32 v81, v74, v75
    v_cvt_pk_bf16_f32 v82, v76, v77
    v_cvt_pk_bf16_f32 v83, v78, v79
    v_lshlrev_b32 v72, 16, v80
    v_and_b32 v73, 0xffff0000, v80
    v_lshlrev_b32 v74, 16, v81
    v_and_b32 v75, 0xffff0000, v81
    v_lshlrev_b32 v76, 16, v82
    v_and_b32 v77, 0xffff0000, v82
    v_lshlrev_b32 v78, 16, v83
    v_and_b32 v79, 0xffff0000, v83
    v_pk_mul_f32 v[72:73], v[72:73], v[66:67]
    v_pk_mul_f32 v[74:75], v[74:75], v[66:67]
    v_pk_mul_f32 v[76:77], v[76:77], v[66:67]
    v_pk_mul_f32 v[78:79], v[78:79], v[66:67]
    v_cvt_pk_bf16_f32 v84, v72, v73
    v_cvt_pk_bf16_f32 v85, v74, v75
    v_cvt_pk_bf16_f32 v86, v76, v77
    v_cvt_pk_bf16_f32 v87, v78, v79
    ds_write_b64 v68, v[84:85] offset:640
    ds_write_b64 v68, v[86:87] offset:656
    v_pk_add_f32 v[72:73], v[208:209], v[62:63] neg_lo:[0,1] neg_hi:[0,1]
    v_pk_add_f32 v[74:75], v[210:211], v[62:63] neg_lo:[0,1] neg_hi:[0,1]
    v_pk_add_f32 v[76:77], v[212:213], v[62:63] neg_lo:[0,1] neg_hi:[0,1]
    v_pk_add_f32 v[78:79], v[214:215], v[62:63] neg_lo:[0,1] neg_hi:[0,1]
    v_cvt_pk_bf16_f32 v80, v72, v73
    v_cvt_pk_bf16_f32 v81, v74, v75
    v_cvt_pk_bf16_f32 v82, v76, v77
    v_cvt_pk_bf16_f32 v83, v78, v79
    v_lshlrev_b32 v72, 16, v80
    v_and_b32 v73, 0xffff0000, v80
    v_lshlrev_b32 v74, 16, v81
    v_and_b32 v75, 0xffff0000, v81
    v_lshlrev_b32 v76, 16, v82
    v_and_b32 v77, 0xffff0000, v82
    v_lshlrev_b32 v78, 16, v83
    v_and_b32 v79, 0xffff0000, v83
    v_pk_mul_f32 v[72:73], v[72:73], v[66:67]
    v_pk_mul_f32 v[74:75], v[74:75], v[66:67]
    v_pk_mul_f32 v[76:77], v[76:77], v[66:67]
    v_pk_mul_f32 v[78:79], v[78:79], v[66:67]
    v_cvt_pk_bf16_f32 v84, v72, v73
    v_cvt_pk_bf16_f32 v85, v74, v75
    v_cvt_pk_bf16_f32 v86, v76, v77
    v_cvt_pk_bf16_f32 v87, v78, v79
    ds_write_b64 v68, v[84:85] offset:768
    ds_write_b64 v68, v[86:87] offset:784
    v_pk_add_f32 v[72:73], v[216:217], v[62:63] neg_lo:[0,1] neg_hi:[0,1]
    v_pk_add_f32 v[74:75], v[218:219], v[62:63] neg_lo:[0,1] neg_hi:[0,1]
    v_pk_add_f32 v[76:77], v[220:221], v[62:63] neg_lo:[0,1] neg_hi:[0,1]
    v_pk_add_f32 v[78:79], v[222:223], v[62:63] neg_lo:[0,1] neg_hi:[0,1]
    v_cvt_pk_bf16_f32 v80, v72, v73
    v_cvt_pk_bf16_f32 v81, v74, v75
    v_cvt_pk_bf16_f32 v82, v76, v77
    v_cvt_pk_bf16_f32 v83, v78, v79
    v_lshlrev_b32 v72, 16, v80
    v_and_b32 v73, 0xffff0000, v80
    v_lshlrev_b32 v74, 16, v81
    v_and_b32 v75, 0xffff0000, v81
    v_lshlrev_b32 v76, 16, v82
    v_and_b32 v77, 0xffff0000, v82
    v_lshlrev_b32 v78, 16, v83
    v_and_b32 v79, 0xffff0000, v83
    v_pk_mul_f32 v[72:73], v[72:73], v[66:67]
    v_pk_mul_f32 v[74:75], v[74:75], v[66:67]
    v_pk_mul_f32 v[76:77], v[76:77], v[66:67]
    v_pk_mul_f32 v[78:79], v[78:79], v[66:67]
    v_cvt_pk_bf16_f32 v84, v72, v73
    v_cvt_pk_bf16_f32 v85, v74, v75
    v_cvt_pk_bf16_f32 v86, v76, v77
    v_cvt_pk_bf16_f32 v87, v78, v79
    ds_write_b64 v68, v[84:85] offset:896
    ds_write_b64 v68, v[86:87] offset:912
    v_pk_add_f32 v[72:73], v[224:225], v[62:63] neg_lo:[0,1] neg_hi:[0,1]
    v_pk_add_f32 v[74:75], v[226:227], v[62:63] neg_lo:[0,1] neg_hi:[0,1]
    v_pk_add_f32 v[76:77], v[228:229], v[62:63] neg_lo:[0,1] neg_hi:[0,1]
    v_pk_add_f32 v[78:79], v[230:231], v[62:63] neg_lo:[0,1] neg_hi:[0,1]
    v_cvt_pk_bf16_f32 v80, v72, v73
    v_cvt_pk_bf16_f32 v81, v74, v75
    v_cvt_pk_bf16_f32 v82, v76, v77
    v_cvt_pk_bf16_f32 v83, v78, v79
    v_lshlrev_b32 v72, 16, v80
    v_and_b32 v73, 0xffff0000, v80
    v_lshlrev_b32 v74, 16, v81
    v_and_b32 v75, 0xffff0000, v81
    v_lshlrev_b32 v76, 16, v82
    v_and_b32 v77, 0xffff0000, v82
    v_lshlrev_b32 v78, 16, v83
    v_and_b32 v79, 0xffff0000, v83
    v_pk_mul_f32 v[72:73], v[72:73], v[66:67]
    v_pk_mul_f32 v[74:75], v[74:75], v[66:67]
    v_pk_mul_f32 v[76:77], v[76:77], v[66:67]
    v_pk_mul_f32 v[78:79], v[78:79], v[66:67]
    v_cvt_pk_bf16_f32 v84, v72, v73
    v_cvt_pk_bf16_f32 v85, v74, v75
    v_cvt_pk_bf16_f32 v86, v76, v77
    v_cvt_pk_bf16_f32 v87, v78, v79
    ds_write_b64 v68, v[84:85] offset:1024
    ds_write_b64 v68, v[86:87] offset:1040
    v_pk_add_f32 v[72:73], v[232:233], v[62:63] neg_lo:[0,1] neg_hi:[0,1]
    v_pk_add_f32 v[74:75], v[234:235], v[62:63] neg_lo:[0,1] neg_hi:[0,1]
    v_pk_add_f32 v[76:77], v[236:237], v[62:63] neg_lo:[0,1] neg_hi:[0,1]
    v_pk_add_f32 v[78:79], v[238:239], v[62:63] neg_lo:[0,1] neg_hi:[0,1]
    v_cvt_pk_bf16_f32 v80, v72, v73
    v_cvt_pk_bf16_f32 v81, v74, v75
    v_cvt_pk_bf16_f32 v82, v76, v77
    v_cvt_pk_bf16_f32 v83, v78, v79
    v_lshlrev_b32 v72, 16, v80
    v_and_b32 v73, 0xffff0000, v80
    v_lshlrev_b32 v74, 16, v81
    v_and_b32 v75, 0xffff0000, v81
    v_lshlrev_b32 v76, 16, v82
    v_and_b32 v77, 0xffff0000, v82
    v_lshlrev_b32 v78, 16, v83
    v_and_b32 v79, 0xffff0000, v83
    v_pk_mul_f32 v[72:73], v[72:73], v[66:67]
    v_pk_mul_f32 v[74:75], v[74:75], v[66:67]
    v_pk_mul_f32 v[76:77], v[76:77], v[66:67]
    v_pk_mul_f32 v[78:79], v[78:79], v[66:67]
    v_cvt_pk_bf16_f32 v84, v72, v73
    v_cvt_pk_bf16_f32 v85, v74, v75
    v_cvt_pk_bf16_f32 v86, v76, v77
    v_cvt_pk_bf16_f32 v87, v78, v79
    ds_write_b64 v68, v[84:85] offset:1152
    ds_write_b64 v68, v[86:87] offset:1168
    s_and_b32 s31, s30, 1
    s_lshr_b32 s32, s30, 1
    s_mul_i32 s33, s31, 41984
    v_mul_u32_u24 v10, 1312, v3
    v_lshl_add_u32 v10, v2, 4, v10
    v_add_u32 v10, s33, v10
    v_lshrrev_b32 v11, 2, v3
    v_lshl_add_u32 v11, v2, 2, v11
    v_mul_u32_u24 v11, 480, v11
    v_and_b32 v12, 3, v3
    v_lshl_add_u32 v11, v12, 3, v11
    s_lshl_b32 s33, s32, 7
    s_add_u32 s33, s33, 83968
    v_add_u32 v11, s33, v11
    v_add_u32 v13, 61440, v11
    v_mov_b32 v96, 0
    v_mov_b32 v97, 0
    v_mov_b32 v98, 0
    v_mov_b32 v99, 0
    v_mov_b32 v100, 0
    v_mov_b32 v101, 0
    v_mov_b32 v102, 0
    v_mov_b32 v103, 0
    v_mov_b32 v104, 0
    v_mov_b32 v105, 0
    v_mov_b32 v106, 0
    v_mov_b32 v107, 0
    v_mov_b32 v108, 0
    v_mov_b32 v109, 0
    v_mov_b32 v110, 0
    v_mov_b32 v111, 0
    v_mov_b32 v112, 0
    v_mov_b32 v113, 0
    v_mov_b32 v114, 0
    v_mov_b32 v115, 0
    v_mov_b32 v116, 0
    v_mov_b32 v117, 0
    v_mov_b32 v118, 0
    v_mov_b32 v119, 0
    v_mov_b32 v120, 0
    v_mov_b32 v121, 0
    v_mov_b32 v122, 0
    v_mov_b32 v123, 0
    v_mov_b32 v124, 0
    v_mov_b32 v125, 0
    v_mov_b32 v126, 0
    v_mov_b32 v127, 0
    s_waitcnt vmcnt(8)
    s_waitcnt lgkmcnt(0)
    s_barrier
    ds_read_b128 v[128:131], v10 offset:0
    ds_read_b128 v[132:135], v10 offset:20992
    ds_read_b64_tr_b16 v[144:145], v11 offset:0
    ds_read_b64_tr_b16 v[146:147], v11 offset:7680
    ds_read_b64_tr_b16 v[148:149], v11 offset:32
    ds_read_b64_tr_b16 v[150:151], v11 offset:7712
    ds_read_b64_tr_b16 v[152:153], v11 offset:64
    ds_read_b64_tr_b16 v[154:155], v11 offset:7744
    ds_read_b64_tr_b16 v[156:157], v11 offset:96
    ds_read_b64_tr_b16 v[158:159], v11 offset:7776
    s_waitcnt lgkmcnt(0)
    s_waitcnt vmcnt(6)
    s_barrier
    s_mov_b32 s33, 0x96000
    s_add_u32 s34, s35, 0x14800
    s_mov_b32 m0, s34
    s_nop 0
    buffer_load_dwordx4 v8, s[12:15], s33 offen lds
    s_add_u32 s34, s34, 1024
    s_mov_b32 m0, s34
    s_mov_b64 exec, s[36:37]
    buffer_load_dwordx4 v9, s[12:15], s33 offen lds
    s_mov_b64 exec, -1
    ds_read_b128 v[136:139], v10 offset:64
    ds_read_b128 v[140:143], v10 offset:21056
    ds_read_b64_tr_b16 v[160:161], v11 offset:15360
    ds_read_b64_tr_b16 v[162:163], v11 offset:23040
    ds_read_b64_tr_b16 v[164:165], v11 offset:15392
    ds_read_b64_tr_b16 v[166:167], v11 offset:23072
    ds_read_b64_tr_b16 v[168:169], v11 offset:15424
    ds_read_b64_tr_b16 v[170:171], v11 offset:23104
    ds_read_b64_tr_b16 v[172:173], v11 offset:15456
    ds_read_b64_tr_b16 v[174:175], v11 offset:23136
    v_mfma_f32_16x16x32_bf16 v[96:99], v[144:147], v[128:131], v[96:99]
    v_mfma_f32_16x16x32_bf16 v[100:103], v[148:151], v[128:131], v[100:103]
    v_mfma_f32_16x16x32_bf16 v[104:107], v[152:155], v[128:131], v[104:107]
    v_mfma_f32_16x16x32_bf16 v[108:111], v[156:159], v[128:131], v[108:111]
    v_mfma_f32_16x16x32_bf16 v[112:115], v[144:147], v[132:135], v[112:115]
    v_mfma_f32_16x16x32_bf16 v[116:119], v[148:151], v[132:135], v[116:119]
    v_mfma_f32_16x16x32_bf16 v[120:123], v[152:155], v[132:135], v[120:123]
    v_mfma_f32_16x16x32_bf16 v[124:127], v[156:159], v[132:135], v[124:127]
    s_waitcnt lgkmcnt(0)
    s_waitcnt vmcnt(6)
    s_barrier
    s_mov_b32 s33, 0xb4000
    s_add_u32 s34, s35, 0x18400
    s_mov_b32 m0, s34
    s_nop 0
    buffer_load_dwordx4 v8, s[12:15], s33 offen lds
    s_add_u32 s34, s34, 1024
    s_mov_b32 m0, s34
    s_mov_b64 exec, s[36:37]
    buffer_load_dwordx4 v9, s[12:15], s33 offen lds
    s_mov_b64 exec, -1
    ds_read_b128 v[128:131], v10 offset:128
    ds_read_b128 v[132:135], v10 offset:21120
    ds_read_b64_tr_b16 v[144:145], v11 offset:30720
    ds_read_b64_tr_b16 v[146:147], v11 offset:38400
    ds_read_b64_tr_b16 v[148:149], v11 offset:30752
    ds_read_b64_tr_b16 v[150:151], v11 offset:38432
    ds_read_b64_tr_b16 v[152:153], v11 offset:30784
    ds_read_b64_tr_b16 v[154:155], v11 offset:38464
    ds_read_b64_tr_b16 v[156:157], v11 offset:30816
    ds_read_b64_tr_b16 v[158:159], v11 offset:38496
    v_mfma_f32_16x16x32_bf16 v[96:99], v[160:163], v[136:139], v[96:99]
    v_mfma_f32_16x16x32_bf16 v[100:103], v[164:167], v[136:139], v[100:103]
    v_mfma_f32_16x16x32_bf16 v[104:107], v[168:171], v[136:139], v[104:107]
    v_mfma_f32_16x16x32_bf16 v[108:111], v[172:175], v[136:139], v[108:111]
    v_mfma_f32_16x16x32_bf16 v[112:115], v[160:163], v[140:143], v[112:115]
    v_mfma_f32_16x16x32_bf16 v[116:119], v[164:167], v[140:143], v[116:119]
    v_mfma_f32_16x16x32_bf16 v[120:123], v[168:171], v[140:143], v[120:123]
    v_mfma_f32_16x16x32_bf16 v[124:127], v[172:175], v[140:143], v[124:127]
    s_waitcnt lgkmcnt(0)
    s_waitcnt vmcnt(6)
    s_barrier
    s_mov_b32 s33, 0xd2000
    s_add_u32 s34, s35, 0x1c000
    s_mov_b32 m0, s34
    s_nop 0
    buffer_load_dwordx4 v8, s[12:15], s33 offen lds
    s_add_u32 s34, s34, 1024
    s_mov_b32 m0, s34
    s_mov_b64 exec, s[36:37]
    buffer_load_dwordx4 v9, s[12:15], s33 offen lds
    s_mov_b64 exec, -1
    ds_read_b128 v[136:139], v10 offset:192
    ds_read_b128 v[140:143], v10 offset:21184
    ds_read_b64_tr_b16 v[160:161], v11 offset:46080
    ds_read_b64_tr_b16 v[162:163], v11 offset:53760
    ds_read_b64_tr_b16 v[164:165], v11 offset:46112
    ds_read_b64_tr_b16 v[166:167], v11 offset:53792
    ds_read_b64_tr_b16 v[168:169], v11 offset:46144
    ds_read_b64_tr_b16 v[170:171], v11 offset:53824
    ds_read_b64_tr_b16 v[172:173], v11 offset:46176
    ds_read_b64_tr_b16 v[174:175], v11 offset:53856
    v_mfma_f32_16x16x32_bf16 v[96:99], v[144:147], v[128:131], v[96:99]
    v_mfma_f32_16x16x32_bf16 v[100:103], v[148:151], v[128:131], v[100:103]
    v_mfma_f32_16x16x32_bf16 v[104:107], v[152:155], v[128:131], v[104:107]
    v_mfma_f32_16x16x32_bf16 v[108:111], v[156:159], v[128:131], v[108:111]
    v_mfma_f32_16x16x32_bf16 v[112:115], v[144:147], v[132:135], v[112:115]
    v_mfma_f32_16x16x32_bf16 v[116:119], v[148:151], v[132:135], v[116:119]
    v_mfma_f32_16x16x32_bf16 v[120:123], v[152:155], v[132:135], v[120:123]
    v_mfma_f32_16x16x32_bf16 v[124:127], v[156:159], v[132:135], v[124:127]
    s_waitcnt lgkmcnt(0)
    s_waitcnt vmcnt(6)
    s_barrier
    s_mov_b32 s33, 0xf0000
    s_add_u32 s34, s35, 0x1fc00
    s_mov_b32 m0, s34
    s_nop 0
    buffer_load_dwordx4 v8, s[12:15], s33 offen lds
    s_add_u32 s34, s34, 1024
    s_mov_b32 m0, s34
    s_mov_b64 exec, s[36:37]
    buffer_load_dwordx4 v9, s[12:15], s33 offen lds
    s_mov_b64 exec, -1
    ds_read_b128 v[128:131], v10 offset:256
    ds_read_b128 v[132:135], v10 offset:21248
    ds_read_b64_tr_b16 v[144:145], v13 offset:0
    ds_read_b64_tr_b16 v[146:147], v13 offset:7680
    ds_read_b64_tr_b16 v[148:149], v13 offset:32
    ds_read_b64_tr_b16 v[150:151], v13 offset:7712
    ds_read_b64_tr_b16 v[152:153], v13 offset:64
    ds_read_b64_tr_b16 v[154:155], v13 offset:7744
    ds_read_b64_tr_b16 v[156:157], v13 offset:96
    ds_read_b64_tr_b16 v[158:159], v13 offset:7776
    v_mfma_f32_16x16x32_bf16 v[96:99], v[160:163], v[136:139], v[96:99]
    v_mfma_f32_16x16x32_bf16 v[100:103], v[164:167], v[136:139], v[100:103]
    v_mfma_f32_16x16x32_bf16 v[104:107], v[168:171], v[136:139], v[104:107]
    v_mfma_f32_16x16x32_bf16 v[108:111], v[172:175], v[136:139], v[108:111]
    v_mfma_f32_16x16x32_bf16 v[112:115], v[160:163], v[140:143], v[112:115]
    v_mfma_f32_16x16x32_bf16 v[116:119], v[164:167], v[140:143], v[116:119]
    v_mfma_f32_16x16x32_bf16 v[120:123], v[168:171], v[140:143], v[120:123]
    v_mfma_f32_16x16x32_bf16 v[124:127], v[172:175], v[140:143], v[124:127]
    s_waitcnt lgkmcnt(0)
    s_waitcnt vmcnt(6)
    s_barrier
    s_mov_b32 s33, 0x10e000
    s_add_u32 s34, s35, 0x23800
    s_mov_b32 m0, s34
    s_nop 0
    buffer_load_dwordx4 v8, s[12:15], s33 offen lds
    s_add_u32 s34, s34, 1024
    s_mov_b32 m0, s34
    s_mov_b64 exec, s[36:37]
    buffer_load_dwordx4 v9, s[12:15], s33 offen lds
    s_mov_b64 exec, -1
    ds_read_b128 v[136:139], v10 offset:320
    ds_read_b128 v[140:143], v10 offset:21312
    ds_read_b64_tr_b16 v[160:161], v11 offset:0
    ds_read_b64_tr_b16 v[162:163], v11 offset:7680
    ds_read_b64_tr_b16 v[164:165], v11 offset:32
    ds_read_b64_tr_b16 v[166:167], v11 offset:7712
    ds_read_b64_tr_b16 v[168:169], v11 offset:64
    ds_read_b64_tr_b16 v[170:171], v11 offset:7744
    ds_read_b64_tr_b16 v[172:173], v11 offset:96
    ds_read_b64_tr_b16 v[174:175], v11 offset:7776
    v_mfma_f32_16x16x32_bf16 v[96:99], v[144:147], v[128:131], v[96:99]
    v_mfma_f32_16x16x32_bf16 v[100:103], v[148:151], v[128:131], v[100:103]
    v_mfma_f32_16x16x32_bf16 v[104:107], v[152:155], v[128:131], v[104:107]
    v_mfma_f32_16x16x32_bf16 v[108:111], v[156:159], v[128:131], v[108:111]
    v_mfma_f32_16x16x32_bf16 v[112:115], v[144:147], v[132:135], v[112:115]
    v_mfma_f32_16x16x32_bf16 v[116:119], v[148:151], v[132:135], v[116:119]
    v_mfma_f32_16x16x32_bf16 v[120:123], v[152:155], v[132:135], v[120:123]
    v_mfma_f32_16x16x32_bf16 v[124:127], v[156:159], v[132:135], v[124:127]
    s_waitcnt lgkmcnt(0)
    s_waitcnt vmcnt(6)
    s_barrier
    s_mov_b32 s33, 0x12c000
    s_add_u32 s34, s35, 0x14800
    s_mov_b32 m0, s34
    s_nop 0
    buffer_load_dwordx4 v8, s[12:15], s33 offen lds
    s_add_u32 s34, s34, 1024
    s_mov_b32 m0, s34
    s_mov_b64 exec, s[36:37]
    buffer_load_dwordx4 v9, s[12:15], s33 offen lds
    s_mov_b64 exec, -1
    ds_read_b128 v[128:131], v10 offset:384
    ds_read_b128 v[132:135], v10 offset:21376
    ds_read_b64_tr_b16 v[144:145], v11 offset:15360
    ds_read_b64_tr_b16 v[146:147], v11 offset:23040
    ds_read_b64_tr_b16 v[148:149], v11 offset:15392
    ds_read_b64_tr_b16 v[150:151], v11 offset:23072
    ds_read_b64_tr_b16 v[152:153], v11 offset:15424
    ds_read_b64_tr_b16 v[154:155], v11 offset:23104
    ds_read_b64_tr_b16 v[156:157], v11 offset:15456
    ds_read_b64_tr_b16 v[158:159], v11 offset:23136
    v_mfma_f32_16x16x32_bf16 v[96:99], v[160:163], v[136:139], v[96:99]
    v_mfma_f32_16x16x32_bf16 v[100:103], v[164:167], v[136:139], v[100:103]
    v_mfma_f32_16x16x32_bf16 v[104:107], v[168:171], v[136:139], v[104:107]
    v_mfma_f32_16x16x32_bf16 v[108:111], v[172:175], v[136:139], v[108:111]
    v_mfma_f32_16x16x32_bf16 v[112:115], v[160:163], v[140:143], v[112:115]
    v_mfma_f32_16x16x32_bf16 v[116:119], v[164:167], v[140:143], v[116:119]
    v_mfma_f32_16x16x32_bf16 v[120:123], v[168:171], v[140:143], v[120:123]
    v_mfma_f32_16x16x32_bf16 v[124:127], v[172:175], v[140:143], v[124:127]
    s_waitcnt lgkmcnt(0)
    s_waitcnt vmcnt(6)
    s_barrier
    s_mov_b32 s33, 0x14a000
    s_add_u32 s34, s35, 0x18400
    s_mov_b32 m0, s34
    s_nop 0
    buffer_load_dwordx4 v8, s[12:15], s33 offen lds
    s_add_u32 s34, s34, 1024
    s_mov_b32 m0, s34
    s_mov_b64 exec, s[36:37]
    buffer_load_dwordx4 v9, s[12:15], s33 offen lds
    s_mov_b64 exec, -1
    ds_read_b128 v[136:139], v10 offset:448
    ds_read_b128 v[140:143], v10 offset:21440
    ds_read_b64_tr_b16 v[160:161], v11 offset:30720
    ds_read_b64_tr_b16 v[162:163], v11 offset:38400
    ds_read_b64_tr_b16 v[164:165], v11 offset:30752
    ds_read_b64_tr_b16 v[166:167], v11 offset:38432
    ds_read_b64_tr_b16 v[168:169], v11 offset:30784
    ds_read_b64_tr_b16 v[170:171], v11 offset:38464
    ds_read_b64_tr_b16 v[172:173], v11 offset:30816
    ds_read_b64_tr_b16 v[174:175], v11 offset:38496
    v_mfma_f32_16x16x32_bf16 v[96:99], v[144:147], v[128:131], v[96:99]
    v_mfma_f32_16x16x32_bf16 v[100:103], v[148:151], v[128:131], v[100:103]
    v_mfma_f32_16x16x32_bf16 v[104:107], v[152:155], v[128:131], v[104:107]
    v_mfma_f32_16x16x32_bf16 v[108:111], v[156:159], v[128:131], v[108:111]
    v_mfma_f32_16x16x32_bf16 v[112:115], v[144:147], v[132:135], v[112:115]
    v_mfma_f32_16x16x32_bf16 v[116:119], v[148:151], v[132:135], v[116:119]
    v_mfma_f32_16x16x32_bf16 v[120:123], v[152:155], v[132:135], v[120:123]
    v_mfma_f32_16x16x32_bf16 v[124:127], v[156:159], v[132:135], v[124:127]
    s_waitcnt lgkmcnt(0)
    s_waitcnt vmcnt(6)
    s_barrier
    s_mov_b32 s33, 0x168000
    s_add_u32 s34, s35, 0x1c000
    s_mov_b32 m0, s34
    s_nop 0
    buffer_load_dwordx4 v8, s[12:15], s33 offen lds
    s_add_u32 s34, s34, 1024
    s_mov_b32 m0, s34
    s_mov_b64 exec, s[36:37]
    buffer_load_dwordx4 v9, s[12:15], s33 offen lds
    s_mov_b64 exec, -1
    ds_read_b128 v[128:131], v10 offset:512
    ds_read_b128 v[132:135], v10 offset:21504
    ds_read_b64_tr_b16 v[144:145], v11 offset:46080
    ds_read_b64_tr_b16 v[146:147], v11 offset:53760
    ds_read_b64_tr_b16 v[148:149], v11 offset:46112
    ds_read_b64_tr_b16 v[150:151], v11 offset:53792
    ds_read_b64_tr_b16 v[152:153], v11 offset:46144
    ds_read_b64_tr_b16 v[154:155], v11 offset:53824
    ds_read_b64_tr_b16 v[156:157], v11 offset:46176
    ds_read_b64_tr_b16 v[158:159], v11 offset:53856
    v_mfma_f32_16x16x32_bf16 v[96:99], v[160:163], v[136:139], v[96:99]
    v_mfma_f32_16x16x32_bf16 v[100:103], v[164:167], v[136:139], v[100:103]
    v_mfma_f32_16x16x32_bf16 v[104:107], v[168:171], v[136:139], v[104:107]
    v_mfma_f32_16x16x32_bf16 v[108:111], v[172:175], v[136:139], v[108:111]
    v_mfma_f32_16x16x32_bf16 v[112:115], v[160:163], v[140:143], v[112:115]
    v_mfma_f32_16x16x32_bf16 v[116:119], v[164:167], v[140:143], v[116:119]
    v_mfma_f32_16x16x32_bf16 v[120:123], v[168:171], v[140:143], v[120:123]
    v_mfma_f32_16x16x32_bf16 v[124:127], v[172:175], v[140:143], v[124:127]
    s_waitcnt lgkmcnt(0)
    s_waitcnt vmcnt(6)
    s_barrier
    s_mov_b32 s33, 0x186000
    s_add_u32 s34, s35, 0x1fc00
    s_mov_b32 m0, s34
    s_nop 0
    buffer_load_dwordx4 v8, s[12:15], s33 offen lds
    s_add_u32 s34, s34, 1024
    s_mov_b32 m0, s34
    s_mov_b64 exec, s[36:37]
    buffer_load_dwordx4 v9, s[12:15], s33 offen lds
    s_mov_b64 exec, -1
    ds_read_b128 v[136:139], v10 offset:576
    ds_read_b128 v[140:143], v10 offset:21568
    ds_read_b64_tr_b16 v[160:161], v13 offset:0
    ds_read_b64_tr_b16 v[162:163], v13 offset:7680
    ds_read_b64_tr_b16 v[164:165], v13 offset:32
    ds_read_b64_tr_b16 v[166:167], v13 offset:7712
    ds_read_b64_tr_b16 v[168:169], v13 offset:64
    ds_read_b64_tr_b16 v[170:171], v13 offset:7744
    ds_read_b64_tr_b16 v[172:173], v13 offset:96
    ds_read_b64_tr_b16 v[174:175], v13 offset:7776
    v_mfma_f32_16x16x32_bf16 v[96:99], v[144:147], v[128:131], v[96:99]
    v_mfma_f32_16x16x32_bf16 v[100:103], v[148:151], v[128:131], v[100:103]
    v_mfma_f32_16x16x32_bf16 v[104:107], v[152:155], v[128:131], v[104:107]
    v_mfma_f32_16x16x32_bf16 v[108:111], v[156:159], v[128:131], v[108:111]
    v_mfma_f32_16x16x32_bf16 v[112:115], v[144:147], v[132:135], v[112:115]
    v_mfma_f32_16x16x32_bf16 v[116:119], v[148:151], v[132:135], v[116:119]
    v_mfma_f32_16x16x32_bf16 v[120:123], v[152:155], v[132:135], v[120:123]
    v_mfma_f32_16x16x32_bf16 v[124:127], v[156:159], v[132:135], v[124:127]
    s_waitcnt lgkmcnt(0)
    s_waitcnt vmcnt(6)
    s_barrier
    s_mov_b32 s33, 0x1a4000
    s_add_u32 s34, s35, 0x23800
    s_mov_b32 m0, s34
    s_nop 0
    buffer_load_dwordx4 v8, s[12:15], s33 offen lds
    s_add_u32 s34, s34, 1024
    s_mov_b32 m0, s34
    s_mov_b64 exec, s[36:37]
    buffer_load_dwordx4 v9, s[12:15], s33 offen lds
    s_mov_b64 exec, -1
    ds_read_b128 v[128:131], v10 offset:640
    ds_read_b128 v[132:135], v10 offset:21632
    ds_read_b64_tr_b16 v[144:145], v11 offset:0
    ds_read_b64_tr_b16 v[146:147], v11 offset:7680
    ds_read_b64_tr_b16 v[148:149], v11 offset:32
    ds_read_b64_tr_b16 v[150:151], v11 offset:7712
    ds_read_b64_tr_b16 v[152:153], v11 offset:64
    ds_read_b64_tr_b16 v[154:155], v11 offset:7744
    ds_read_b64_tr_b16 v[156:157], v11 offset:96
    ds_read_b64_tr_b16 v[158:159], v11 offset:7776
    v_mfma_f32_16x16x32_bf16 v[96:99], v[160:163], v[136:139], v[96:99]
    v_mfma_f32_16x16x32_bf16 v[100:103], v[164:167], v[136:139], v[100:103]
    v_mfma_f32_16x16x32_bf16 v[104:107], v[168:171], v[136:139], v[104:107]
    v_mfma_f32_16x16x32_bf16 v[108:111], v[172:175], v[136:139], v[108:111]
    v_mfma_f32_16x16x32_bf16 v[112:115], v[160:163], v[140:143], v[112:115]
    v_mfma_f32_16x16x32_bf16 v[116:119], v[164:167], v[140:143], v[116:119]
    v_mfma_f32_16x16x32_bf16 v[120:123], v[168:171], v[140:143], v[120:123]
    v_mfma_f32_16x16x32_bf16 v[124:127], v[172:175], v[140:143], v[124:127]
    s_waitcnt lgkmcnt(0)
    s_waitcnt vmcnt(6)
    s_barrier
    s_mov_b32 s33, 0x1c2000
    s_add_u32 s34, s35, 0x14800
    s_mov_b32 m0, s34
    s_nop 0
    buffer_load_dwordx4 v8, s[12:15], s33 offen lds
    s_add_u32 s34, s34, 1024
    s_mov_b32 m0, s34
    s_mov_b64 exec, s[36:37]
    buffer_load_dwordx4 v9, s[12:15], s33 offen lds
    s_mov_b64 exec, -1
    ds_read_b128 v[136:139], v10 offset:704
    ds_read_b128 v[140:143], v10 offset:21696
    ds_read_b64_tr_b16 v[160:161], v11 offset:15360
    ds_read_b64_tr_b16 v[162:163], v11 offset:23040
    ds_read_b64_tr_b16 v[164:165], v11 offset:15392
    ds_read_b64_tr_b16 v[166:167], v11 offset:23072
    ds_read_b64_tr_b16 v[168:169], v11 offset:15424
    ds_read_b64_tr_b16 v[170:171], v11 offset:23104
    ds_read_b64_tr_b16 v[172:173], v11 offset:15456
    ds_read_b64_tr_b16 v[174:175], v11 offset:23136
    v_mfma_f32_16x16x32_bf16 v[96:99], v[144:147], v[128:131], v[96:99]
    v_mfma_f32_16x16x32_bf16 v[100:103], v[148:151], v[128:131], v[100:103]
    v_mfma_f32_16x16x32_bf16 v[104:107], v[152:155], v[128:131], v[104:107]
    v_mfma_f32_16x16x32_bf16 v[108:111], v[156:159], v[128:131], v[108:111]
    v_mfma_f32_16x16x32_bf16 v[112:115], v[144:147], v[132:135], v[112:115]
    v_mfma_f32_16x16x32_bf16 v[116:119], v[148:151], v[132:135], v[116:119]
    v_mfma_f32_16x16x32_bf16 v[120:123], v[152:155], v[132:135], v[120:123]
    v_mfma_f32_16x16x32_bf16 v[124:127], v[156:159], v[132:135], v[124:127]
    s_waitcnt lgkmcnt(0)
    s_waitcnt vmcnt(6)
    s_barrier
    s_mov_b32 s33, 0x1e0000
    s_add_u32 s34, s35, 0x18400
    s_mov_b32 m0, s34
    s_nop 0
    buffer_load_dwordx4 v8, s[12:15], s33 offen lds
    s_add_u32 s34, s34, 1024
    s_mov_b32 m0, s34
    s_mov_b64 exec, s[36:37]
    buffer_load_dwordx4 v9, s[12:15], s33 offen lds
    s_mov_b64 exec, -1
    ds_read_b128 v[128:131], v10 offset:768
    ds_read_b128 v[132:135], v10 offset:21760
    ds_read_b64_tr_b16 v[144:145], v11 offset:30720
    ds_read_b64_tr_b16 v[146:147], v11 offset:38400
    ds_read_b64_tr_b16 v[148:149], v11 offset:30752
    ds_read_b64_tr_b16 v[150:151], v11 offset:38432
    ds_read_b64_tr_b16 v[152:153], v11 offset:30784
    ds_read_b64_tr_b16 v[154:155], v11 offset:38464
    ds_read_b64_tr_b16 v[156:157], v11 offset:30816
    ds_read_b64_tr_b16 v[158:159], v11 offset:38496
    v_mfma_f32_16x16x32_bf16 v[96:99], v[160:163], v[136:139], v[96:99]
    v_mfma_f32_16x16x32_bf16 v[100:103], v[164:167], v[136:139], v[100:103]
    v_mfma_f32_16x16x32_bf16 v[104:107], v[168:171], v[136:139], v[104:107]
    v_mfma_f32_16x16x32_bf16 v[108:111], v[172:175], v[136:139], v[108:111]
    v_mfma_f32_16x16x32_bf16 v[112:115], v[160:163], v[140:143], v[112:115]
    v_mfma_f32_16x16x32_bf16 v[116:119], v[164:167], v[140:143], v[116:119]
    v_mfma_f32_16x16x32_bf16 v[120:123], v[168:171], v[140:143], v[120:123]
    v_mfma_f32_16x16x32_bf16 v[124:127], v[172:175], v[140:143], v[124:127]
    s_waitcnt lgkmcnt(0)
    s_waitcnt vmcnt(6)
    s_barrier
    s_mov_b32 s33, 0x1fe000
    s_add_u32 s34, s35, 0x1c000
    s_mov_b32 m0, s34
    s_nop 0
    buffer_load_dwordx4 v8, s[12:15], s33 offen lds
    s_add_u32 s34, s34, 1024
    s_mov_b32 m0, s34
    s_mov_b64 exec, s[36:37]
    buffer_load_dwordx4 v9, s[12:15], s33 offen lds
    s_mov_b64 exec, -1
    ds_read_b128 v[136:139], v10 offset:832
    ds_read_b128 v[140:143], v10 offset:21824
    ds_read_b64_tr_b16 v[160:161], v11 offset:46080
    ds_read_b64_tr_b16 v[162:163], v11 offset:53760
    ds_read_b64_tr_b16 v[164:165], v11 offset:46112
    ds_read_b64_tr_b16 v[166:167], v11 offset:53792
    ds_read_b64_tr_b16 v[168:169], v11 offset:46144
    ds_read_b64_tr_b16 v[170:171], v11 offset:53824
    ds_read_b64_tr_b16 v[172:173], v11 offset:46176
    ds_read_b64_tr_b16 v[174:175], v11 offset:53856
    v_mfma_f32_16x16x32_bf16 v[96:99], v[144:147], v[128:131], v[96:99]
    v_mfma_f32_16x16x32_bf16 v[100:103], v[148:151], v[128:131], v[100:103]
    v_mfma_f32_16x16x32_bf16 v[104:107], v[152:155], v[128:131], v[104:107]
    v_mfma_f32_16x16x32_bf16 v[108:111], v[156:159], v[128:131], v[108:111]
    v_mfma_f32_16x16x32_bf16 v[112:115], v[144:147], v[132:135], v[112:115]
    v_mfma_f32_16x16x32_bf16 v[116:119], v[148:151], v[132:135], v[116:119]
    v_mfma_f32_16x16x32_bf16 v[120:123], v[152:155], v[132:135], v[120:123]
    v_mfma_f32_16x16x32_bf16 v[124:127], v[156:159], v[132:135], v[124:127]
    s_waitcnt lgkmcnt(0)
    s_waitcnt vmcnt(6)
    s_barrier
    s_mov_b32 s33, 0x21c000
    s_add_u32 s34, s35, 0x1fc00
    s_mov_b32 m0, s34
    s_nop 0
    buffer_load_dwordx4 v8, s[12:15], s33 offen lds
    s_add_u32 s34, s34, 1024
    s_mov_b32 m0, s34
    s_mov_b64 exec, s[36:37]
    buffer_load_dwordx4 v9, s[12:15], s33 offen lds
    s_mov_b64 exec, -1
    ds_read_b128 v[128:131], v10 offset:896
    ds_read_b128 v[132:135], v10 offset:21888
    ds_read_b64_tr_b16 v[144:145], v13 offset:0
    ds_read_b64_tr_b16 v[146:147], v13 offset:7680
    ds_read_b64_tr_b16 v[148:149], v13 offset:32
    ds_read_b64_tr_b16 v[150:151], v13 offset:7712
    ds_read_b64_tr_b16 v[152:153], v13 offset:64
    ds_read_b64_tr_b16 v[154:155], v13 offset:7744
    ds_read_b64_tr_b16 v[156:157], v13 offset:96
    ds_read_b64_tr_b16 v[158:159], v13 offset:7776
    v_mfma_f32_16x16x32_bf16 v[96:99], v[160:163], v[136:139], v[96:99]
    v_mfma_f32_16x16x32_bf16 v[100:103], v[164:167], v[136:139], v[100:103]
    v_mfma_f32_16x16x32_bf16 v[104:107], v[168:171], v[136:139], v[104:107]
    v_mfma_f32_16x16x32_bf16 v[108:111], v[172:175], v[136:139], v[108:111]
    v_mfma_f32_16x16x32_bf16 v[112:115], v[160:163], v[140:143], v[112:115]
    v_mfma_f32_16x16x32_bf16 v[116:119], v[164:167], v[140:143], v[116:119]
    v_mfma_f32_16x16x32_bf16 v[120:123], v[168:171], v[140:143], v[120:123]
    v_mfma_f32_16x16x32_bf16 v[124:127], v[172:175], v[140:143], v[124:127]
    s_waitcnt lgkmcnt(0)
    s_waitcnt vmcnt(6)
    s_barrier
    s_mov_b32 s33, 0x23a000
    s_add_u32 s34, s35, 0x23800
    s_mov_b32 m0, s34
    s_nop 0
    buffer_load_dwordx4 v8, s[12:15], s33 offen lds
    s_add_u32 s34, s34, 1024
    s_mov_b32 m0, s34
    s_mov_b64 exec, s[36:37]
    buffer_load_dwordx4 v9, s[12:15], s33 offen lds
    s_mov_b64 exec, -1
    ds_read_b128 v[136:139], v10 offset:960
    ds_read_b128 v[140:143], v10 offset:21952
    ds_read_b64_tr_b16 v[160:161], v11 offset:0
    ds_read_b64_tr_b16 v[162:163], v11 offset:7680
    ds_read_b64_tr_b16 v[164:165], v11 offset:32
    ds_read_b64_tr_b16 v[166:167], v11 offset:7712
    ds_read_b64_tr_b16 v[168:169], v11 offset:64
    ds_read_b64_tr_b16 v[170:171], v11 offset:7744
    ds_read_b64_tr_b16 v[172:173], v11 offset:96
    ds_read_b64_tr_b16 v[174:175], v11 offset:7776
    v_mfma_f32_16x16x32_bf16 v[96:99], v[144:147], v[128:131], v[96:99]
    v_mfma_f32_16x16x32_bf16 v[100:103], v[148:151], v[128:131], v[100:103]
    v_mfma_f32_16x16x32_bf16 v[104:107], v[152:155], v[128:131], v[104:107]
    v_mfma_f32_16x16x32_bf16 v[108:111], v[156:159], v[128:131], v[108:111]
    v_mfma_f32_16x16x32_bf16 v[112:115], v[144:147], v[132:135], v[112:115]
    v_mfma_f32_16x16x32_bf16 v[116:119], v[148:151], v[132:135], v[116:119]
    v_mfma_f32_16x16x32_bf16 v[120:123], v[152:155], v[132:135], v[120:123]
    v_mfma_f32_16x16x32_bf16 v[124:127], v[156:159], v[132:135], v[124:127]
    s_waitcnt lgkmcnt(0)
    s_waitcnt vmcnt(6)
    s_barrier
    ds_read_b128 v[128:131], v10 offset:1024
    ds_read_b128 v[132:135], v10 offset:22016
    ds_read_b64_tr_b16 v[144:145], v11 offset:15360
    ds_read_b64_tr_b16 v[146:147], v11 offset:23040
    ds_read_b64_tr_b16 v[148:149], v11 offset:15392
    ds_read_b64_tr_b16 v[150:151], v11 offset:23072
    ds_read_b64_tr_b16 v[152:153], v11 offset:15424
    ds_read_b64_tr_b16 v[154:155], v11 offset:23104
    ds_read_b64_tr_b16 v[156:157], v11 offset:15456
    ds_read_b64_tr_b16 v[158:159], v11 offset:23136
    v_mfma_f32_16x16x32_bf16 v[96:99], v[160:163], v[136:139], v[96:99]
    v_mfma_f32_16x16x32_bf16 v[100:103], v[164:167], v[136:139], v[100:103]
    v_mfma_f32_16x16x32_bf16 v[104:107], v[168:171], v[136:139], v[104:107]
    v_mfma_f32_16x16x32_bf16 v[108:111], v[172:175], v[136:139], v[108:111]
    v_mfma_f32_16x16x32_bf16 v[112:115], v[160:163], v[140:143], v[112:115]
    v_mfma_f32_16x16x32_bf16 v[116:119], v[164:167], v[140:143], v[116:119]
    v_mfma_f32_16x16x32_bf16 v[120:123], v[168:171], v[140:143], v[120:123]
    v_mfma_f32_16x16x32_bf16 v[124:127], v[172:175], v[140:143], v[124:127]
    s_waitcnt lgkmcnt(0)
    s_waitcnt vmcnt(4)
    s_barrier
    ds_read_b128 v[136:139], v10 offset:1088
    ds_read_b128 v[140:143], v10 offset:22080
    ds_read_b64_tr_b16 v[160:161], v11 offset:30720
    ds_read_b64_tr_b16 v[162:163], v11 offset:38400
    ds_read_b64_tr_b16 v[164:165], v11 offset:30752
    ds_read_b64_tr_b16 v[166:167], v11 offset:38432
    ds_read_b64_tr_b16 v[168:169], v11 offset:30784
    ds_read_b64_tr_b16 v[170:171], v11 offset:38464
    ds_read_b64_tr_b16 v[172:173], v11 offset:30816
    ds_read_b64_tr_b16 v[174:175], v11 offset:38496
    v_mfma_f32_16x16x32_bf16 v[96:99], v[144:147], v[128:131], v[96:99]
    v_mfma_f32_16x16x32_bf16 v[100:103], v[148:151], v[128:131], v[100:103]
    v_mfma_f32_16x16x32_bf16 v[104:107], v[152:155], v[128:131], v[104:107]
    v_mfma_f32_16x16x32_bf16 v[108:111], v[156:159], v[128:131], v[108:111]
    v_mfma_f32_16x16x32_bf16 v[112:115], v[144:147], v[132:135], v[112:115]
    v_mfma_f32_16x16x32_bf16 v[116:119], v[148:151], v[132:135], v[116:119]
    v_mfma_f32_16x16x32_bf16 v[120:123], v[152:155], v[132:135], v[120:123]
    v_mfma_f32_16x16x32_bf16 v[124:127], v[156:159], v[132:135], v[124:127]
    s_waitcnt lgkmcnt(0)
    s_waitcnt vmcnt(2)
    s_barrier
    ds_read_b128 v[128:131], v10 offset:1152
    ds_read_b128 v[132:135], v10 offset:22144
    ds_read_b64_tr_b16 v[144:145], v11 offset:46080
    ds_read_b64_tr_b16 v[146:147], v11 offset:53760
    ds_read_b64_tr_b16 v[148:149], v11 offset:46112
    ds_read_b64_tr_b16 v[150:151], v11 offset:53792
    ds_read_b64_tr_b16 v[152:153], v11 offset:46144
    ds_read_b64_tr_b16 v[154:155], v11 offset:53824
    ds_read_b64_tr_b16 v[156:157], v11 offset:46176
    ds_read_b64_tr_b16 v[158:159], v11 offset:53856
    v_mfma_f32_16x16x32_bf16 v[96:99], v[160:163], v[136:139], v[96:99]
    v_mfma_f32_16x16x32_bf16 v[100:103], v[164:167], v[136:139], v[100:103]
    v_mfma_f32_16x16x32_bf16 v[104:107], v[168:171], v[136:139], v[104:107]
    v_mfma_f32_16x16x32_bf16 v[108:111], v[172:175], v[136:139], v[108:111]
    v_mfma_f32_16x16x32_bf16 v[112:115], v[160:163], v[140:143], v[112:115]
    v_mfma_f32_16x16x32_bf16 v[116:119], v[164:167], v[140:143], v[116:119]
    v_mfma_f32_16x16x32_bf16 v[120:123], v[168:171], v[140:143], v[120:123]
    v_mfma_f32_16x16x32_bf16 v[124:127], v[172:175], v[140:143], v[124:127]
    s_waitcnt lgkmcnt(0)
    s_waitcnt vmcnt(0)
    s_barrier
    ds_read_b128 v[136:139], v10 offset:1216
    ds_read_b128 v[140:143], v10 offset:22208
    ds_read_b64_tr_b16 v[160:161], v13 offset:0
    ds_read_b64_tr_b16 v[162:163], v13 offset:7680
    ds_read_b64_tr_b16 v[164:165], v13 offset:32
    ds_read_b64_tr_b16 v[166:167], v13 offset:7712
    ds_read_b64_tr_b16 v[168:169], v13 offset:64
    ds_read_b64_tr_b16 v[170:171], v13 offset:7744
    ds_read_b64_tr_b16 v[172:173], v13 offset:96
    ds_read_b64_tr_b16 v[174:175], v13 offset:7776
    v_mfma_f32_16x16x32_bf16 v[96:99], v[144:147], v[128:131], v[96:99]
    v_mfma_f32_16x16x32_bf16 v[100:103], v[148:151], v[128:131], v[100:103]
    v_mfma_f32_16x16x32_bf16 v[104:107], v[152:155], v[128:131], v[104:107]
    v_mfma_f32_16x16x32_bf16 v[108:111], v[156:159], v[128:131], v[108:111]
    v_mfma_f32_16x16x32_bf16 v[112:115], v[144:147], v[132:135], v[112:115]
    v_mfma_f32_16x16x32_bf16 v[116:119], v[148:151], v[132:135], v[116:119]
    v_mfma_f32_16x16x32_bf16 v[120:123], v[152:155], v[132:135], v[120:123]
    v_mfma_f32_16x16x32_bf16 v[124:127], v[156:159], v[132:135], v[124:127]
    s_waitcnt lgkmcnt(0)
    s_barrier
    v_mfma_f32_16x16x32_bf16 v[96:99], v[160:163], v[136:139], v[96:99]
    v_mfma_f32_16x16x32_bf16 v[100:103], v[164:167], v[136:139], v[100:103]
    v_mfma_f32_16x16x32_bf16 v[104:107], v[168:171], v[136:139], v[104:107]
    v_mfma_f32_16x16x32_bf16 v[108:111], v[172:175], v[136:139], v[108:111]
    v_mfma_f32_16x16x32_bf16 v[112:115], v[160:163], v[140:143], v[112:115]
    v_mfma_f32_16x16x32_bf16 v[116:119], v[164:167], v[140:143], v[116:119]
    v_mfma_f32_16x16x32_bf16 v[120:123], v[168:171], v[140:143], v[120:123]
    v_mfma_f32_16x16x32_bf16 v[124:127], v[172:175], v[140:143], v[124:127]
    s_nop 7
    s_nop 7
    s_barrier
    v_mov_b32 v76, 0
    v_mov_b32 v77, 0
    v_mov_b32 v78, 0
    v_mov_b32 v79, 0
    v_lshlrev_b32 v80, 4, v0
    v_add_u32 v80, 98304, v80
    ds_write_b128 v80, v[76:79]
    v_mul_u32_u24 v84, 656, v0
    v_lshrrev_b32 v84, 16, v84
    v_mul_u32_u24 v85, 100, v84
    v_sub_u32 v85, v0, v85
    v_mul_u32_u24 v86, 13108, v85
    v_lshrrev_b32 v86, 16, v86
    v_mul_u32_u24 v87, 5, v86
    v_sub_u32 v87, v85, v87
    v_lshlrev_b32 v84, 11, v84
    v_lshl_add_u32 v84, v86, 6, v84
    v_lshl_add_u32 v84, v87, 3, v84
    v_add_u32 v84, 98304, v84
    s_mul_i32 s33, s31, 15872
    s_lshl_b32 s34, s32, 7
    s_add_u32 s33, s33, s34
    v_mul_u32_u24 v12, 496, v3
    v_lshl_add_u32 v12, v2, 3, v12
    v_add_u32 v12, s33, v12
    v_cvt_pk_bf16_f32 v14, v96, v97
    v_cvt_pk_bf16_f32 v15, v98, v99
    ds_write_b64 v12, v[14:15] offset:0
    v_cvt_pk_bf16_f32 v14, v112, v113
    v_cvt_pk_bf16_f32 v15, v114, v115
    ds_write_b64 v12, v[14:15] offset:7936
    v_cvt_pk_bf16_f32 v14, v100, v101
    v_cvt_pk_bf16_f32 v15, v102, v103
    ds_write_b64 v12, v[14:15] offset:32
    v_cvt_pk_bf16_f32 v14, v116, v117
    v_cvt_pk_bf16_f32 v15, v118, v119
    ds_write_b64 v12, v[14:15] offset:7968
    v_cvt_pk_bf16_f32 v14, v104, v105
    v_cvt_pk_bf16_f32 v15, v106, v107
    ds_write_b64 v12, v[14:15] offset:64
    v_cvt_pk_bf16_f32 v14, v120, v121
    v_cvt_pk_bf16_f32 v15, v122, v123
    ds_write_b64 v12, v[14:15] offset:8000
    s_cmp_eq_u32 s32, 3
    s_cbranch_scc1 L_skip_t3_hh_k1_kernel_1
    v_cvt_pk_bf16_f32 v14, v108, v109
    v_cvt_pk_bf16_f32 v15, v110, v111
    ds_write_b64 v12, v[14:15] offset:96
    v_cvt_pk_bf16_f32 v14, v124, v125
    v_cvt_pk_bf16_f32 v15, v126, v127
    ds_write_b64 v12, v[14:15] offset:8032
L_skip_t3_hh_k1_kernel_1:
    s_waitcnt lgkmcnt(0)
    s_barrier
    v_cmp_gt_u32 vcc, 400, v0
    s_and_saveexec_b64 s[44:45], vcc
    ds_write_b64 v84, v[240:241]
    s_mov_b64 exec, s[44:45]
    s_waitcnt lgkmcnt(0)
    s_barrier
    s_and_b32 s43, s30, 3
    s_lshr_b32 s46, s30, 2
    s_mul_i32 s33, s46, 160
    s_mul_i32 s34, s43, 40
    s_add_u32 s33, s33, s34
    v_mul_u32_u24 v12, 496, v3
    v_lshl_add_u32 v12, v2, 3, v12
    v_add_u32 v12, s33, v12
    ds_read_b64 v[16:17], v12 offset:0
    ds_read_b64 v[18:19], v12 offset:32
    ds_read_b64 v[20:21], v12 offset:7936
    ds_read_b64 v[22:23], v12 offset:7968
    ds_read_b64 v[24:25], v12 offset:15872
    ds_read_b64 v[26:27], v12 offset:15904
    ds_read_b64 v[28:29], v12 offset:23808
    ds_read_b64 v[30:31], v12 offset:23840
    v_lshrrev_b32 v13, 2, v3
    v_lshl_add_u32 v13, v2, 2, v13
    v_lshlrev_b32 v13, 6, v13
    v_and_b32 v14, 3, v3
    v_lshl_add_u32 v13, v14, 3, v13
    s_lshl_b32 s33, s43, 11
    s_add_u32 s33, s33, 98304
    v_add_u32 v13, s33, v13
    ds_read_b64_tr_b16 v[32:33], v13 offset:0
    ds_read_b64_tr_b16 v[34:35], v13 offset:1024
    ds_read_b64_tr_b16 v[36:37], v13 offset:32
    ds_read_b64_tr_b16 v[38:39], v13 offset:1056
    v_mov_b32 v40, 0
    v_mov_b32 v41, 0
    v_mov_b32 v42, 0
    v_mov_b32 v43, 0
    v_mov_b32 v44, 0
    v_mov_b32 v45, 0
    v_mov_b32 v46, 0
    v_mov_b32 v47, 0
    v_mov_b32 v48, 0
    v_mov_b32 v49, 0
    v_mov_b32 v50, 0
    v_mov_b32 v51, 0
    v_mov_b32 v52, 0
    v_mov_b32 v53, 0
    v_mov_b32 v54, 0
    v_mov_b32 v55, 0
    v_mov_b32 v56, 0
    v_mov_b32 v57, 0
    v_mov_b32 v58, 0
    v_mov_b32 v59, 0
    v_mov_b32 v60, 0
    v_mov_b32 v61, 0
    v_mov_b32 v62, 0
    v_mov_b32 v63, 0
    v_mov_b32 v64, 0
    v_mov_b32 v65, 0
    v_mov_b32 v66, 0
    v_mov_b32 v67, 0
    v_mov_b32 v68, 0
    v_mov_b32 v69, 0
    v_mov_b32 v70, 0
    v_mov_b32 v71, 0
    s_waitcnt lgkmcnt(0)
    s_nop 1
    v_mfma_f32_16x16x32_bf16 v[40:43], v[32:35], v[16:19], v[40:43]
    v_mfma_f32_16x16x32_bf16 v[44:47], v[36:39], v[16:19], v[44:47]
    v_mfma_f32_16x16x32_bf16 v[48:51], v[32:35], v[20:23], v[48:51]
    v_mfma_f32_16x16x32_bf16 v[52:55], v[36:39], v[20:23], v[52:55]
    v_mfma_f32_16x16x32_bf16 v[56:59], v[32:35], v[24:27], v[56:59]
    v_mfma_f32_16x16x32_bf16 v[60:63], v[36:39], v[24:27], v[60:63]
    v_mfma_f32_16x16x32_bf16 v[64:67], v[32:35], v[28:31], v[64:67]
    v_mfma_f32_16x16x32_bf16 v[68:71], v[36:39], v[28:31], v[68:71]
    s_nop 7
    s_nop 7
    s_mul_i32 s33, s30, 5120
    s_add_u32 s33, s33, 32768
    v_mul_u32_u24 v12, 80, v3
    v_lshl_add_u32 v12, v2, 3, v12
    v_add_u32 v12, s33, v12
    v_cvt_pk_bf16_f32 v14, v40, v41
    v_cvt_pk_bf16_f32 v15, v42, v43
    ds_write_b64 v12, v[14:15] offset:0
    v_cvt_pk_bf16_f32 v14, v44, v45
    v_cvt_pk_bf16_f32 v15, v46, v47
    ds_write_b64 v12, v[14:15] offset:32
    v_cvt_pk_bf16_f32 v14, v48, v49
    v_cvt_pk_bf16_f32 v15, v50, v51
    ds_write_b64 v12, v[14:15] offset:1280
    v_cvt_pk_bf16_f32 v14, v52, v53
    v_cvt_pk_bf16_f32 v15, v54, v55
    ds_write_b64 v12, v[14:15] offset:1312
    v_cvt_pk_bf16_f32 v14, v56, v57
    v_cvt_pk_bf16_f32 v15, v58, v59
    ds_write_b64 v12, v[14:15] offset:2560
    v_cvt_pk_bf16_f32 v14, v60, v61
    v_cvt_pk_bf16_f32 v15, v62, v63
    ds_write_b64 v12, v[14:15] offset:2592
    v_cvt_pk_bf16_f32 v14, v64, v65
    v_cvt_pk_bf16_f32 v15, v66, v67
    ds_write_b64 v12, v[14:15] offset:3840
    v_cvt_pk_bf16_f32 v14, v68, v69
    v_cvt_pk_bf16_f32 v15, v70, v71
    ds_write_b64 v12, v[14:15] offset:3872
    s_waitcnt lgkmcnt(0)
    v_mul_u32_u24 v12, 80, v1
    v_add_u32 v12, s33, v12
    ds_read_b64 v[16:17], v12 offset:0
    ds_read_b64 v[18:19], v12 offset:8
    ds_read_b64 v[20:21], v12 offset:16
    ds_read_b64 v[22:23], v12 offset:24
    ds_read_b64 v[24:25], v12 offset:32
    s_waitcnt lgkmcnt(0)
    v_lshlrev_b32 v28, 16, v16
    v_and_b32 v29, 0xffff0000, v16
    v_lshlrev_b32 v30, 16, v17
    v_and_b32 v31, 0xffff0000, v17
    v_lshlrev_b32 v32, 16, v18
    v_and_b32 v33, 0xffff0000, v18
    v_lshlrev_b32 v34, 16, v19
    v_and_b32 v35, 0xffff0000, v19
    v_lshlrev_b32 v36, 16, v20
    v_and_b32 v37, 0xffff0000, v20
    v_lshlrev_b32 v38, 16, v21
    v_and_b32 v39, 0xffff0000, v21
    v_lshlrev_b32 v40, 16, v22
    v_and_b32 v41, 0xffff0000, v22
    v_lshlrev_b32 v42, 16, v23
    v_and_b32 v43, 0xffff0000, v23
    v_lshlrev_b32 v44, 16, v24
    v_and_b32 v45, 0xffff0000, v24
    v_lshlrev_b32 v46, 16, v25
    v_and_b32 v47, 0xffff0000, v25
    v_max3_f32 v48, v28, v29, v30
    v_min3_f32 v49, v28, v29, v30
    v_max3_f32 v48, v48, v31, v32
    v_min3_f32 v49, v49, v31, v32
    v_max3_f32 v48, v48, v33, v34
    v_min3_f32 v49, v49, v33, v34
    v_max3_f32 v48, v48, v35, v36
    v_min3_f32 v49, v49, v35, v36
    v_max3_f32 v48, v48, v37, v38
    v_min3_f32 v49, v49, v37, v38
    v_max3_f32 v48, v48, v39, v40
    v_min3_f32 v49, v49, v39, v40
    v_max3_f32 v48, v48, v41, v42
    v_min3_f32 v49, v49, v41, v42
    v_max3_f32 v48, v48, v43, v44
    v_min3_f32 v49, v49, v43, v44
    v_max3_f32 v48, v48, v45, v46
    v_min3_f32 v49, v49, v45, v46
    v_max_f32 v48, v48, v47
    v_min_f32 v49, v49, v47
    s_mov_b32 s47, 0x3fb8aa3b
    v_mul_f32 v50, s47, v48
    v_mul_f32 v51, s47, v49
    v_fma_f32 v52, v28, s47, -v50
    v_fma_f32 v72, -v28, s47, v51
    v_fma_f32 v53, v29, s47, -v50
    v_fma_f32 v73, -v29, s47, v51
    v_fma_f32 v54, v30, s47, -v50
    v_fma_f32 v74, -v30, s47, v51
    v_fma_f32 v55, v31, s47, -v50
    v_fma_f32 v75, -v31, s47, v51
    v_fma_f32 v56, v32, s47, -v50
    v_fma_f32 v76, -v32, s47, v51
    v_fma_f32 v57, v33, s47, -v50
    v_fma_f32 v77, -v33, s47, v51
    v_fma_f32 v58, v34, s47, -v50
    v_fma_f32 v78, -v34, s47, v51
    v_fma_f32 v59, v35, s47, -v50
    v_fma_f32 v79, -v35, s47, v51
    v_fma_f32 v60, v36, s47, -v50
    v_fma_f32 v80, -v36, s47, v51
    v_fma_f32 v61, v37, s47, -v50
    v_fma_f32 v81, -v37, s47, v51
    v_fma_f32 v62, v38, s47, -v50
    v_fma_f32 v82, -v38, s47, v51
    v_fma_f32 v63, v39, s47, -v50
    v_fma_f32 v83, -v39, s47, v51
    v_fma_f32 v64, v40, s47, -v50
    v_fma_f32 v84, -v40, s47, v51
    v_fma_f32 v65, v41, s47, -v50
    v_fma_f32 v85, -v41, s47, v51
    v_fma_f32 v66, v42, s47, -v50
    v_fma_f32 v86, -v42, s47, v51
    v_fma_f32 v67, v43, s47, -v50
    v_fma_f32 v87, -v43, s47, v51
    v_fma_f32 v68, v44, s47, -v50
    v_fma_f32 v88, -v44, s47, v51
    v_fma_f32 v69, v45, s47, -v50
    v_fma_f32 v89, -v45, s47, v51
    v_fma_f32 v70, v46, s47, -v50
    v_fma_f32 v90, -v46, s47, v51
    v_fma_f32 v71, v47, s47, -v50
    v_fma_f32 v91, -v47, s47, v51
    v_exp_f32 v52, v52
    v_exp_f32 v72, v72
    v_exp_f32 v53, v53
    v_exp_f32 v73, v73
    v_exp_f32 v54, v54
    v_exp_f32 v74, v74
    v_exp_f32 v55, v55
    v_exp_f32 v75, v75
    v_exp_f32 v56, v56
    v_exp_f32 v76, v76
    v_exp_f32 v57, v57
    v_exp_f32 v77, v77
    v_exp_f32 v58, v58
    v_exp_f32 v78, v78
    v_exp_f32 v59, v59
    v_exp_f32 v79, v79
    v_exp_f32 v60, v60
    v_exp_f32 v80, v80
    v_exp_f32 v61, v61
    v_exp_f32 v81, v81
    v_exp_f32 v62, v62
    v_exp_f32 v82, v82
    v_exp_f32 v63, v63
    v_exp_f32 v83, v83
    v_exp_f32 v64, v64
    v_exp_f32 v84, v84
    v_exp_f32 v65, v65
    v_exp_f32 v85, v85
    v_exp_f32 v66, v66
    v_exp_f32 v86, v86
    v_exp_f32 v67, v67
    v_exp_f32 v87, v87
    v_exp_f32 v68, v68
    v_exp_f32 v88, v88
    v_exp_f32 v69, v69
    v_exp_f32 v89, v89
    v_exp_f32 v70, v70
    v_exp_f32 v90, v90
    v_exp_f32 v71, v71
    v_exp_f32 v91, v91
    s_nop 0
    v_add_f32 v92, v52, v53
    v_add_f32 v93, v72, v73
    v_add_f32 v92, v92, v54
    v_add_f32 v93, v93, v74
    v_add_f32 v92, v92, v55
    v_add_f32 v93, v93, v75
    v_add_f32 v92, v92, v56
    v_add_f32 v93, v93, v76
    v_add_f32 v92, v92, v57
    v_add_f32 v93, v93, v77
    v_add_f32 v92, v92, v58
    v_add_f32 v93, v93, v78
    v_add_f32 v92, v92, v59
    v_add_f32 v93, v93, v79
    v_add_f32 v92, v92, v60
    v_add_f32 v93, v93, v80
    v_add_f32 v92, v92, v61
    v_add_f32 v93, v93, v81
    v_add_f32 v92, v92, v62
    v_add_f32 v93, v93, v82
    v_add_f32 v92, v92, v63
    v_add_f32 v93, v93, v83
    v_add_f32 v92, v92, v64
    v_add_f32 v93, v93, v84
    v_add_f32 v92, v92, v65
    v_add_f32 v93, v93, v85
    v_add_f32 v92, v92, v66
    v_add_f32 v93, v93, v86
    v_add_f32 v92, v92, v67
    v_add_f32 v93, v93, v87
    v_add_f32 v92, v92, v68
    v_add_f32 v93, v93, v88
    v_add_f32 v92, v92, v69
    v_add_f32 v93, v93, v89
    v_add_f32 v92, v92, v70
    v_add_f32 v93, v93, v90
    v_add_f32 v92, v92, v71
    v_add_f32 v93, v93, v91
    v_rcp_f32 v92, v92
    v_rcp_f32 v93, v93
    s_nop 0
    v_mul_f32 v94, v52, v92
    v_mul_f32 v95, v53, v92
    v_cvt_pk_bf16_f32 v16, v94, v95
    v_mul_f32 v94, v54, v92
    v_mul_f32 v95, v55, v92
    v_cvt_pk_bf16_f32 v17, v94, v95
    v_mul_f32 v94, v56, v92
    v_mul_f32 v95, v57, v92
    v_cvt_pk_bf16_f32 v18, v94, v95
    v_mul_f32 v94, v58, v92
    v_mul_f32 v95, v59, v92
    v_cvt_pk_bf16_f32 v19, v94, v95
    v_mul_f32 v94, v60, v92
    v_mul_f32 v95, v61, v92
    v_cvt_pk_bf16_f32 v20, v94, v95
    v_mul_f32 v94, v62, v92
    v_mul_f32 v95, v63, v92
    v_cvt_pk_bf16_f32 v21, v94, v95
    v_mul_f32 v94, v64, v92
    v_mul_f32 v95, v65, v92
    v_cvt_pk_bf16_f32 v22, v94, v95
    v_mul_f32 v94, v66, v92
    v_mul_f32 v95, v67, v92
    v_cvt_pk_bf16_f32 v23, v94, v95
    v_mul_f32 v94, v68, v92
    v_mul_f32 v95, v69, v92
    v_cvt_pk_bf16_f32 v24, v94, v95
    v_mul_f32 v94, v70, v92
    v_mul_f32 v95, v71, v92
    v_cvt_pk_bf16_f32 v25, v94, v95
    v_mul_f32 v94, v72, v93
    v_mul_f32 v95, v73, v93
    v_cvt_pk_bf16_f32 v26, v94, v95
    v_mul_f32 v94, v74, v93
    v_mul_f32 v95, v75, v93
    v_cvt_pk_bf16_f32 v27, v94, v95
    v_mul_f32 v94, v76, v93
    v_mul_f32 v95, v77, v93
    v_cvt_pk_bf16_f32 v28, v94, v95
    v_mul_f32 v94, v78, v93
    v_mul_f32 v95, v79, v93
    v_cvt_pk_bf16_f32 v29, v94, v95
    v_mul_f32 v94, v80, v93
    v_mul_f32 v95, v81, v93
    v_cvt_pk_bf16_f32 v30, v94, v95
    v_mul_f32 v94, v82, v93
    v_mul_f32 v95, v83, v93
    v_cvt_pk_bf16_f32 v31, v94, v95
    v_mul_f32 v94, v84, v93
    v_mul_f32 v95, v85, v93
    v_cvt_pk_bf16_f32 v32, v94, v95
    v_mul_f32 v94, v86, v93
    v_mul_f32 v95, v87, v93
    v_cvt_pk_bf16_f32 v33, v94, v95
    v_mul_f32 v94, v88, v93
    v_mul_f32 v95, v89, v93
    v_cvt_pk_bf16_f32 v34, v94, v95
    v_mul_f32 v94, v90, v93
    v_mul_f32 v95, v91, v93
    v_cvt_pk_bf16_f32 v35, v94, v95
    s_cmp_eq_u32 s46, 1
    s_cbranch_scc1 L_phik_hh_k1_kernel_2
    s_lshl_b32 s33, s29, 2
    s_add_u32 s33, s33, s43
    s_mul_i32 s33, s33, 80
    v_add_u32 v12, s42, v1
    v_mul_u32_u24 v12, 2560, v12
    v_add_u32 v12, s33, v12
    buffer_store_dwordx4 v[16:19], v12, s[20:23], 0 offen offset:0
    buffer_store_dwordx4 v[20:23], v12, s[20:23], 0 offen offset:16
    buffer_store_dwordx4 v[24:27], v12, s[20:23], 0 offen offset:32
    buffer_store_dwordx4 v[28:31], v12, s[20:23], 0 offen offset:48
    buffer_store_dwordx4 v[32:35], v12, s[20:23], 0 offen offset:64
    s_branch L_phidone_hh_k1_kernel_3
L_phik_hh_k1_kernel_2:
    s_mul_i32 s33, s43, 6144
    s_add_u32 s33, s33, 73728
    v_mul_u32_u24 v12, 96, v1
    v_add_u32 v12, s33, v12
    ds_write_b128 v12, v[16:19] offset:0
    ds_write_b128 v12, v[20:23] offset:16
    ds_write_b128 v12, v[24:27] offset:32
    ds_write_b128 v12, v[28:31] offset:48
    ds_write_b128 v12, v[32:35] offset:64
L_phidone_hh_k1_kernel_3:
    s_waitcnt lgkmcnt(0)
    s_barrier
    s_cmp_ge_u32 s30, 4
    s_cbranch_scc1 L_kv_skip_hh_k1_kernel_4
    v_lshrrev_b32 v13, 2, v3
    v_lshl_add_u32 v13, v2, 2, v13
    v_and_b32 v14, 3, v3
    v_mul_u32_u24 v15, 96, v13
    v_lshl_add_u32 v15, v14, 3, v15
    s_mul_i32 s33, s30, 6144
    s_add_u32 s33, s33, 73728
    v_add_u32 v15, s33, v15
    v_mul_u32_u24 v16, 496, v13
    v_lshl_add_u32 v16, v14, 3, v16
    s_mul_i32 s33, s30, 40
    s_add_u32 s33, s33, 320
    v_add_u32 v16, s33, v16
    ds_read_b64_tr_b16 v[20:21], v15 offset:0
    ds_read_b64_tr_b16 v[22:23], v15 offset:1536
    ds_read_b64_tr_b16 v[24:25], v15 offset:32
    ds_read_b64_tr_b16 v[26:27], v15 offset:1568
    ds_read_b64_tr_b16 v[28:29], v15 offset:64
    ds_read_b64_tr_b16 v[30:31], v15 offset:1600
    ds_read_b64_tr_b16 v[44:45], v16 offset:0
    ds_read_b64_tr_b16 v[46:47], v16 offset:7936
    ds_read_b64_tr_b16 v[48:49], v16 offset:32
    ds_read_b64_tr_b16 v[50:51], v16 offset:7968
    ds_read_b64_tr_b16 v[32:33], v15 offset:3072
    ds_read_b64_tr_b16 v[34:35], v15 offset:4608
    ds_read_b64_tr_b16 v[36:37], v15 offset:3104
    ds_read_b64_tr_b16 v[38:39], v15 offset:4640
    ds_read_b64_tr_b16 v[40:41], v15 offset:3136
    ds_read_b64_tr_b16 v[42:43], v15 offset:4672
    ds_read_b64_tr_b16 v[52:53], v16 offset:15872
    ds_read_b64_tr_b16 v[54:55], v16 offset:23808
    ds_read_b64_tr_b16 v[56:57], v16 offset:15904
    ds_read_b64_tr_b16 v[58:59], v16 offset:23840
    v_mov_b32 v60, 0
    v_mov_b32 v61, 0
    v_mov_b32 v62, 0
    v_mov_b32 v63, 0
    v_mov_b32 v64, 0
    v_mov_b32 v65, 0
    v_mov_b32 v66, 0
    v_mov_b32 v67, 0
    v_mov_b32 v68, 0
    v_mov_b32 v69, 0
    v_mov_b32 v70, 0
    v_mov_b32 v71, 0
    v_mov_b32 v72, 0
    v_mov_b32 v73, 0
    v_mov_b32 v74, 0
    v_mov_b32 v75, 0
    v_mov_b32 v76, 0
    v_mov_b32 v77, 0
    v_mov_b32 v78, 0
    v_mov_b32 v79, 0
    v_mov_b32 v80, 0
    v_mov_b32 v81, 0
    v_mov_b32 v82, 0
    v_mov_b32 v83, 0
    v_mov_b32 v17, 0x3f803f80
    v_cmp_eq_u32 vcc, 4, v3
    s_waitcnt lgkmcnt(0)
    v_cndmask_b32 v48, v48, v17, vcc
    v_cndmask_b32 v49, v49, v17, vcc
    v_cndmask_b32 v50, v50, v17, vcc
    v_cndmask_b32 v51, v51, v17, vcc
    v_cndmask_b32 v56, v56, v17, vcc
    v_cndmask_b32 v57, v57, v17, vcc
    v_cndmask_b32 v58, v58, v17, vcc
    v_cndmask_b32 v59, v59, v17, vcc
    s_nop 1
    v_mfma_f32_16x16x32_bf16 v[60:63], v[20:23], v[44:47], v[60:63]
    v_mfma_f32_16x16x32_bf16 v[64:67], v[20:23], v[48:51], v[64:67]
    v_mfma_f32_16x16x32_bf16 v[68:71], v[24:27], v[44:47], v[68:71]
    v_mfma_f32_16x16x32_bf16 v[72:75], v[24:27], v[48:51], v[72:75]
    v_mfma_f32_16x16x32_bf16 v[76:79], v[28:31], v[44:47], v[76:79]
    v_mfma_f32_16x16x32_bf16 v[80:83], v[28:31], v[48:51], v[80:83]
    v_mfma_f32_16x16x32_bf16 v[60:63], v[32:35], v[52:55], v[60:63]
    v_mfma_f32_16x16x32_bf16 v[64:67], v[32:35], v[56:59], v[64:67]
    v_mfma_f32_16x16x32_bf16 v[68:71], v[36:39], v[52:55], v[68:71]
    v_mfma_f32_16x16x32_bf16 v[72:75], v[36:39], v[56:59], v[72:75]
    v_mfma_f32_16x16x32_bf16 v[76:79], v[40:43], v[52:55], v[76:79]
    v_mfma_f32_16x16x32_bf16 v[80:83], v[40:43], v[56:59], v[80:83]
    s_nop 7
    s_nop 7
    s_lshl_b32 s33, s28, 5
    s_lshl_b32 s34, s29, 2
    s_add_u32 s33, s33, s34
    s_add_u32 s33, s33, s30
    s_mul_i32 s33, s33, 3360
    v_mul_u32_u24 v12, 160, v3
    v_lshl_add_u32 v12, v2, 4, v12
    v_add_u32 v12, s33, v12
    buffer_store_dwordx4 v[60:63], v12, s[24:27], 0 offen offset:0
    buffer_store_dwordx4 v[68:71], v12, s[24:27], 0 offen offset:64
    s_mov_b64 s[44:45], exec
    v_cmp_gt_u32 vcc, 2, v2
    s_and_b64 exec, exec, vcc
    buffer_store_dwordx4 v[76:79], v12, s[24:27], 0 offen offset:128
    s_mov_b64 exec, s[44:45]
    s_mov_b64 s[44:45], exec
    v_cmp_ge_u32 vcc, 4, v3
    s_and_b64 exec, exec, vcc
    buffer_store_dwordx4 v[64:67], v12, s[24:27], 0 offen offset:2560
    s_mov_b64 exec, s[44:45]
    s_mov_b64 s[44:45], exec
    v_cmp_ge_u32 vcc, 4, v3
    s_and_b64 exec, exec, vcc
    buffer_store_dwordx4 v[72:75], v12, s[24:27], 0 offen offset:2624
    s_mov_b64 exec, s[44:45]
    s_mov_b64 s[44:45], exec
    v_cmp_ge_u32 vcc, 4, v3
    s_and_b64 exec, exec, vcc
    v_cmp_gt_u32 vcc, 2, v2
    s_and_b64 exec, exec, vcc
    buffer_store_dwordx4 v[80:83], v12, s[24:27], 0 offen offset:2688
    s_mov_b64 exec, s[44:45]
L_kv_skip_hh_k1_kernel_4:
    s_waitcnt vmcnt(0)
L_k1_end:
    s_endpgm

.text
.globl hh_kr_kernel
.p2align 8
.type hh_kr_kernel,@function
hh_kr_kernel:
    s_cmp_ge_u32 s2, 256
    s_cbranch_scc1 L_kr_end
    s_load_dwordx2 s[40:41], s[0:1], 72
    s_and_b32 s28, s2, 7
    s_lshl_b32 s28, s28, 2
    s_bfe_u32 s29, s2, 0x20003
    s_add_u32 s28, s28, s29
    s_lshr_b32 s29, s2, 5
    v_and_b32 v1, 63, v0
    v_lshrrev_b32 v2, 4, v1
    v_and_b32 v3, 15, v1
    v_lshrrev_b32 v4, 6, v0
    s_nop 0
    v_readfirstlane_b32 s30, v4
    s_waitcnt lgkmcnt(0)
    s_add_u32 s8, s40, 0x600000
    s_addc_u32 s9, s41, 0
    s_mov_b32 s10, 0x348000
    s_mov_b32 s11, 0x00020000
    s_mov_b32 s12, s40
    s_mov_b32 s13, s41
    s_mov_b32 s14, 0x500000
    s_mov_b32 s15, 0x00020000
    s_add_u32 s16, s40, 0xa00000
    s_addc_u32 s17, s41, 0
    s_mov_b32 s18, 0x280000
    s_mov_b32 s19, 0x00020000
    v_mov_b32 v4, 0
    v_mov_b32 v5, 0
    v_mov_b32 v6, 0
    v_mov_b32 v7, 0
    v_lshlrev_b32 v8, 4, v0
    ds_write_b128 v8, v[4:7]
    v_cmp_gt_u32 vcc, 64, v0
    s_and_saveexec_b64 s[44:45], vcc
    ds_write_b128 v8, v[4:7] offset:4096
    s_mov_b64 exec, s[44:45]
    s_mul_i32 s33, s28, 3360
    v_lshlrev_b32 v9, 4, v0
    v_add_u32 v9, s33, v9
    v_cmp_gt_u32 vcc, 210, v0
    s_and_saveexec_b64 s[44:45], vcc
    s_mov_b32 s33, 0
    buffer_load_dwordx4 v[64:67], v9, s[8:11], s33 offen
    s_mov_b32 s33, 107520
    buffer_load_dwordx4 v[68:71], v9, s[8:11], s33 offen
    s_mov_b32 s33, 215040
    buffer_load_dwordx4 v[72:75], v9, s[8:11], s33 offen
    s_mov_b32 s33, 322560
    buffer_load_dwordx4 v[76:79], v9, s[8:11], s33 offen
    s_mov_b32 s33, 430080
    buffer_load_dwordx4 v[80:83], v9, s[8:11], s33 offen
    s_mov_b32 s33, 537600
    buffer_load_dwordx4 v[84:87], v9, s[8:11], s33 offen
    s_mov_b32 s33, 645120
    buffer_load_dwordx4 v[88:91], v9, s[8:11], s33 offen
    s_mov_b32 s33, 752640
    buffer_load_dwordx4 v[92:95], v9, s[8:11], s33 offen
    s_mov_b32 s33, 860160
    buffer_load_dwordx4 v[96:99], v9, s[8:11], s33 offen
    s_mov_b32 s33, 967680
    buffer_load_dwordx4 v[100:103], v9, s[8:11], s33 offen
    s_mov_b32 s33, 1075200
    buffer_load_dwordx4 v[104:107], v9, s[8:11], s33 offen
    s_mov_b32 s33, 1182720
    buffer_load_dwordx4 v[108:111], v9, s[8:11], s33 offen
    s_mov_b32 s33, 1290240
    buffer_load_dwordx4 v[112:115], v9, s[8:11], s33 offen
    s_mov_b32 s33, 1397760
    buffer_load_dwordx4 v[116:119], v9, s[8:11], s33 offen
    s_mov_b32 s33, 1505280
    buffer_load_dwordx4 v[120:123], v9, s[8:11], s33 offen
    s_mov_b32 s33, 1612800
    buffer_load_dwordx4 v[124:127], v9, s[8:11], s33 offen
    s_mov_b32 s33, 1720320
    buffer_load_dwordx4 v[128:131], v9, s[8:11], s33 offen
    s_mov_b32 s33, 1827840
    buffer_load_dwordx4 v[132:135], v9, s[8:11], s33 offen
    s_mov_b32 s33, 1935360
    buffer_load_dwordx4 v[136:139], v9, s[8:11], s33 offen
    s_mov_b32 s33, 2042880
    buffer_load_dwordx4 v[140:143], v9, s[8:11], s33 offen
    s_mov_b32 s33, 2150400
    buffer_load_dwordx4 v[144:147], v9, s[8:11], s33 offen
    s_mov_b32 s33, 2257920
    buffer_load_dwordx4 v[148:151], v9, s[8:11], s33 offen
    s_mov_b32 s33, 2365440
    buffer_load_dwordx4 v[152:155], v9, s[8:11], s33 offen
    s_mov_b32 s33, 2472960
    buffer_load_dwordx4 v[156:159], v9, s[8:11], s33 offen
    s_mov_b32 s33, 2580480
    buffer_load_dwordx4 v[160:163], v9, s[8:11], s33 offen
    s_mov_b32 s33, 2688000
    buffer_load_dwordx4 v[164:167], v9, s[8:11], s33 offen
    s_mov_b32 s33, 2795520
    buffer_load_dwordx4 v[168:171], v9, s[8:11], s33 offen
    s_mov_b32 s33, 2903040
    buffer_load_dwordx4 v[172:175], v9, s[8:11], s33 offen
    s_mov_b32 s33, 3010560
    buffer_load_dwordx4 v[176:179], v9, s[8:11], s33 offen
    s_mov_b32 s33, 3118080
    buffer_load_dwordx4 v[180:183], v9, s[8:11], s33 offen
    s_mov_b32 s33, 3225600
    buffer_load_dwordx4 v[184:187], v9, s[8:11], s33 offen
    s_mov_b32 s33, 3333120
    buffer_load_dwordx4 v[188:191], v9, s[8:11], s33 offen
    s_mov_b64 exec, s[44:45]
    s_lshl_b32 s33, s29, 8
    s_lshl_b32 s34, s30, 6
    s_add_u32 s33, s33, s34
    v_add_u32 v10, s33, v3
    v_mul_u32_u24 v11, 2560, v10
    s_mul_i32 s34, s28, 80
    v_lshl_add_u32 v11, v2, 4, v11
    v_add_u32 v11, s34, v11
    s_mov_b32 s35, 0
    buffer_load_dwordx4 v[16:19], v11, s[12:15], s35 offen
    buffer_load_dwordx4 v[20:23], v11, s[12:15], s35 offen offset:64
    s_mov_b32 s35, 40960
    buffer_load_dwordx4 v[24:27], v11, s[12:15], s35 offen
    buffer_load_dwordx4 v[28:31], v11, s[12:15], s35 offen offset:64
    s_mov_b32 s35, 81920
    buffer_load_dwordx4 v[32:35], v11, s[12:15], s35 offen
    buffer_load_dwordx4 v[36:39], v11, s[12:15], s35 offen offset:64
    s_mov_b32 s35, 122880
    buffer_load_dwordx4 v[40:43], v11, s[12:15], s35 offen
    buffer_load_dwordx4 v[44:47], v11, s[12:15], s35 offen offset:64
    s_waitcnt vmcnt(8)
    v_cmp_gt_u32 vcc, 210, v0
    s_and_saveexec_b64 s[44:45], vcc
    v_pk_add_f32 v[64:65], v[64:65], v[68:69]
    v_pk_add_f32 v[66:67], v[66:67], v[70:71]
    v_pk_add_f32 v[64:65], v[64:65], v[72:73]
    v_pk_add_f32 v[66:67], v[66:67], v[74:75]
    v_pk_add_f32 v[64:65], v[64:65], v[76:77]
    v_pk_add_f32 v[66:67], v[66:67], v[78:79]
    v_pk_add_f32 v[64:65], v[64:65], v[80:81]
    v_pk_add_f32 v[66:67], v[66:67], v[82:83]
    v_pk_add_f32 v[64:65], v[64:65], v[84:85]
    v_pk_add_f32 v[66:67], v[66:67], v[86:87]
    v_pk_add_f32 v[64:65], v[64:65], v[88:89]
    v_pk_add_f32 v[66:67], v[66:67], v[90:91]
    v_pk_add_f32 v[64:65], v[64:65], v[92:93]
    v_pk_add_f32 v[66:67], v[66:67], v[94:95]
    v_pk_add_f32 v[64:65], v[64:65], v[96:97]
    v_pk_add_f32 v[66:67], v[66:67], v[98:99]
    v_pk_add_f32 v[64:65], v[64:65], v[100:101]
    v_pk_add_f32 v[66:67], v[66:67], v[102:103]
    v_pk_add_f32 v[64:65], v[64:65], v[104:105]
    v_pk_add_f32 v[66:67], v[66:67], v[106:107]
    v_pk_add_f32 v[64:65], v[64:65], v[108:109]
    v_pk_add_f32 v[66:67], v[66:67], v[110:111]
    v_pk_add_f32 v[64:65], v[64:65], v[112:113]
    v_pk_add_f32 v[66:67], v[66:67], v[114:115]
    v_pk_add_f32 v[64:65], v[64:65], v[116:117]
    v_pk_add_f32 v[66:67], v[66:67], v[118:119]
    v_pk_add_f32 v[64:65], v[64:65], v[120:121]
    v_pk_add_f32 v[66:67], v[66:67], v[122:123]
    v_pk_add_f32 v[64:65], v[64:65], v[124:125]
    v_pk_add_f32 v[66:67], v[66:67], v[126:127]
    v_pk_add_f32 v[64:65], v[64:65], v[128:129]
    v_pk_add_f32 v[66:67], v[66:67], v[130:131]
    v_pk_add_f32 v[64:65], v[64:65], v[132:133]
    v_pk_add_f32 v[66:67], v[66:67], v[134:135]
    v_pk_add_f32 v[64:65], v[64:65], v[136:137]
    v_pk_add_f32 v[66:67], v[66:67], v[138:139]
    v_pk_add_f32 v[64:65], v[64:65], v[140:141]
    v_pk_add_f32 v[66:67], v[66:67], v[142:143]
    v_pk_add_f32 v[64:65], v[64:65], v[144:145]
    v_pk_add_f32 v[66:67], v[66:67], v[146:147]
    v_pk_add_f32 v[64:65], v[64:65], v[148:149]
    v_pk_add_f32 v[66:67], v[66:67], v[150:151]
    v_pk_add_f32 v[64:65], v[64:65], v[152:153]
    v_pk_add_f32 v[66:67], v[66:67], v[154:155]
    v_pk_add_f32 v[64:65], v[64:65], v[156:157]
    v_pk_add_f32 v[66:67], v[66:67], v[158:159]
    v_pk_add_f32 v[64:65], v[64:65], v[160:161]
    v_pk_add_f32 v[66:67], v[66:67], v[162:163]
    v_pk_add_f32 v[64:65], v[64:65], v[164:165]
    v_pk_add_f32 v[66:67], v[66:67], v[166:167]
    v_pk_add_f32 v[64:65], v[64:65], v[168:169]
    v_pk_add_f32 v[66:67], v[66:67], v[170:171]
    v_pk_add_f32 v[64:65], v[64:65], v[172:173]
    v_pk_add_f32 v[66:67], v[66:67], v[174:175]
    v_pk_add_f32 v[64:65], v[64:65], v[176:177]
    v_pk_add_f32 v[66:67], v[66:67], v[178:179]
    v_pk_add_f32 v[64:65], v[64:65], v[180:181]
    v_pk_add_f32 v[66:67], v[66:67], v[182:183]
    v_pk_add_f32 v[64:65], v[64:65], v[184:185]
    v_pk_add_f32 v[66:67], v[66:67], v[186:187]
    v_pk_add_f32 v[64:65], v[64:65], v[188:189]
    v_pk_add_f32 v[66:67], v[66:67], v[190:191]
    v_cvt_pk_bf16_f32 v12, v64, v65
    v_cvt_pk_bf16_f32 v13, v66, v67
    v_mul_u32_u24 v14, 6554, v0
    v_lshrrev_b32 v14, 16, v14
    v_mul_u32_u24 v15, 10, v14
    v_sub_u32 v15, v0, v15
    v_mul_u32_u24 v14, 144, v14
    v_lshl_add_u32 v14, v15, 3, v14
    s_waitcnt lgkmcnt(0)
    s_barrier
    ds_write_b64 v14, v[12:13]
    s_mov_b64 exec, s[44:45]
    s_waitcnt lgkmcnt(0)
    s_barrier
    v_mul_u32_u24 v12, 144, v3
    v_lshl_add_u32 v12, v2, 4, v12
    ds_read_b128 v[48:51], v12 offset:0
    ds_read_b128 v[52:55], v12 offset:2304
    ds_read_b128 v[56:59], v12 offset:64
    ds_read_b128 v[60:63], v12 offset:2368
    v_lshlrev_b32 v13, 4, v2
    ds_read_b128 v[64:67], v13 offset:2880
    ds_read_b128 v[68:71], v13 offset:2944
    v_mul_u32_u24 v14, 1280, v10
    s_mul_i32 s34, s28, 40
    v_lshl_add_u32 v14, v2, 3, v14
    v_add_u32 v14, s34, v14
    s_waitcnt vmcnt(0) lgkmcnt(0)
    v_mov_b32 v72, 0
    v_mov_b32 v73, 0
    v_mov_b32 v74, 0
    v_mov_b32 v75, 0
    v_mov_b32 v76, 0
    v_mov_b32 v77, 0
    v_mov_b32 v78, 0
    v_mov_b32 v79, 0
    v_mov_b32 v80, 0
    v_mov_b32 v81, 0
    v_mov_b32 v82, 0
    v_mov_b32 v83, 0
    s_nop 1
    v_mfma_f32_16x16x32_bf16 v[72:75], v[48:51], v[16:19], v[72:75]
    v_mfma_f32_16x16x32_bf16 v[76:79], v[52:55], v[16:19], v[76:79]
    v_mfma_f32_16x16x32_bf16 v[80:83], v[64:67], v[16:19], v[80:83]
    v_mfma_f32_16x16x32_bf16 v[72:75], v[56:59], v[20:23], v[72:75]
    v_mfma_f32_16x16x32_bf16 v[76:79], v[60:63], v[20:23], v[76:79]
    v_mfma_f32_16x16x32_bf16 v[80:83], v[68:71], v[20:23], v[80:83]
    s_nop 7
    s_nop 7
    v_cvt_pk_bf16_f32 v84, v80, v80
    v_and_b32 v84, 0xffff0000, v84
    v_add_f32 v84, 0x358637bd, v84
    v_cvt_pk_bf16_f32 v84, v84, v84
    v_and_b32 v84, 0xffff0000, v84
    v_rcp_f32 v84, v84
    v_cvt_pk_bf16_f32 v86, v72, v73
    v_cvt_pk_bf16_f32 v87, v74, v75
    v_lshlrev_b32 v88, 16, v86
    v_and_b32 v89, 0xffff0000, v86
    v_mul_f32 v88, v88, v84
    v_mul_f32 v89, v89, v84
    v_cvt_pk_bf16_f32 v90, v88, v89
    v_lshlrev_b32 v88, 16, v87
    v_and_b32 v89, 0xffff0000, v87
    v_mul_f32 v88, v88, v84
    v_mul_f32 v89, v89, v84
    v_cvt_pk_bf16_f32 v91, v88, v89
    s_mov_b32 s35, 0
    buffer_store_dwordx2 v[90:91], v14, s[16:19], s35 offen offset:0
    s_nop 1
    v_cvt_pk_bf16_f32 v86, v76, v77
    v_cvt_pk_bf16_f32 v87, v78, v79
    v_lshlrev_b32 v88, 16, v86
    v_and_b32 v89, 0xffff0000, v86
    v_mul_f32 v88, v88, v84
    v_mul_f32 v89, v89, v84
    v_cvt_pk_bf16_f32 v90, v88, v89
    v_lshlrev_b32 v88, 16, v87
    v_and_b32 v89, 0xffff0000, v87
    v_mul_f32 v88, v88, v84
    v_mul_f32 v89, v89, v84
    v_cvt_pk_bf16_f32 v91, v88, v89
    v_cmp_eq_u32 vcc, 0, v2
    s_and_saveexec_b64 s[44:45], vcc
    s_mov_b32 s35, 0
    buffer_store_dwordx2 v[90:91], v14, s[16:19], s35 offen offset:32
    s_mov_b64 exec, s[44:45]
    s_nop 1
    v_mov_b32 v72, 0
    v_mov_b32 v73, 0
    v_mov_b32 v74, 0
    v_mov_b32 v75, 0
    v_mov_b32 v76, 0
    v_mov_b32 v77, 0
    v_mov_b32 v78, 0
    v_mov_b32 v79, 0
    v_mov_b32 v80, 0
    v_mov_b32 v81, 0
    v_mov_b32 v82, 0
    v_mov_b32 v83, 0
    s_nop 1
    v_mfma_f32_16x16x32_bf16 v[72:75], v[48:51], v[24:27], v[72:75]
    v_mfma_f32_16x16x32_bf16 v[76:79], v[52:55], v[24:27], v[76:79]
    v_mfma_f32_16x16x32_bf16 v[80:83], v[64:67], v[24:27], v[80:83]
    v_mfma_f32_16x16x32_bf16 v[72:75], v[56:59], v[28:31], v[72:75]
    v_mfma_f32_16x16x32_bf16 v[76:79], v[60:63], v[28:31], v[76:79]
    v_mfma_f32_16x16x32_bf16 v[80:83], v[68:71], v[28:31], v[80:83]
    s_nop 7
    s_nop 7
    v_cvt_pk_bf16_f32 v84, v80, v80
    v_and_b32 v84, 0xffff0000, v84
    v_add_f32 v84, 0x358637bd, v84
    v_cvt_pk_bf16_f32 v84, v84, v84
    v_and_b32 v84, 0xffff0000, v84
    v_rcp_f32 v84, v84
    v_cvt_pk_bf16_f32 v86, v72, v73
    v_cvt_pk_bf16_f32 v87, v74, v75
    v_lshlrev_b32 v88, 16, v86
    v_and_b32 v89, 0xffff0000, v86
    v_mul_f32 v88, v88, v84
    v_mul_f32 v89, v89, v84
    v_cvt_pk_bf16_f32 v90, v88, v89
    v_lshlrev_b32 v88, 16, v87
    v_and_b32 v89, 0xffff0000, v87
    v_mul_f32 v88, v88, v84
    v_mul_f32 v89, v89, v84
    v_cvt_pk_bf16_f32 v91, v88, v89
    s_mov_b32 s35, 20480
    buffer_store_dwordx2 v[90:91], v14, s[16:19], s35 offen offset:0
    s_nop 1
    v_cvt_pk_bf16_f32 v86, v76, v77
    v_cvt_pk_bf16_f32 v87, v78, v79
    v_lshlrev_b32 v88, 16, v86
    v_and_b32 v89, 0xffff0000, v86
    v_mul_f32 v88, v88, v84
    v_mul_f32 v89, v89, v84
    v_cvt_pk_bf16_f32 v90, v88, v89
    v_lshlrev_b32 v88, 16, v87
    v_and_b32 v89, 0xffff0000, v87
    v_mul_f32 v88, v88, v84
    v_mul_f32 v89, v89, v84
    v_cvt_pk_bf16_f32 v91, v88, v89
    v_cmp_eq_u32 vcc, 0, v2
    s_and_saveexec_b64 s[44:45], vcc
    s_mov_b32 s35, 20480
    buffer_store_dwordx2 v[90:91], v14, s[16:19], s35 offen offset:32
    s_mov_b64 exec, s[44:45]
    s_nop 1
    v_mov_b32 v72, 0
    v_mov_b32 v73, 0
    v_mov_b32 v74, 0
    v_mov_b32 v75, 0
    v_mov_b32 v76, 0
    v_mov_b32 v77, 0
    v_mov_b32 v78, 0
    v_mov_b32 v79, 0
    v_mov_b32 v80, 0
    v_mov_b32 v81, 0
    v_mov_b32 v82, 0
    v_mov_b32 v83, 0
    s_nop 1
    v_mfma_f32_16x16x32_bf16 v[72:75], v[48:51], v[32:35], v[72:75]
    v_mfma_f32_16x16x32_bf16 v[76:79], v[52:55], v[32:35], v[76:79]
    v_mfma_f32_16x16x32_bf16 v[80:83], v[64:67], v[32:35], v[80:83]
    v_mfma_f32_16x16x32_bf16 v[72:75], v[56:59], v[36:39], v[72:75]
    v_mfma_f32_16x16x32_bf16 v[76:79], v[60:63], v[36:39], v[76:79]
    v_mfma_f32_16x16x32_bf16 v[80:83], v[68:71], v[36:39], v[80:83]
    s_nop 7
    s_nop 7
    v_cvt_pk_bf16_f32 v84, v80, v80
    v_and_b32 v84, 0xffff0000, v84
    v_add_f32 v84, 0x358637bd, v84
    v_cvt_pk_bf16_f32 v84, v84, v84
    v_and_b32 v84, 0xffff0000, v84
    v_rcp_f32 v84, v84
    v_cvt_pk_bf16_f32 v86, v72, v73
    v_cvt_pk_bf16_f32 v87, v74, v75
    v_lshlrev_b32 v88, 16, v86
    v_and_b32 v89, 0xffff0000, v86
    v_mul_f32 v88, v88, v84
    v_mul_f32 v89, v89, v84
    v_cvt_pk_bf16_f32 v90, v88, v89
    v_lshlrev_b32 v88, 16, v87
    v_and_b32 v89, 0xffff0000, v87
    v_mul_f32 v88, v88, v84
    v_mul_f32 v89, v89, v84
    v_cvt_pk_bf16_f32 v91, v88, v89
    s_mov_b32 s35, 40960
    buffer_store_dwordx2 v[90:91], v14, s[16:19], s35 offen offset:0
    s_nop 1
    v_cvt_pk_bf16_f32 v86, v76, v77
    v_cvt_pk_bf16_f32 v87, v78, v79
    v_lshlrev_b32 v88, 16, v86
    v_and_b32 v89, 0xffff0000, v86
    v_mul_f32 v88, v88, v84
    v_mul_f32 v89, v89, v84
    v_cvt_pk_bf16_f32 v90, v88, v89
    v_lshlrev_b32 v88, 16, v87
    v_and_b32 v89, 0xffff0000, v87
    v_mul_f32 v88, v88, v84
    v_mul_f32 v89, v89, v84
    v_cvt_pk_bf16_f32 v91, v88, v89
    v_cmp_eq_u32 vcc, 0, v2
    s_and_saveexec_b64 s[44:45], vcc
    s_mov_b32 s35, 40960
    buffer_store_dwordx2 v[90:91], v14, s[16:19], s35 offen offset:32
    s_mov_b64 exec, s[44:45]
    s_nop 1
    v_mov_b32 v72, 0
    v_mov_b32 v73, 0
    v_mov_b32 v74, 0
    v_mov_b32 v75, 0
    v_mov_b32 v76, 0
    v_mov_b32 v77, 0
    v_mov_b32 v78, 0
    v_mov_b32 v79, 0
    v_mov_b32 v80, 0
    v_mov_b32 v81, 0
    v_mov_b32 v82, 0
    v_mov_b32 v83, 0
    s_nop 1
    v_mfma_f32_16x16x32_bf16 v[72:75], v[48:51], v[40:43], v[72:75]
    v_mfma_f32_16x16x32_bf16 v[76:79], v[52:55], v[40:43], v[76:79]
    v_mfma_f32_16x16x32_bf16 v[80:83], v[64:67], v[40:43], v[80:83]
    v_mfma_f32_16x16x32_bf16 v[72:75], v[56:59], v[44:47], v[72:75]
    v_mfma_f32_16x16x32_bf16 v[76:79], v[60:63], v[44:47], v[76:79]
    v_mfma_f32_16x16x32_bf16 v[80:83], v[68:71], v[44:47], v[80:83]
    s_nop 7
    s_nop 7
    v_cvt_pk_bf16_f32 v84, v80, v80
    v_and_b32 v84, 0xffff0000, v84
    v_add_f32 v84, 0x358637bd, v84
    v_cvt_pk_bf16_f32 v84, v84, v84
    v_and_b32 v84, 0xffff0000, v84
    v_rcp_f32 v84, v84
    v_cvt_pk_bf16_f32 v86, v72, v73
    v_cvt_pk_bf16_f32 v87, v74, v75
    v_lshlrev_b32 v88, 16, v86
    v_and_b32 v89, 0xffff0000, v86
    v_mul_f32 v88, v88, v84
    v_mul_f32 v89, v89, v84
    v_cvt_pk_bf16_f32 v90, v88, v89
    v_lshlrev_b32 v88, 16, v87
    v_and_b32 v89, 0xffff0000, v87
    v_mul_f32 v88, v88, v84
    v_mul_f32 v89, v89, v84
    v_cvt_pk_bf16_f32 v91, v88, v89
    s_mov_b32 s35, 61440
    buffer_store_dwordx2 v[90:91], v14, s[16:19], s35 offen offset:0
    s_nop 1
    v_cvt_pk_bf16_f32 v86, v76, v77
    v_cvt_pk_bf16_f32 v87, v78, v79
    v_lshlrev_b32 v88, 16, v86
    v_and_b32 v89, 0xffff0000, v86
    v_mul_f32 v88, v88, v84
    v_mul_f32 v89, v89, v84
    v_cvt_pk_bf16_f32 v90, v88, v89
    v_lshlrev_b32 v88, 16, v87
    v_and_b32 v89, 0xffff0000, v87
    v_mul_f32 v88, v88, v84
    v_mul_f32 v89, v89, v84
    v_cvt_pk_bf16_f32 v91, v88, v89
    v_cmp_eq_u32 vcc, 0, v2
    s_and_saveexec_b64 s[44:45], vcc
    s_mov_b32 s35, 61440
    buffer_store_dwordx2 v[90:91], v14, s[16:19], s35 offen offset:32
    s_mov_b64 exec, s[44:45]
    s_nop 1
L_kr_end:
    s_endpgm

.text
.globl hh_k2_kernel
.p2align 8
.type hh_k2_kernel,@function
hh_k2_kernel:
    s_cmp_ge_u32 s2, 256
    s_cbranch_scc1 L_hh_k2_kernel_end
    s_load_dwordx2 s[4:5], s[0:1], 24
    s_load_dwordx2 s[6:7], s[0:1], 0
    s_load_dwordx2 s[38:39], s[0:1], 72
    s_load_dwordx2 s[40:41], s[0:1], 72
    s_and_b32 s28, s2, 7
    s_lshl_b32 s28, s28, 2
    s_bfe_u32 s29, s2, 0x20003
    s_add_u32 s28, s28, s29
    s_lshr_b32 s29, s2, 5
    v_and_b32 v1, 63, v0
    v_lshrrev_b32 v2, 4, v1
    v_and_b32 v3, 15, v1
    v_lshrrev_b32 v4, 6, v0
    s_nop 0
    v_readfirstlane_b32 s30, v4
    s_mul_i32 s33, s30, 320
    s_mul_i32 s34, s29, 160
    v_add_u32 v12, s33, v1
    v_mul_u32_u24 v13, 6554, v12
    v_lshrrev_b32 v13, 16, v13
    v_mul_u32_u24 v14, 10, v13
    v_sub_u32 v14, v12, v14
    v_mul_u32_u24 v4, 1280, v13
    v_lshl_add_u32 v4, v14, 4, v4
    v_add_u32 v4, s34, v4
    v_add_u32 v12, s33, v1
    v_add_u32 v12, 64, v12
    v_mul_u32_u24 v13, 6554, v12
    v_lshrrev_b32 v13, 16, v13
    v_mul_u32_u24 v14, 10, v13
    v_sub_u32 v14, v12, v14
    v_mul_u32_u24 v5, 1280, v13
    v_lshl_add_u32 v5, v14, 4, v5
    v_add_u32 v5, s34, v5
    v_add_u32 v12, s33, v1
    v_add_u32 v12, 128, v12
    v_mul_u32_u24 v13, 6554, v12
    v_lshrrev_b32 v13, 16, v13
    v_mul_u32_u24 v14, 10, v13
    v_sub_u32 v14, v12, v14
    v_mul_u32_u24 v6, 1280, v13
    v_lshl_add_u32 v6, v14, 4, v6
    v_add_u32 v6, s34, v6
    v_add_u32 v12, s33, v1
    v_add_u32 v12, 192, v12
    v_mul_u32_u24 v13, 6554, v12
    v_lshrrev_b32 v13, 16, v13
    v_mul_u32_u24 v14, 10, v13
    v_sub_u32 v14, v12, v14
    v_mul_u32_u24 v7, 1280, v13
    v_lshl_add_u32 v7, v14, 4, v7
    v_add_u32 v7, s34, v7
    v_add_u32 v12, s33, v1
    v_add_u32 v12, 256, v12
    v_mul_u32_u24 v13, 6554, v12
    v_lshrrev_b32 v13, 16, v13
    v_mul_u32_u24 v14, 10, v13
    v_sub_u32 v14, v12, v14
    v_mul_u32_u24 v8, 1280, v13
    v_lshl_add_u32 v8, v14, 4, v8
    v_add_u32 v8, s34, v8
    s_lshl_b32 s33, s28, 6
    s_lshl_b32 s34, s30, 4
    s_add_u32 s33, s33, s34
    v_add_u32 v12, 0, v2
    v_xor_b32 v13, v12, v3
    v_add_u32 v12, s33, v12
    v_mul_u32_u24 v20, 1280, v12
    v_lshl_add_u32 v20, v13, 4, v20
    v_add_u32 v12, 4, v2
    v_xor_b32 v13, v12, v3
    v_add_u32 v12, s33, v12
    v_mul_u32_u24 v21, 1280, v12
    v_lshl_add_u32 v21, v13, 4, v21
    v_add_u32 v12, 8, v2
    v_xor_b32 v13, v12, v3
    v_add_u32 v12, s33, v12
    v_mul_u32_u24 v22, 1280, v12
    v_lshl_add_u32 v22, v13, 4, v22
    v_add_u32 v12, 12, v2
    v_xor_b32 v13, v12, v3
    v_add_u32 v12, s33, v12
    v_mul_u32_u24 v23, 1280, v12
    v_lshl_add_u32 v23, v13, 4, v23
    s_waitcnt lgkmcnt(0)
    s_add_u32 s8, s40, 0xa00000
    s_addc_u32 s9, s41, 0
    s_mov_b32 s10, 0x280000
    s_mov_b32 s11, 0x00020000
    s_mov_b32 s12, s4
    s_mov_b32 s13, s5
    s_mov_b32 s14, 0xc8000
    s_mov_b32 s15, 0x00020000
    s_mov_b32 s16, s6
    s_mov_b32 s17, s7
    s_mov_b32 s18, 0x280000
    s_mov_b32 s19, 0x00020000
    s_add_u32 s20, s38, 0xd00000
    s_addc_u32 s21, s39, 0
    s_mov_b32 s22, 0x280000
    s_mov_b32 s23, 0x00020000
    s_lshl_b32 s35, s30, 10
    s_mul_i32 s42, s30, 5120
    s_mov_b32 s36, 0x0
    s_add_u32 s37, s42, 16384
    s_mov_b32 m0, s37
    s_nop 0
    buffer_load_dwordx4 v4, s[12:15], s36 offen lds
    s_add_u32 s37, s37, 1024
    s_mov_b32 m0, s37
    s_nop 0
    buffer_load_dwordx4 v5, s[12:15], s36 offen lds
    s_add_u32 s37, s37, 1024
    s_mov_b32 m0, s37
    s_nop 0
    buffer_load_dwordx4 v6, s[12:15], s36 offen lds
    s_add_u32 s37, s37, 1024
    s_mov_b32 m0, s37
    s_nop 0
    buffer_load_dwordx4 v7, s[12:15], s36 offen lds
    s_add_u32 s37, s37, 1024
    s_mov_b32 m0, s37
    s_nop 0
    buffer_load_dwordx4 v8, s[12:15], s36 offen lds
    s_mov_b32 s36, 0x0
    s_lshl_b32 s37, s35, 2
    s_add_u32 s37, s37, 0
    s_mov_b32 m0, s37
    s_nop 0
    buffer_load_dwordx4 v20, s[8:11], s36 offen lds
    s_add_u32 s37, s37, 1024
    s_mov_b32 m0, s37
    s_nop 0
    buffer_load_dwordx4 v21, s[8:11], s36 offen lds
    s_add_u32 s37, s37, 1024
    s_mov_b32 m0, s37
    s_nop 0
    buffer_load_dwordx4 v22, s[8:11], s36 offen lds
    s_add_u32 s37, s37, 1024
    s_mov_b32 m0, s37
    s_nop 0
    buffer_load_dwordx4 v23, s[8:11], s36 offen lds
    s_mov_b32 s36, 0x28000
    s_add_u32 s37, s42, 53248
    s_mov_b32 m0, s37
    s_nop 0
    buffer_load_dwordx4 v4, s[12:15], s36 offen lds
    s_add_u32 s37, s37, 1024
    s_mov_b32 m0, s37
    s_nop 0
    buffer_load_dwordx4 v5, s[12:15], s36 offen lds
    s_add_u32 s37, s37, 1024
    s_mov_b32 m0, s37
    s_nop 0
    buffer_load_dwordx4 v6, s[12:15], s36 offen lds
    s_add_u32 s37, s37, 1024
    s_mov_b32 m0, s37
    s_nop 0
    buffer_load_dwordx4 v7, s[12:15], s36 offen lds
    s_add_u32 s37, s37, 1024
    s_mov_b32 m0, s37
    s_nop 0
    buffer_load_dwordx4 v8, s[12:15], s36 offen lds
    s_mov_b32 s36, 0x100
    s_lshl_b32 s37, s35, 2
    s_add_u32 s37, s37, 36864
    s_mov_b32 m0, s37
    s_nop 0
    buffer_load_dwordx4 v20, s[8:11], s36 offen lds
    s_add_u32 s37, s37, 1024
    s_mov_b32 m0, s37
    s_nop 0
    buffer_load_dwordx4 v21, s[8:11], s36 offen lds
    s_add_u32 s37, s37, 1024
    s_mov_b32 m0, s37
    s_nop 0
    buffer_load_dwordx4 v22, s[8:11], s36 offen lds
    s_add_u32 s37, s37, 1024
    s_mov_b32 m0, s37
    s_nop 0
    buffer_load_dwordx4 v23, s[8:11], s36 offen lds
    s_mov_b32 s36, 0x50000
    s_add_u32 s37, s42, 90112
    s_mov_b32 m0, s37
    s_nop 0
    buffer_load_dwordx4 v4, s[12:15], s36 offen lds
    s_add_u32 s37, s37, 1024
    s_mov_b32 m0, s37
    s_nop 0
    buffer_load_dwordx4 v5, s[12:15], s36 offen lds
    s_add_u32 s37, s37, 1024
    s_mov_b32 m0, s37
    s_nop 0
    buffer_load_dwordx4 v6, s[12:15], s36 offen lds
    s_add_u32 s37, s37, 1024
    s_mov_b32 m0, s37
    s_nop 0
    buffer_load_dwordx4 v7, s[12:15], s36 offen lds
    s_add_u32 s37, s37, 1024
    s_mov_b32 m0, s37
    s_nop 0
    buffer_load_dwordx4 v8, s[12:15], s36 offen lds
    s_mov_b32 s36, 0x200
    s_lshl_b32 s37, s35, 2
    s_add_u32 s37, s37, 73728
    s_mov_b32 m0, s37
    s_nop 0
    buffer_load_dwordx4 v20, s[8:11], s36 offen lds
    s_add_u32 s37, s37, 1024
    s_mov_b32 m0, s37
    s_nop 0
    buffer_load_dwordx4 v21, s[8:11], s36 offen lds
    s_add_u32 s37, s37, 1024
    s_mov_b32 m0, s37
    s_nop 0
    buffer_load_dwordx4 v22, s[8:11], s36 offen lds
    s_add_u32 s37, s37, 1024
    s_mov_b32 m0, s37
    s_nop 0
    buffer_load_dwordx4 v23, s[8:11], s36 offen lds
    s_mov_b32 s36, 0x78000
    s_add_u32 s37, s42, 126976
    s_mov_b32 m0, s37
    s_nop 0
    buffer_load_dwordx4 v4, s[12:15], s36 offen lds
    s_add_u32 s37, s37, 1024
    s_mov_b32 m0, s37
    s_nop 0
    buffer_load_dwordx4 v5, s[12:15], s36 offen lds
    s_add_u32 s37, s37, 1024
    s_mov_b32 m0, s37
    s_nop 0
    buffer_load_dwordx4 v6, s[12:15], s36 offen lds
    s_add_u32 s37, s37, 1024
    s_mov_b32 m0, s37
    s_nop 0
    buffer_load_dwordx4 v7, s[12:15], s36 offen lds
    s_add_u32 s37, s37, 1024
    s_mov_b32 m0, s37
    s_nop 0
    buffer_load_dwordx4 v8, s[12:15], s36 offen lds
    s_mov_b32 s36, 0x300
    s_lshl_b32 s37, s35, 2
    s_add_u32 s37, s37, 110592
    s_mov_b32 m0, s37
    s_nop 0
    buffer_load_dwordx4 v20, s[8:11], s36 offen lds
    s_add_u32 s37, s37, 1024
    s_mov_b32 m0, s37
    s_nop 0
    buffer_load_dwordx4 v21, s[8:11], s36 offen lds
    s_add_u32 s37, s37, 1024
    s_mov_b32 m0, s37
    s_nop 0
    buffer_load_dwordx4 v22, s[8:11], s36 offen lds
    s_add_u32 s37, s37, 1024
    s_mov_b32 m0, s37
    s_nop 0
    buffer_load_dwordx4 v23, s[8:11], s36 offen lds
    v_add_u32 v9, s33, v3
    v_mul_u32_u24 v11, 1280, v9
    s_mul_i32 s34, s29, 160
    v_lshl_add_u32 v11, v2, 3, v11
    v_add_u32 v11, s34, v11
    buffer_load_dwordx2 v[96:97], v11, s[16:19], 0 offen offset:0
    buffer_load_dwordx2 v[98:99], v11, s[16:19], 0 offen offset:32
    buffer_load_dwordx2 v[100:101], v11, s[16:19], 0 offen offset:64
    buffer_load_dwordx2 v[102:103], v11, s[16:19], 0 offen offset:96
    buffer_load_dwordx2 v[104:105], v11, s[16:19], 0 offen offset:128
    v_lshrrev_b32 v12, 2, v3
    v_lshl_add_u32 v12, v2, 2, v12
    v_mul_u32_u24 v12, 160, v12
    v_and_b32 v13, 3, v3
    v_lshl_add_u32 v12, v13, 3, v12
    v_add_u32 v12, 16384, v12
    v_lshrrev_b32 v13, 1, v2
    v_and_b32 v14, 1, v2
    s_lshl_b32 s34, s30, 12
    v_lshl_add_u32 v15, v3, 8, s34
    v_lshl_add_u32 v15, v14, 3, v15
    v_add_u32 v24, 0, v13
    v_xor_b32 v24, v24, v3
    v_lshl_add_u32 v24, v24, 4, v15
    v_add_u32 v25, 2, v13
    v_xor_b32 v25, v25, v3
    v_lshl_add_u32 v25, v25, 4, v15
    v_add_u32 v26, 4, v13
    v_xor_b32 v26, v26, v3
    v_lshl_add_u32 v26, v26, 4, v15
    v_add_u32 v27, 6, v13
    v_xor_b32 v27, v27, v3
    v_lshl_add_u32 v27, v27, 4, v15
    v_add_u32 v28, 8, v13
    v_xor_b32 v28, v28, v3
    v_lshl_add_u32 v28, v28, 4, v15
    v_add_u32 v29, 10, v13
    v_xor_b32 v29, v29, v3
    v_lshl_add_u32 v29, v29, 4, v15
    v_add_u32 v30, 12, v13
    v_xor_b32 v30, v30, v3
    v_lshl_add_u32 v30, v30, 4, v15
    v_add_u32 v31, 14, v13
    v_xor_b32 v31, v31, v3
    v_lshl_add_u32 v31, v31, 4, v15
    v_add_u32 v120, 73728, v24
    v_add_u32 v121, 73728, v25
    v_add_u32 v122, 73728, v26
    v_add_u32 v123, 73728, v27
    v_add_u32 v124, 73728, v28
    v_add_u32 v125, 73728, v29
    v_add_u32 v126, 73728, v30
    v_add_u32 v127, 73728, v31
    v_add_u32 v10, 73728, v12
    v_mov_b32 v32, 0
    v_mov_b32 v33, 0
    v_mov_b32 v34, 0
    v_mov_b32 v35, 0
    v_mov_b32 v36, 0
    v_mov_b32 v37, 0
    v_mov_b32 v38, 0
    v_mov_b32 v39, 0
    v_mov_b32 v40, 0
    v_mov_b32 v41, 0
    v_mov_b32 v42, 0
    v_mov_b32 v43, 0
    v_mov_b32 v44, 0
    v_mov_b32 v45, 0
    v_mov_b32 v46, 0
    v_mov_b32 v47, 0
    v_mov_b32 v48, 0
    v_mov_b32 v49, 0
    v_mov_b32 v50, 0
    v_mov_b32 v51, 0
    s_waitcnt vmcnt(32)
    s_barrier
    ds_read_b64 v[108:109], v24 offset:0
    ds_read_b64 v[110:111], v25 offset:0
    ds_read_b64_tr_b16 v[52:53], v12 offset:0
    ds_read_b64_tr_b16 v[54:55], v12 offset:2560
    ds_read_b64_tr_b16 v[56:57], v12 offset:32
    ds_read_b64_tr_b16 v[58:59], v12 offset:2592
    ds_read_b64_tr_b16 v[60:61], v12 offset:64
    ds_read_b64_tr_b16 v[62:63], v12 offset:2624
    ds_read_b64_tr_b16 v[64:65], v12 offset:96
    ds_read_b64_tr_b16 v[66:67], v12 offset:2656
    ds_read_b64_tr_b16 v[68:69], v12 offset:128
    ds_read_b64_tr_b16 v[70:71], v12 offset:2688
    s_waitcnt lgkmcnt(0)
    ds_read_b64 v[112:113], v26 offset:0
    ds_read_b64 v[114:115], v27 offset:0
    ds_read_b64_tr_b16 v[72:73], v12 offset:5120
    ds_read_b64_tr_b16 v[74:75], v12 offset:7680
    ds_read_b64_tr_b16 v[76:77], v12 offset:5152
    ds_read_b64_tr_b16 v[78:79], v12 offset:7712
    ds_read_b64_tr_b16 v[80:81], v12 offset:5184
    ds_read_b64_tr_b16 v[82:83], v12 offset:7744
    ds_read_b64_tr_b16 v[84:85], v12 offset:5216
    ds_read_b64_tr_b16 v[86:87], v12 offset:7776
    ds_read_b64_tr_b16 v[88:89], v12 offset:5248
    ds_read_b64_tr_b16 v[90:91], v12 offset:7808
    v_mfma_f32_16x16x32_bf16 v[32:35], v[52:55], v[108:111], v[32:35]
    v_mfma_f32_16x16x32_bf16 v[36:39], v[56:59], v[108:111], v[36:39]
    v_mfma_f32_16x16x32_bf16 v[40:43], v[60:63], v[108:111], v[40:43]
    v_mfma_f32_16x16x32_bf16 v[44:47], v[64:67], v[108:111], v[44:47]
    v_mfma_f32_16x16x32_bf16 v[48:51], v[68:71], v[108:111], v[48:51]
    s_waitcnt lgkmcnt(0)
    ds_read_b64 v[108:109], v28 offset:0
    ds_read_b64 v[110:111], v29 offset:0
    ds_read_b64_tr_b16 v[52:53], v12 offset:10240
    ds_read_b64_tr_b16 v[54:55], v12 offset:12800
    ds_read_b64_tr_b16 v[56:57], v12 offset:10272
    ds_read_b64_tr_b16 v[58:59], v12 offset:12832
    ds_read_b64_tr_b16 v[60:61], v12 offset:10304
    ds_read_b64_tr_b16 v[62:63], v12 offset:12864
    ds_read_b64_tr_b16 v[64:65], v12 offset:10336
    ds_read_b64_tr_b16 v[66:67], v12 offset:12896
    ds_read_b64_tr_b16 v[68:69], v12 offset:10368
    ds_read_b64_tr_b16 v[70:71], v12 offset:12928
    v_mfma_f32_16x16x32_bf16 v[32:35], v[72:75], v[112:115], v[32:35]
    v_mfma_f32_16x16x32_bf16 v[36:39], v[76:79], v[112:115], v[36:39]
    v_mfma_f32_16x16x32_bf16 v[40:43], v[80:83], v[112:115], v[40:43]
    v_mfma_f32_16x16x32_bf16 v[44:47], v[84:87], v[112:115], v[44:47]
    v_mfma_f32_16x16x32_bf16 v[48:51], v[88:91], v[112:115], v[48:51]
    s_waitcnt lgkmcnt(0)
    ds_read_b64 v[112:113], v30 offset:0
    ds_read_b64 v[114:115], v31 offset:0
    ds_read_b64_tr_b16 v[72:73], v12 offset:15360
    ds_read_b64_tr_b16 v[74:75], v12 offset:17920
    ds_read_b64_tr_b16 v[76:77], v12 offset:15392
    ds_read_b64_tr_b16 v[78:79], v12 offset:17952
    ds_read_b64_tr_b16 v[80:81], v12 offset:15424
    ds_read_b64_tr_b16 v[82:83], v12 offset:17984
    ds_read_b64_tr_b16 v[84:85], v12 offset:15456
    ds_read_b64_tr_b16 v[86:87], v12 offset:18016
    ds_read_b64_tr_b16 v[88:89], v12 offset:15488
    ds_read_b64_tr_b16 v[90:91], v12 offset:18048
    v_mfma_f32_16x16x32_bf16 v[32:35], v[52:55], v[108:111], v[32:35]
    v_mfma_f32_16x16x32_bf16 v[36:39], v[56:59], v[108:111], v[36:39]
    v_mfma_f32_16x16x32_bf16 v[40:43], v[60:63], v[108:111], v[40:43]
    v_mfma_f32_16x16x32_bf16 v[44:47], v[64:67], v[108:111], v[44:47]
    v_mfma_f32_16x16x32_bf16 v[48:51], v[68:71], v[108:111], v[48:51]
    s_waitcnt lgkmcnt(0)
    s_waitcnt vmcnt(23)
    s_barrier
    s_mov_b32 s36, 0xa0000
    s_add_u32 s37, s42, 16384
    s_mov_b32 m0, s37
    s_nop 0
    buffer_load_dwordx4 v4, s[12:15], s36 offen lds
    s_add_u32 s37, s37, 1024
    s_mov_b32 m0, s37
    s_nop 0
    buffer_load_dwordx4 v5, s[12:15], s36 offen lds
    s_add_u32 s37, s37, 1024
    s_mov_b32 m0, s37
    s_nop 0
    buffer_load_dwordx4 v6, s[12:15], s36 offen lds
    s_add_u32 s37, s37, 1024
    s_mov_b32 m0, s37
    s_nop 0
    buffer_load_dwordx4 v7, s[12:15], s36 offen lds
    s_add_u32 s37, s37, 1024
    s_mov_b32 m0, s37
    s_nop 0
    buffer_load_dwordx4 v8, s[12:15], s36 offen lds
    s_mov_b32 s36, 0x400
    s_lshl_b32 s37, s35, 2
    s_add_u32 s37, s37, 0
    s_mov_b32 m0, s37
    s_nop 0
    buffer_load_dwordx4 v20, s[8:11], s36 offen lds
    s_add_u32 s37, s37, 1024
    s_mov_b32 m0, s37
    s_nop 0
    buffer_load_dwordx4 v21, s[8:11], s36 offen lds
    s_add_u32 s37, s37, 1024
    s_mov_b32 m0, s37
    s_nop 0
    buffer_load_dwordx4 v22, s[8:11], s36 offen lds
    s_add_u32 s37, s37, 1024
    s_mov_b32 m0, s37
    s_nop 0
    buffer_load_dwordx4 v23, s[8:11], s36 offen lds
    ds_read_b64 v[108:109], v24 offset:36864
    ds_read_b64 v[110:111], v25 offset:36864
    ds_read_b64_tr_b16 v[52:53], v12 offset:36864
    ds_read_b64_tr_b16 v[54:55], v12 offset:39424
    ds_read_b64_tr_b16 v[56:57], v12 offset:36896
    ds_read_b64_tr_b16 v[58:59], v12 offset:39456
    ds_read_b64_tr_b16 v[60:61], v12 offset:36928
    ds_read_b64_tr_b16 v[62:63], v12 offset:39488
    ds_read_b64_tr_b16 v[64:65], v12 offset:36960
    ds_read_b64_tr_b16 v[66:67], v12 offset:39520
    ds_read_b64_tr_b16 v[68:69], v12 offset:36992
    ds_read_b64_tr_b16 v[70:71], v12 offset:39552
    v_mfma_f32_16x16x32_bf16 v[32:35], v[72:75], v[112:115], v[32:35]
    v_mfma_f32_16x16x32_bf16 v[36:39], v[76:79], v[112:115], v[36:39]
    v_mfma_f32_16x16x32_bf16 v[40:43], v[80:83], v[112:115], v[40:43]
    v_mfma_f32_16x16x32_bf16 v[44:47], v[84:87], v[112:115], v[44:47]
    v_mfma_f32_16x16x32_bf16 v[48:51], v[88:91], v[112:115], v[48:51]
    s_waitcnt lgkmcnt(0)
    ds_read_b64 v[112:113], v26 offset:36864
    ds_read_b64 v[114:115], v27 offset:36864
    ds_read_b64_tr_b16 v[72:73], v12 offset:41984
    ds_read_b64_tr_b16 v[74:75], v12 offset:44544
    ds_read_b64_tr_b16 v[76:77], v12 offset:42016
    ds_read_b64_tr_b16 v[78:79], v12 offset:44576
    ds_read_b64_tr_b16 v[80:81], v12 offset:42048
    ds_read_b64_tr_b16 v[82:83], v12 offset:44608
    ds_read_b64_tr_b16 v[84:85], v12 offset:42080
    ds_read_b64_tr_b16 v[86:87], v12 offset:44640
    ds_read_b64_tr_b16 v[88:89], v12 offset:42112
    ds_read_b64_tr_b16 v[90:91], v12 offset:44672
    v_mfma_f32_16x16x32_bf16 v[32:35], v[52:55], v[108:111], v[32:35]
    v_mfma_f32_16x16x32_bf16 v[36:39], v[56:59], v[108:111], v[36:39]
    v_mfma_f32_16x16x32_bf16 v[40:43], v[60:63], v[108:111], v[40:43]
    v_mfma_f32_16x16x32_bf16 v[44:47], v[64:67], v[108:111], v[44:47]
    v_mfma_f32_16x16x32_bf16 v[48:51], v[68:71], v[108:111], v[48:51]
    s_waitcnt lgkmcnt(0)
    ds_read_b64 v[108:109], v28 offset:36864
    ds_read_b64 v[110:111], v29 offset:36864
    ds_read_b64_tr_b16 v[52:53], v12 offset:47104
    ds_read_b64_tr_b16 v[54:55], v12 offset:49664
    ds_read_b64_tr_b16 v[56:57], v12 offset:47136
    ds_read_b64_tr_b16 v[58:59], v12 offset:49696
    ds_read_b64_tr_b16 v[60:61], v12 offset:47168
    ds_read_b64_tr_b16 v[62:63], v12 offset:49728
    ds_read_b64_tr_b16 v[64:65], v12 offset:47200
    ds_read_b64_tr_b16 v[66:67], v12 offset:49760
    ds_read_b64_tr_b16 v[68:69], v12 offset:47232
    ds_read_b64_tr_b16 v[70:71], v12 offset:49792
    v_mfma_f32_16x16x32_bf16 v[32:35], v[72:75], v[112:115], v[32:35]
    v_mfma_f32_16x16x32_bf16 v[36:39], v[76:79], v[112:115], v[36:39]
    v_mfma_f32_16x16x32_bf16 v[40:43], v[80:83], v[112:115], v[40:43]
    v_mfma_f32_16x16x32_bf16 v[44:47], v[84:87], v[112:115], v[44:47]
    v_mfma_f32_16x16x32_bf16 v[48:51], v[88:91], v[112:115], v[48:51]
    s_waitcnt lgkmcnt(0)
    ds_read_b64 v[112:113], v30 offset:36864
    ds_read_b64 v[114:115], v31 offset:36864
    ds_read_b64_tr_b16 v[72:73], v12 offset:52224
    ds_read_b64_tr_b16 v[74:75], v12 offset:54784
    ds_read_b64_tr_b16 v[76:77], v12 offset:52256
    ds_read_b64_tr_b16 v[78:79], v12 offset:54816
    ds_read_b64_tr_b16 v[80:81], v12 offset:52288
    ds_read_b64_tr_b16 v[82:83], v12 offset:54848
    ds_read_b64_tr_b16 v[84:85], v12 offset:52320
    ds_read_b64_tr_b16 v[86:87], v12 offset:54880
    ds_read_b64_tr_b16 v[88:89], v12 offset:52352
    ds_read_b64_tr_b16 v[90:91], v12 offset:54912
    v_mfma_f32_16x16x32_bf16 v[32:35], v[52:55], v[108:111], v[32:35]
    v_mfma_f32_16x16x32_bf16 v[36:39], v[56:59], v[108:111], v[36:39]
    v_mfma_f32_16x16x32_bf16 v[40:43], v[60:63], v[108:111], v[40:43]
    v_mfma_f32_16x16x32_bf16 v[44:47], v[64:67], v[108:111], v[44:47]
    v_mfma_f32_16x16x32_bf16 v[48:51], v[68:71], v[108:111], v[48:51]
    s_waitcnt lgkmcnt(0)
    s_waitcnt vmcnt(23)
    s_barrier
    ds_read_b64 v[108:109], v120 offset:0
    ds_read_b64 v[110:111], v121 offset:0
    ds_read_b64_tr_b16 v[52:53], v10 offset:0
    ds_read_b64_tr_b16 v[54:55], v10 offset:2560
    ds_read_b64_tr_b16 v[56:57], v10 offset:32
    ds_read_b64_tr_b16 v[58:59], v10 offset:2592
    ds_read_b64_tr_b16 v[60:61], v10 offset:64
    ds_read_b64_tr_b16 v[62:63], v10 offset:2624
    ds_read_b64_tr_b16 v[64:65], v10 offset:96
    ds_read_b64_tr_b16 v[66:67], v10 offset:2656
    ds_read_b64_tr_b16 v[68:69], v10 offset:128
    ds_read_b64_tr_b16 v[70:71], v10 offset:2688
    v_mfma_f32_16x16x32_bf16 v[32:35], v[72:75], v[112:115], v[32:35]
    v_mfma_f32_16x16x32_bf16 v[36:39], v[76:79], v[112:115], v[36:39]
    v_mfma_f32_16x16x32_bf16 v[40:43], v[80:83], v[112:115], v[40:43]
    v_mfma_f32_16x16x32_bf16 v[44:47], v[84:87], v[112:115], v[44:47]
    v_mfma_f32_16x16x32_bf16 v[48:51], v[88:91], v[112:115], v[48:51]
    s_waitcnt lgkmcnt(0)
    ds_read_b64 v[112:113], v122 offset:0
    ds_read_b64 v[114:115], v123 offset:0
    ds_read_b64_tr_b16 v[72:73], v10 offset:5120
    ds_read_b64_tr_b16 v[74:75], v10 offset:7680
    ds_read_b64_tr_b16 v[76:77], v10 offset:5152
    ds_read_b64_tr_b16 v[78:79], v10 offset:7712
    ds_read_b64_tr_b16 v[80:81], v10 offset:5184
    ds_read_b64_tr_b16 v[82:83], v10 offset:7744
    ds_read_b64_tr_b16 v[84:85], v10 offset:5216
    ds_read_b64_tr_b16 v[86:87], v10 offset:7776
    ds_read_b64_tr_b16 v[88:89], v10 offset:5248
    ds_read_b64_tr_b16 v[90:91], v10 offset:7808
    v_mfma_f32_16x16x32_bf16 v[32:35], v[52:55], v[108:111], v[32:35]
    v_mfma_f32_16x16x32_bf16 v[36:39], v[56:59], v[108:111], v[36:39]
    v_mfma_f32_16x16x32_bf16 v[40:43], v[60:63], v[108:111], v[40:43]
    v_mfma_f32_16x16x32_bf16 v[44:47], v[64:67], v[108:111], v[44:47]
    v_mfma_f32_16x16x32_bf16 v[48:51], v[68:71], v[108:111], v[48:51]
    s_waitcnt lgkmcnt(0)
    ds_read_b64 v[108:109], v124 offset:0
    ds_read_b64 v[110:111], v125 offset:0
    ds_read_b64_tr_b16 v[52:53], v10 offset:10240
    ds_read_b64_tr_b16 v[54:55], v10 offset:12800
    ds_read_b64_tr_b16 v[56:57], v10 offset:10272
    ds_read_b64_tr_b16 v[58:59], v10 offset:12832
    ds_read_b64_tr_b16 v[60:61], v10 offset:10304
    ds_read_b64_tr_b16 v[62:63], v10 offset:12864
    ds_read_b64_tr_b16 v[64:65], v10 offset:10336
    ds_read_b64_tr_b16 v[66:67], v10 offset:12896
    ds_read_b64_tr_b16 v[68:69], v10 offset:10368
    ds_read_b64_tr_b16 v[70:71], v10 offset:12928
    v_mfma_f32_16x16x32_bf16 v[32:35], v[72:75], v[112:115], v[32:35]
    v_mfma_f32_16x16x32_bf16 v[36:39], v[76:79], v[112:115], v[36:39]
    v_mfma_f32_16x16x32_bf16 v[40:43], v[80:83], v[112:115], v[40:43]
    v_mfma_f32_16x16x32_bf16 v[44:47], v[84:87], v[112:115], v[44:47]
    v_mfma_f32_16x16x32_bf16 v[48:51], v[88:91], v[112:115], v[48:51]
    s_waitcnt lgkmcnt(0)
    ds_read_b64 v[112:113], v126 offset:0
    ds_read_b64 v[114:115], v127 offset:0
    ds_read_b64_tr_b16 v[72:73], v10 offset:15360
    ds_read_b64_tr_b16 v[74:75], v10 offset:17920
    ds_read_b64_tr_b16 v[76:77], v10 offset:15392
    ds_read_b64_tr_b16 v[78:79], v10 offset:17952
    ds_read_b64_tr_b16 v[80:81], v10 offset:15424
    ds_read_b64_tr_b16 v[82:83], v10 offset:17984
    ds_read_b64_tr_b16 v[84:85], v10 offset:15456
    ds_read_b64_tr_b16 v[86:87], v10 offset:18016
    ds_read_b64_tr_b16 v[88:89], v10 offset:15488
    ds_read_b64_tr_b16 v[90:91], v10 offset:18048
    v_mfma_f32_16x16x32_bf16 v[32:35], v[52:55], v[108:111], v[32:35]
    v_mfma_f32_16x16x32_bf16 v[36:39], v[56:59], v[108:111], v[36:39]
    v_mfma_f32_16x16x32_bf16 v[40:43], v[60:63], v[108:111], v[40:43]
    v_mfma_f32_16x16x32_bf16 v[44:47], v[64:67], v[108:111], v[44:47]
    v_mfma_f32_16x16x32_bf16 v[48:51], v[68:71], v[108:111], v[48:51]
    s_waitcnt lgkmcnt(0)
    s_waitcnt vmcnt(14)
    s_barrier
    ds_read_b64 v[108:109], v120 offset:36864
    ds_read_b64 v[110:111], v121 offset:36864
    ds_read_b64_tr_b16 v[52:53], v10 offset:36864
    ds_read_b64_tr_b16 v[54:55], v10 offset:39424
    ds_read_b64_tr_b16 v[56:57], v10 offset:36896
    ds_read_b64_tr_b16 v[58:59], v10 offset:39456
    ds_read_b64_tr_b16 v[60:61], v10 offset:36928
    ds_read_b64_tr_b16 v[62:63], v10 offset:39488
    ds_read_b64_tr_b16 v[64:65], v10 offset:36960
    ds_read_b64_tr_b16 v[66:67], v10 offset:39520
    ds_read_b64_tr_b16 v[68:69], v10 offset:36992
    ds_read_b64_tr_b16 v[70:71], v10 offset:39552
    v_mfma_f32_16x16x32_bf16 v[32:35], v[72:75], v[112:115], v[32:35]
    v_mfma_f32_16x16x32_bf16 v[36:39], v[76:79], v[112:115], v[36:39]
    v_mfma_f32_16x16x32_bf16 v[40:43], v[80:83], v[112:115], v[40:43]
    v_mfma_f32_16x16x32_bf16 v[44:47], v[84:87], v[112:115], v[44:47]
    v_mfma_f32_16x16x32_bf16 v[48:51], v[88:91], v[112:115], v[48:51]
    s_waitcnt lgkmcnt(0)
    ds_read_b64 v[112:113], v122 offset:36864
    ds_read_b64 v[114:115], v123 offset:36864
    ds_read_b64_tr_b16 v[72:73], v10 offset:41984
    ds_read_b64_tr_b16 v[74:75], v10 offset:44544
    ds_read_b64_tr_b16 v[76:77], v10 offset:42016
    ds_read_b64_tr_b16 v[78:79], v10 offset:44576
    ds_read_b64_tr_b16 v[80:81], v10 offset:42048
    ds_read_b64_tr_b16 v[82:83], v10 offset:44608
    ds_read_b64_tr_b16 v[84:85], v10 offset:42080
    ds_read_b64_tr_b16 v[86:87], v10 offset:44640
    ds_read_b64_tr_b16 v[88:89], v10 offset:42112
    ds_read_b64_tr_b16 v[90:91], v10 offset:44672
    v_mfma_f32_16x16x32_bf16 v[32:35], v[52:55], v[108:111], v[32:35]
    v_mfma_f32_16x16x32_bf16 v[36:39], v[56:59], v[108:111], v[36:39]
    v_mfma_f32_16x16x32_bf16 v[40:43], v[60:63], v[108:111], v[40:43]
    v_mfma_f32_16x16x32_bf16 v[44:47], v[64:67], v[108:111], v[44:47]
    v_mfma_f32_16x16x32_bf16 v[48:51], v[68:71], v[108:111], v[48:51]
    s_waitcnt lgkmcnt(0)
    ds_read_b64 v[108:109], v124 offset:36864
    ds_read_b64 v[110:111], v125 offset:36864
    ds_read_b64_tr_b16 v[52:53], v10 offset:47104
    ds_read_b64_tr_b16 v[54:55], v10 offset:49664
    ds_read_b64_tr_b16 v[56:57], v10 offset:47136
    ds_read_b64_tr_b16 v[58:59], v10 offset:49696
    ds_read_b64_tr_b16 v[60:61], v10 offset:47168
    ds_read_b64_tr_b16 v[62:63], v10 offset:49728
    ds_read_b64_tr_b16 v[64:65], v10 offset:47200
    ds_read_b64_tr_b16 v[66:67], v10 offset:49760
    ds_read_b64_tr_b16 v[68:69], v10 offset:47232
    ds_read_b64_tr_b16 v[70:71], v10 offset:49792
    v_mfma_f32_16x16x32_bf16 v[32:35], v[72:75], v[112:115], v[32:35]
    v_mfma_f32_16x16x32_bf16 v[36:39], v[76:79], v[112:115], v[36:39]
    v_mfma_f32_16x16x32_bf16 v[40:43], v[80:83], v[112:115], v[40:43]
    v_mfma_f32_16x16x32_bf16 v[44:47], v[84:87], v[112:115], v[44:47]
    v_mfma_f32_16x16x32_bf16 v[48:51], v[88:91], v[112:115], v[48:51]
    s_waitcnt lgkmcnt(0)
    ds_read_b64 v[112:113], v126 offset:36864
    ds_read_b64 v[114:115], v127 offset:36864
    ds_read_b64_tr_b16 v[72:73], v10 offset:52224
    ds_read_b64_tr_b16 v[74:75], v10 offset:54784
    ds_read_b64_tr_b16 v[76:77], v10 offset:52256
    ds_read_b64_tr_b16 v[78:79], v10 offset:54816
    ds_read_b64_tr_b16 v[80:81], v10 offset:52288
    ds_read_b64_tr_b16 v[82:83], v10 offset:54848
    ds_read_b64_tr_b16 v[84:85], v10 offset:52320
    ds_read_b64_tr_b16 v[86:87], v10 offset:54880
    ds_read_b64_tr_b16 v[88:89], v10 offset:52352
    ds_read_b64_tr_b16 v[90:91], v10 offset:54912
    v_mfma_f32_16x16x32_bf16 v[32:35], v[52:55], v[108:111], v[32:35]
    v_mfma_f32_16x16x32_bf16 v[36:39], v[56:59], v[108:111], v[36:39]
    v_mfma_f32_16x16x32_bf16 v[40:43], v[60:63], v[108:111], v[40:43]
    v_mfma_f32_16x16x32_bf16 v[44:47], v[64:67], v[108:111], v[44:47]
    v_mfma_f32_16x16x32_bf16 v[48:51], v[68:71], v[108:111], v[48:51]
    s_waitcnt lgkmcnt(0)
    s_waitcnt vmcnt(0)
    s_barrier
    ds_read_b64 v[108:109], v24 offset:0
    ds_read_b64 v[110:111], v25 offset:0
    ds_read_b64_tr_b16 v[52:53], v12 offset:0
    ds_read_b64_tr_b16 v[54:55], v12 offset:2560
    ds_read_b64_tr_b16 v[56:57], v12 offset:32
    ds_read_b64_tr_b16 v[58:59], v12 offset:2592
    ds_read_b64_tr_b16 v[60:61], v12 offset:64
    ds_read_b64_tr_b16 v[62:63], v12 offset:2624
    ds_read_b64_tr_b16 v[64:65], v12 offset:96
    ds_read_b64_tr_b16 v[66:67], v12 offset:2656
    ds_read_b64_tr_b16 v[68:69], v12 offset:128
    ds_read_b64_tr_b16 v[70:71], v12 offset:2688
    v_mfma_f32_16x16x32_bf16 v[32:35], v[72:75], v[112:115], v[32:35]
    v_mfma_f32_16x16x32_bf16 v[36:39], v[76:79], v[112:115], v[36:39]
    v_mfma_f32_16x16x32_bf16 v[40:43], v[80:83], v[112:115], v[40:43]
    v_mfma_f32_16x16x32_bf16 v[44:47], v[84:87], v[112:115], v[44:47]
    v_mfma_f32_16x16x32_bf16 v[48:51], v[88:91], v[112:115], v[48:51]
    s_waitcnt lgkmcnt(0)
    ds_read_b64 v[112:113], v26 offset:0
    ds_read_b64 v[114:115], v27 offset:0
    ds_read_b64_tr_b16 v[72:73], v12 offset:5120
    ds_read_b64_tr_b16 v[74:75], v12 offset:7680
    ds_read_b64_tr_b16 v[76:77], v12 offset:5152
    ds_read_b64_tr_b16 v[78:79], v12 offset:7712
    ds_read_b64_tr_b16 v[80:81], v12 offset:5184
    ds_read_b64_tr_b16 v[82:83], v12 offset:7744
    ds_read_b64_tr_b16 v[84:85], v12 offset:5216
    ds_read_b64_tr_b16 v[86:87], v12 offset:7776
    ds_read_b64_tr_b16 v[88:89], v12 offset:5248
    ds_read_b64_tr_b16 v[90:91], v12 offset:7808
    v_mfma_f32_16x16x32_bf16 v[32:35], v[52:55], v[108:111], v[32:35]
    v_mfma_f32_16x16x32_bf16 v[36:39], v[56:59], v[108:111], v[36:39]
    v_mfma_f32_16x16x32_bf16 v[40:43], v[60:63], v[108:111], v[40:43]
    v_mfma_f32_16x16x32_bf16 v[44:47], v[64:67], v[108:111], v[44:47]
    v_mfma_f32_16x16x32_bf16 v[48:51], v[68:71], v[108:111], v[48:51]
    s_waitcnt lgkmcnt(0)
    ds_read_b64 v[108:109], v28 offset:0
    ds_read_b64 v[110:111], v29 offset:0
    ds_read_b64_tr_b16 v[52:53], v12 offset:10240
    ds_read_b64_tr_b16 v[54:55], v12 offset:12800
    ds_read_b64_tr_b16 v[56:57], v12 offset:10272
    ds_read_b64_tr_b16 v[58:59], v12 offset:12832
    ds_read_b64_tr_b16 v[60:61], v12 offset:10304
    ds_read_b64_tr_b16 v[62:63], v12 offset:12864
    ds_read_b64_tr_b16 v[64:65], v12 offset:10336
    ds_read_b64_tr_b16 v[66:67], v12 offset:12896
    ds_read_b64_tr_b16 v[68:69], v12 offset:10368
    ds_read_b64_tr_b16 v[70:71], v12 offset:12928
    v_mfma_f32_16x16x32_bf16 v[32:35], v[72:75], v[112:115], v[32:35]
    v_mfma_f32_16x16x32_bf16 v[36:39], v[76:79], v[112:115], v[36:39]
    v_mfma_f32_16x16x32_bf16 v[40:43], v[80:83], v[112:115], v[40:43]
    v_mfma_f32_16x16x32_bf16 v[44:47], v[84:87], v[112:115], v[44:47]
    v_mfma_f32_16x16x32_bf16 v[48:51], v[88:91], v[112:115], v[48:51]
    s_waitcnt lgkmcnt(0)
    ds_read_b64 v[112:113], v30 offset:0
    ds_read_b64 v[114:115], v31 offset:0
    ds_read_b64_tr_b16 v[72:73], v12 offset:15360
    ds_read_b64_tr_b16 v[74:75], v12 offset:17920
    ds_read_b64_tr_b16 v[76:77], v12 offset:15392
    ds_read_b64_tr_b16 v[78:79], v12 offset:17952
    ds_read_b64_tr_b16 v[80:81], v12 offset:15424
    ds_read_b64_tr_b16 v[82:83], v12 offset:17984
    ds_read_b64_tr_b16 v[84:85], v12 offset:15456
    ds_read_b64_tr_b16 v[86:87], v12 offset:18016
    ds_read_b64_tr_b16 v[88:89], v12 offset:15488
    ds_read_b64_tr_b16 v[90:91], v12 offset:18048
    v_mfma_f32_16x16x32_bf16 v[32:35], v[52:55], v[108:111], v[32:35]
    v_mfma_f32_16x16x32_bf16 v[36:39], v[56:59], v[108:111], v[36:39]
    v_mfma_f32_16x16x32_bf16 v[40:43], v[60:63], v[108:111], v[40:43]
    v_mfma_f32_16x16x32_bf16 v[44:47], v[64:67], v[108:111], v[44:47]
    v_mfma_f32_16x16x32_bf16 v[48:51], v[68:71], v[108:111], v[48:51]
    s_waitcnt lgkmcnt(0)
    v_mfma_f32_16x16x32_bf16 v[32:35], v[72:75], v[112:115], v[32:35]
    v_mfma_f32_16x16x32_bf16 v[36:39], v[76:79], v[112:115], v[36:39]
    v_mfma_f32_16x16x32_bf16 v[40:43], v[80:83], v[112:115], v[40:43]
    v_mfma_f32_16x16x32_bf16 v[44:47], v[84:87], v[112:115], v[44:47]
    v_mfma_f32_16x16x32_bf16 v[48:51], v[88:91], v[112:115], v[48:51]
    s_nop 7
    s_nop 7
    v_cvt_pk_bf16_f32 v92, v32, v33
    v_cvt_pk_bf16_f32 v93, v34, v35
    v_lshlrev_b32 v116, 16, v92
    v_and_b32 v117, 0xffff0000, v92
    v_lshlrev_b32 v118, 16, v96
    v_and_b32 v119, 0xffff0000, v96
    v_pk_add_f32 v[116:117], v[116:117], v[118:119]
    v_cvt_pk_bf16_f32 v94, v116, v117
    v_lshlrev_b32 v116, 16, v93
    v_and_b32 v117, 0xffff0000, v93
    v_lshlrev_b32 v118, 16, v97
    v_and_b32 v119, 0xffff0000, v97
    v_pk_add_f32 v[116:117], v[116:117], v[118:119]
    v_cvt_pk_bf16_f32 v95, v116, v117
    buffer_store_dwordx2 v[94:95], v11, s[20:23], 0 offen offset:0
    s_nop 1
    v_cvt_pk_bf16_f32 v92, v36, v37
    v_cvt_pk_bf16_f32 v93, v38, v39
    v_lshlrev_b32 v116, 16, v92
    v_and_b32 v117, 0xffff0000, v92
    v_lshlrev_b32 v118, 16, v98
    v_and_b32 v119, 0xffff0000, v98
    v_pk_add_f32 v[116:117], v[116:117], v[118:119]
    v_cvt_pk_bf16_f32 v94, v116, v117
    v_lshlrev_b32 v116, 16, v93
    v_and_b32 v117, 0xffff0000, v93
    v_lshlrev_b32 v118, 16, v99
    v_and_b32 v119, 0xffff0000, v99
    v_pk_add_f32 v[116:117], v[116:117], v[118:119]
    v_cvt_pk_bf16_f32 v95, v116, v117
    buffer_store_dwordx2 v[94:95], v11, s[20:23], 0 offen offset:32
    s_nop 1
    v_cvt_pk_bf16_f32 v92, v40, v41
    v_cvt_pk_bf16_f32 v93, v42, v43
    v_lshlrev_b32 v116, 16, v92
    v_and_b32 v117, 0xffff0000, v92
    v_lshlrev_b32 v118, 16, v100
    v_and_b32 v119, 0xffff0000, v100
    v_pk_add_f32 v[116:117], v[116:117], v[118:119]
    v_cvt_pk_bf16_f32 v94, v116, v117
    v_lshlrev_b32 v116, 16, v93
    v_and_b32 v117, 0xffff0000, v93
    v_lshlrev_b32 v118, 16, v101
    v_and_b32 v119, 0xffff0000, v101
    v_pk_add_f32 v[116:117], v[116:117], v[118:119]
    v_cvt_pk_bf16_f32 v95, v116, v117
    buffer_store_dwordx2 v[94:95], v11, s[20:23], 0 offen offset:64
    s_nop 1
    v_cvt_pk_bf16_f32 v92, v44, v45
    v_cvt_pk_bf16_f32 v93, v46, v47
    v_lshlrev_b32 v116, 16, v92
    v_and_b32 v117, 0xffff0000, v92
    v_lshlrev_b32 v118, 16, v102
    v_and_b32 v119, 0xffff0000, v102
    v_pk_add_f32 v[116:117], v[116:117], v[118:119]
    v_cvt_pk_bf16_f32 v94, v116, v117
    v_lshlrev_b32 v116, 16, v93
    v_and_b32 v117, 0xffff0000, v93
    v_lshlrev_b32 v118, 16, v103
    v_and_b32 v119, 0xffff0000, v103
    v_pk_add_f32 v[116:117], v[116:117], v[118:119]
    v_cvt_pk_bf16_f32 v95, v116, v117
    buffer_store_dwordx2 v[94:95], v11, s[20:23], 0 offen offset:96
    s_nop 1
    v_cvt_pk_bf16_f32 v92, v48, v49
    v_cvt_pk_bf16_f32 v93, v50, v51
    v_lshlrev_b32 v116, 16, v92
    v_and_b32 v117, 0xffff0000, v92
    v_lshlrev_b32 v118, 16, v104
    v_and_b32 v119, 0xffff0000, v104
    v_pk_add_f32 v[116:117], v[116:117], v[118:119]
    v_cvt_pk_bf16_f32 v94, v116, v117
    v_lshlrev_b32 v116, 16, v93
    v_and_b32 v117, 0xffff0000, v93
    v_lshlrev_b32 v118, 16, v105
    v_and_b32 v119, 0xffff0000, v105
    v_pk_add_f32 v[116:117], v[116:117], v[118:119]
    v_cvt_pk_bf16_f32 v95, v116, v117
    buffer_store_dwordx2 v[94:95], v11, s[20:23], 0 offen offset:128
    s_nop 1
L_hh_k2_kernel_end:
    s_endpgm

.text
.globl hh_k3_kernel
.p2align 8
.type hh_k3_kernel,@function
hh_k3_kernel:
    s_cmp_ge_u32 s2, 256
    s_cbranch_scc1 L_k3_end
    s_load_dwordx2 s[6:7], s[0:1], 40
    s_load_dwordx2 s[40:41], s[0:1], 72
    s_and_b32 s28, s2, 7
    s_lshl_b32 s28, s28, 2
    s_bfe_u32 s29, s2, 0x20003
    s_add_u32 s28, s28, s29
    s_lshr_b32 s29, s2, 5
    v_and_b32 v1, 63, v0
    v_lshrrev_b32 v2, 4, v1
    v_and_b32 v3, 15, v1
    v_lshrrev_b32 v4, 6, v0
    s_nop 0
    v_readfirstlane_b32 s30, v4
    s_waitcnt lgkmcnt(0)
    s_add_u32 s8, s40, 0xd00000
    s_addc_u32 s9, s41, 0
    s_mov_b32 s10, 0x280000
    s_mov_b32 s11, 0x00020000
    s_mov_b32 s16, s6
    s_mov_b32 s17, s7
    s_mov_b32 s18, 0x21c000
    s_mov_b32 s19, 0x00020000
    s_add_u32 s20, s40, 0x1000000
    s_addc_u32 s21, s41, 0
    s_mov_b32 s22, 0x6c0000
    s_mov_b32 s23, 0x00020000
    s_lshl_b32 s42, s28, 6
    v_lshrrev_b32 v5, 3, v0
    v_and_b32 v6, 7, v0
    v_add_u32 v7, s42, v5
    v_mul_u32_u24 v7, 1280, v7
    v_lshl_add_u32 v7, v6, 4, v7
    buffer_load_dwordx4 v[16:19], v7, s[8:11], 0 offen offset:0
    buffer_load_dwordx4 v[20:23], v7, s[8:11], 0 offen offset:128
    buffer_load_dwordx4 v[24:27], v7, s[8:11], 0 offen offset:256
    buffer_load_dwordx4 v[28:31], v7, s[8:11], 0 offen offset:384
    buffer_load_dwordx4 v[32:35], v7, s[8:11], 0 offen offset:512
    buffer_load_dwordx4 v[36:39], v7, s[8:11], 0 offen offset:640
    buffer_load_dwordx4 v[40:43], v7, s[8:11], 0 offen offset:768
    buffer_load_dwordx4 v[44:47], v7, s[8:11], 0 offen offset:896
    buffer_load_dwordx4 v[48:51], v7, s[8:11], 0 offen offset:1024
    buffer_load_dwordx4 v[52:55], v7, s[8:11], 0 offen offset:1152
    s_mul_i32 s35, s30, 1920
    s_mul_i32 s33, s30, 120
    s_mul_i32 s34, s29, 432
    s_mov_b32 s36, -1
    s_mov_b32 s37, 0x00ffffff
    v_add_u32 v12, s33, v1
    v_mul_u32_u24 v13, 2185, v12
    v_lshrrev_b32 v13, 16, v13
    v_mul_u32_u24 v14, 30, v13
    v_sub_u32 v14, v12, v14
    v_mul_u32_u24 v8, 3456, v13
    v_lshl_add_u32 v8, v14, 4, v8
    v_add_u32 v8, s34, v8
    v_add_u32 v12, s33, v1
    v_add_u32 v12, 64, v12
    v_mul_u32_u24 v13, 2185, v12
    v_lshrrev_b32 v13, 16, v13
    v_mul_u32_u24 v14, 30, v13
    v_sub_u32 v14, v12, v14
    v_mul_u32_u24 v9, 3456, v13
    v_lshl_add_u32 v9, v14, 4, v9
    v_add_u32 v9, s34, v9
    s_mov_b32 s33, 0x0
    s_add_u32 s34, s35, 0x14800
    s_mov_b32 m0, s34
    s_nop 0
    buffer_load_dwordx4 v8, s[16:19], s33 offen lds
    s_add_u32 s34, s34, 1024
    s_mov_b32 m0, s34
    s_mov_b64 exec, s[36:37]
    buffer_load_dwordx4 v9, s[16:19], s33 offen lds
    s_mov_b64 exec, -1
    s_mov_b32 s33, 0x1b000
    s_add_u32 s34, s35, 0x18400
    s_mov_b32 m0, s34
    s_nop 0
    buffer_load_dwordx4 v8, s[16:19], s33 offen lds
    s_add_u32 s34, s34, 1024
    s_mov_b32 m0, s34
    s_mov_b64 exec, s[36:37]
    buffer_load_dwordx4 v9, s[16:19], s33 offen lds
    s_mov_b64 exec, -1
    s_mov_b32 s33, 0x36000
    s_add_u32 s34, s35, 0x1c000
    s_mov_b32 m0, s34
    s_nop 0
    buffer_load_dwordx4 v8, s[16:19], s33 offen lds
    s_add_u32 s34, s34, 1024
    s_mov_b32 m0, s34
    s_mov_b64 exec, s[36:37]
    buffer_load_dwordx4 v9, s[16:19], s33 offen lds
    s_mov_b64 exec, -1
    s_mov_b32 s33, 0x51000
    s_add_u32 s34, s35, 0x1fc00
    s_mov_b32 m0, s34
    s_nop 0
    buffer_load_dwordx4 v8, s[16:19], s33 offen lds
    s_add_u32 s34, s34, 1024
    s_mov_b32 m0, s34
    s_mov_b64 exec, s[36:37]
    buffer_load_dwordx4 v9, s[16:19], s33 offen lds
    s_mov_b64 exec, -1
    s_mov_b32 s33, 0x6c000
    s_add_u32 s34, s35, 0x23800
    s_mov_b32 m0, s34
    s_nop 0
    buffer_load_dwordx4 v8, s[16:19], s33 offen lds
    s_add_u32 s34, s34, 1024
    s_mov_b32 m0, s34
    s_mov_b64 exec, s[36:37]
    buffer_load_dwordx4 v9, s[16:19], s33 offen lds
    s_mov_b64 exec, -1
    s_waitcnt vmcnt(10)
    v_mov_b32 v56, 0x3f803f80
    v_mov_b32 v57, 0
    v_mov_b32 v58, 0
    v_mov_b32 v59, 0
    v_mov_b32 v60, 0
    v_dot2_f32_bf16 v57, v16, v56, v57
    v_lshlrev_b32 v160, 16, v16
    v_and_b32 v161, 0xffff0000, v16
    v_dot2_f32_bf16 v58, v17, v56, v58
    v_lshlrev_b32 v162, 16, v17
    v_and_b32 v163, 0xffff0000, v17
    v_dot2_f32_bf16 v59, v18, v56, v59
    v_lshlrev_b32 v164, 16, v18
    v_and_b32 v165, 0xffff0000, v18
    v_dot2_f32_bf16 v60, v19, v56, v60
    v_lshlrev_b32 v166, 16, v19
    v_and_b32 v167, 0xffff0000, v19
    v_dot2_f32_bf16 v57, v20, v56, v57
    v_lshlrev_b32 v168, 16, v20
    v_and_b32 v169, 0xffff0000, v20
    v_dot2_f32_bf16 v58, v21, v56, v58
    v_lshlrev_b32 v170, 16, v21
    v_and_b32 v171, 0xffff0000, v21
    v_dot2_f32_bf16 v59, v22, v56, v59
    v_lshlrev_b32 v172, 16, v22
    v_and_b32 v173, 0xffff0000, v22
    v_dot2_f32_bf16 v60, v23, v56, v60
    v_lshlrev_b32 v174, 16, v23
    v_and_b32 v175, 0xffff0000, v23
    v_dot2_f32_bf16 v57, v24, v56, v57
    v_lshlrev_b32 v176, 16, v24
    v_and_b32 v177, 0xffff0000, v24
    v_dot2_f32_bf16 v58, v25, v56, v58
    v_lshlrev_b32 v178, 16, v25
    v_and_b32 v179, 0xffff0000, v25
    v_dot2_f32_bf16 v59, v26, v56, v59
    v_lshlrev_b32 v180, 16, v26
    v_and_b32 v181, 0xffff0000, v26
    v_dot2_f32_bf16 v60, v27, v56, v60
    v_lshlrev_b32 v182, 16, v27
    v_and_b32 v183, 0xffff0000, v27
    v_dot2_f32_bf16 v57, v28, v56, v57
    v_lshlrev_b32 v184, 16, v28
    v_and_b32 v185, 0xffff0000, v28
    v_dot2_f32_bf16 v58, v29, v56, v58
    v_lshlrev_b32 v186, 16, v29
    v_and_b32 v187, 0xffff0000, v29
    v_dot2_f32_bf16 v59, v30, v56, v59
    v_lshlrev_b32 v188, 16, v30
    v_and_b32 v189, 0xffff0000, v30
    v_dot2_f32_bf16 v60, v31, v56, v60
    v_lshlrev_b32 v190, 16, v31
    v_and_b32 v191, 0xffff0000, v31
    v_dot2_f32_bf16 v57, v32, v56, v57
    v_lshlrev_b32 v192, 16, v32
    v_and_b32 v193, 0xffff0000, v32
    v_dot2_f32_bf16 v58, v33, v56, v58
    v_lshlrev_b32 v194, 16, v33
    v_and_b32 v195, 0xffff0000, v33
    v_dot2_f32_bf16 v59, v34, v56, v59
    v_lshlrev_b32 v196, 16, v34
    v_and_b32 v197, 0xffff0000, v34
    v_dot2_f32_bf16 v60, v35, v56, v60
    v_lshlrev_b32 v198, 16, v35
    v_and_b32 v199, 0xffff0000, v35
    v_dot2_f32_bf16 v57, v36, v56, v57
    v_lshlrev_b32 v200, 16, v36
    v_and_b32 v201, 0xffff0000, v36
    v_dot2_f32_bf16 v58, v37, v56, v58
    v_lshlrev_b32 v202, 16, v37
    v_and_b32 v203, 0xffff0000, v37
    v_dot2_f32_bf16 v59, v38, v56, v59
    v_lshlrev_b32 v204, 16, v38
    v_and_b32 v205, 0xffff0000, v38
    v_dot2_f32_bf16 v60, v39, v56, v60
    v_lshlrev_b32 v206, 16, v39
    v_and_b32 v207, 0xffff0000, v39
    v_dot2_f32_bf16 v57, v40, v56, v57
    v_lshlrev_b32 v208, 16, v40
    v_and_b32 v209, 0xffff0000, v40
    v_dot2_f32_bf16 v58, v41, v56, v58
    v_lshlrev_b32 v210, 16, v41
    v_and_b32 v211, 0xffff0000, v41
    v_dot2_f32_bf16 v59, v42, v56, v59
    v_lshlrev_b32 v212, 16, v42
    v_and_b32 v213, 0xffff0000, v42
    v_dot2_f32_bf16 v60, v43, v56, v60
    v_lshlrev_b32 v214, 16, v43
    v_and_b32 v215, 0xffff0000, v43
    v_dot2_f32_bf16 v57, v44, v56, v57
    v_lshlrev_b32 v216, 16, v44
    v_and_b32 v217, 0xffff0000, v44
    v_dot2_f32_bf16 v58, v45, v56, v58
    v_lshlrev_b32 v218, 16, v45
    v_and_b32 v219, 0xffff0000, v45
    v_dot2_f32_bf16 v59, v46, v56, v59
    v_lshlrev_b32 v220, 16, v46
    v_and_b32 v221, 0xffff0000, v46
    v_dot2_f32_bf16 v60, v47, v56, v60
    v_lshlrev_b32 v222, 16, v47
    v_and_b32 v223, 0xffff0000, v47
    v_dot2_f32_bf16 v57, v48, v56, v57
    v_lshlrev_b32 v224, 16, v48
    v_and_b32 v225, 0xffff0000, v48
    v_dot2_f32_bf16 v58, v49, v56, v58
    v_lshlrev_b32 v226, 16, v49
    v_and_b32 v227, 0xffff0000, v49
    v_dot2_f32_bf16 v59, v50, v56, v59
    v_lshlrev_b32 v228, 16, v50
    v_and_b32 v229, 0xffff0000, v50
    v_dot2_f32_bf16 v60, v51, v56, v60
    v_lshlrev_b32 v230, 16, v51
    v_and_b32 v231, 0xffff0000, v51
    v_dot2_f32_bf16 v57, v52, v56, v57
    v_lshlrev_b32 v232, 16, v52
    v_and_b32 v233, 0xffff0000, v52
    v_dot2_f32_bf16 v58, v53, v56, v58
    v_lshlrev_b32 v234, 16, v53
    v_and_b32 v235, 0xffff0000, v53
    v_dot2_f32_bf16 v59, v54, v56, v59
    v_lshlrev_b32 v236, 16, v54
    v_and_b32 v237, 0xffff0000, v54
    v_dot2_f32_bf16 v60, v55, v56, v60
    v_lshlrev_b32 v238, 16, v55
    v_and_b32 v239, 0xffff0000, v55
    v_add_f32 v57, v57, v58
    v_add_f32 v59, v59, v60
    v_add_f32 v57, v57, v59
    s_nop 1
    v_add_f32_dpp v61, v57, v57 quad_perm:[1,0,3,2] row_mask:0xf bank_mask:0xf
    s_nop 1
    v_add_f32_dpp v57, v61, v61 quad_perm:[2,3,0,1] row_mask:0xf bank_mask:0xf
    s_nop 1
    v_add_f32_dpp v61, v57, v57 row_half_mirror row_mask:0xf bank_mask:0xf
    v_mov_b32 v57, v61
    v_mul_f32 v57, 0x3acccccd, v57
    v_mov_b32 v62, v57
    v_mov_b32 v63, v57
    v_mov_b32 v64, 0
    v_mov_b32 v65, 0
    v_mov_b32 v66, 0
    v_mov_b32 v67, 0
    v_mov_b32 v68, 0
    v_mov_b32 v69, 0
    v_mov_b32 v70, 0
    v_mov_b32 v71, 0
    v_pk_add_f32 v[72:73], v[160:161], v[62:63] neg_lo:[0,1] neg_hi:[0,1]
    v_pk_fma_f32 v[64:65], v[72:73], v[72:73], v[64:65]
    v_pk_add_f32 v[74:75], v[162:163], v[62:63] neg_lo:[0,1] neg_hi:[0,1]
    v_pk_fma_f32 v[66:67], v[74:75], v[74:75], v[66:67]
    v_pk_add_f32 v[76:77], v[164:165], v[62:63] neg_lo:[0,1] neg_hi:[0,1]
    v_pk_fma_f32 v[68:69], v[76:77], v[76:77], v[68:69]
    v_pk_add_f32 v[78:79], v[166:167], v[62:63] neg_lo:[0,1] neg_hi:[0,1]
    v_pk_fma_f32 v[70:71], v[78:79], v[78:79], v[70:71]
    v_pk_add_f32 v[72:73], v[168:169], v[62:63] neg_lo:[0,1] neg_hi:[0,1]
    v_pk_fma_f32 v[64:65], v[72:73], v[72:73], v[64:65]
    v_pk_add_f32 v[74:75], v[170:171], v[62:63] neg_lo:[0,1] neg_hi:[0,1]
    v_pk_fma_f32 v[66:67], v[74:75], v[74:75], v[66:67]
    v_pk_add_f32 v[76:77], v[172:173], v[62:63] neg_lo:[0,1] neg_hi:[0,1]
    v_pk_fma_f32 v[68:69], v[76:77], v[76:77], v[68:69]
    v_pk_add_f32 v[78:79], v[174:175], v[62:63] neg_lo:[0,1] neg_hi:[0,1]
    v_pk_fma_f32 v[70:71], v[78:79], v[78:79], v[70:71]
    v_pk_add_f32 v[72:73], v[176:177], v[62:63] neg_lo:[0,1] neg_hi:[0,1]
    v_pk_fma_f32 v[64:65], v[72:73], v[72:73], v[64:65]
    v_pk_add_f32 v[74:75], v[178:179], v[62:63] neg_lo:[0,1] neg_hi:[0,1]
    v_pk_fma_f32 v[66:67], v[74:75], v[74:75], v[66:67]
    v_pk_add_f32 v[76:77], v[180:181], v[62:63] neg_lo:[0,1] neg_hi:[0,1]
    v_pk_fma_f32 v[68:69], v[76:77], v[76:77], v[68:69]
    v_pk_add_f32 v[78:79], v[182:183], v[62:63] neg_lo:[0,1] neg_hi:[0,1]
    v_pk_fma_f32 v[70:71], v[78:79], v[78:79], v[70:71]
    v_pk_add_f32 v[72:73], v[184:185], v[62:63] neg_lo:[0,1] neg_hi:[0,1]
    v_pk_fma_f32 v[64:65], v[72:73], v[72:73], v[64:65]
    v_pk_add_f32 v[74:75], v[186:187], v[62:63] neg_lo:[0,1] neg_hi:[0,1]
    v_pk_fma_f32 v[66:67], v[74:75], v[74:75], v[66:67]
    v_pk_add_f32 v[76:77], v[188:189], v[62:63] neg_lo:[0,1] neg_hi:[0,1]
    v_pk_fma_f32 v[68:69], v[76:77], v[76:77], v[68:69]
    v_pk_add_f32 v[78:79], v[190:191], v[62:63] neg_lo:[0,1] neg_hi:[0,1]
    v_pk_fma_f32 v[70:71], v[78:79], v[78:79], v[70:71]
    v_pk_add_f32 v[72:73], v[192:193], v[62:63] neg_lo:[0,1] neg_hi:[0,1]
    v_pk_fma_f32 v[64:65], v[72:73], v[72:73], v[64:65]
    v_pk_add_f32 v[74:75], v[194:195], v[62:63] neg_lo:[0,1] neg_hi:[0,1]
    v_pk_fma_f32 v[66:67], v[74:75], v[74:75], v[66:67]
    v_pk_add_f32 v[76:77], v[196:197], v[62:63] neg_lo:[0,1] neg_hi:[0,1]
    v_pk_fma_f32 v[68:69], v[76:77], v[76:77], v[68:69]
    v_pk_add_f32 v[78:79], v[198:199], v[62:63] neg_lo:[0,1] neg_hi:[0,1]
    v_pk_fma_f32 v[70:71], v[78:79], v[78:79], v[70:71]
    v_pk_add_f32 v[72:73], v[200:201], v[62:63] neg_lo:[0,1] neg_hi:[0,1]
    v_pk_fma_f32 v[64:65], v[72:73], v[72:73], v[64:65]
    v_pk_add_f32 v[74:75], v[202:203], v[62:63] neg_lo:[0,1] neg_hi:[0,1]
    v_pk_fma_f32 v[66:67], v[74:75], v[74:75], v[66:67]
    v_pk_add_f32 v[76:77], v[204:205], v[62:63] neg_lo:[0,1] neg_hi:[0,1]
    v_pk_fma_f32 v[68:69], v[76:77], v[76:77], v[68:69]
    v_pk_add_f32 v[78:79], v[206:207], v[62:63] neg_lo:[0,1] neg_hi:[0,1]
    v_pk_fma_f32 v[70:71], v[78:79], v[78:79], v[70:71]
    v_pk_add_f32 v[72:73], v[208:209], v[62:63] neg_lo:[0,1] neg_hi:[0,1]
    v_pk_fma_f32 v[64:65], v[72:73], v[72:73], v[64:65]
    v_pk_add_f32 v[74:75], v[210:211], v[62:63] neg_lo:[0,1] neg_hi:[0,1]
    v_pk_fma_f32 v[66:67], v[74:75], v[74:75], v[66:67]
    v_pk_add_f32 v[76:77], v[212:213], v[62:63] neg_lo:[0,1] neg_hi:[0,1]
    v_pk_fma_f32 v[68:69], v[76:77], v[76:77], v[68:69]
    v_pk_add_f32 v[78:79], v[214:215], v[62:63] neg_lo:[0,1] neg_hi:[0,1]
    v_pk_fma_f32 v[70:71], v[78:79], v[78:79], v[70:71]
    v_pk_add_f32 v[72:73], v[216:217], v[62:63] neg_lo:[0,1] neg_hi:[0,1]
    v_pk_fma_f32 v[64:65], v[72:73], v[72:73], v[64:65]
    v_pk_add_f32 v[74:75], v[218:219], v[62:63] neg_lo:[0,1] neg_hi:[0,1]
    v_pk_fma_f32 v[66:67], v[74:75], v[74:75], v[66:67]
    v_pk_add_f32 v[76:77], v[220:221], v[62:63] neg_lo:[0,1] neg_hi:[0,1]
    v_pk_fma_f32 v[68:69], v[76:77], v[76:77], v[68:69]
    v_pk_add_f32 v[78:79], v[222:223], v[62:63] neg_lo:[0,1] neg_hi:[0,1]
    v_pk_fma_f32 v[70:71], v[78:79], v[78:79], v[70:71]
    v_pk_add_f32 v[72:73], v[224:225], v[62:63] neg_lo:[0,1] neg_hi:[0,1]
    v_pk_fma_f32 v[64:65], v[72:73], v[72:73], v[64:65]
    v_pk_add_f32 v[74:75], v[226:227], v[62:63] neg_lo:[0,1] neg_hi:[0,1]
    v_pk_fma_f32 v[66:67], v[74:75], v[74:75], v[66:67]
    v_pk_add_f32 v[76:77], v[228:229], v[62:63] neg_lo:[0,1] neg_hi:[0,1]
    v_pk_fma_f32 v[68:69], v[76:77], v[76:77], v[68:69]
    v_pk_add_f32 v[78:79], v[230:231], v[62:63] neg_lo:[0,1] neg_hi:[0,1]
    v_pk_fma_f32 v[70:71], v[78:79], v[78:79], v[70:71]
    v_pk_add_f32 v[72:73], v[232:233], v[62:63] neg_lo:[0,1] neg_hi:[0,1]
    v_pk_fma_f32 v[64:65], v[72:73], v[72:73], v[64:65]
    v_pk_add_f32 v[74:75], v[234:235], v[62:63] neg_lo:[0,1] neg_hi:[0,1]
    v_pk_fma_f32 v[66:67], v[74:75], v[74:75], v[66:67]
    v_pk_add_f32 v[76:77], v[236:237], v[62:63] neg_lo:[0,1] neg_hi:[0,1]
    v_pk_fma_f32 v[68:69], v[76:77], v[76:77], v[68:69]
    v_pk_add_f32 v[78:79], v[238:239], v[62:63] neg_lo:[0,1] neg_hi:[0,1]
    v_pk_fma_f32 v[70:71], v[78:79], v[78:79], v[70:71]
    v_pk_add_f32 v[64:65], v[64:65], v[66:67]
    v_pk_add_f32 v[68:69], v[68:69], v[70:71]
    v_pk_add_f32 v[64:65], v[64:65], v[68:69]
    v_add_f32 v60, v64, v65
    s_nop 1
    v_add_f32_dpp v61, v60, v60 quad_perm:[1,0,3,2] row_mask:0xf bank_mask:0xf
    s_nop 1
    v_add_f32_dpp v60, v61, v61 quad_perm:[2,3,0,1] row_mask:0xf bank_mask:0xf
    s_nop 1
    v_add_f32_dpp v61, v60, v60 row_half_mirror row_mask:0xf bank_mask:0xf
    v_mov_b32 v60, v61
    v_mul_f32 v60, 0x3acccccd, v60
    v_cvt_pk_bf16_f32 v61, v57, v60
    v_lshlrev_b32 v62, 16, v61
    v_and_b32 v63, 0xffff0000, v61
    v_add_f32 v63, 0x3727c5ac, v63
    v_cvt_pk_bf16_f32 v63, v63, v63
    v_and_b32 v63, 0xffff0000, v63
    v_sqrt_f32 v63, v63
    s_nop 0
    v_cvt_pk_bf16_f32 v63, v63, v63
    v_and_b32 v63, 0xffff0000, v63
    v_rcp_f32 v66, v63
    s_nop 0
    v_mov_b32 v67, v66
    v_mov_b32 v63, v62
    v_mul_u32_u24 v68, 1312, v5
    v_lshrrev_b32 v69, 2, v6
    v_lshl_add_u32 v68, v69, 6, v68
    v_and_b32 v69, 1, v6
    v_lshl_add_u32 v68, v69, 5, v68
    v_bfe_u32 v69, v6, 1, 1
    v_lshl_add_u32 v68, v69, 3, v68
    v_pk_add_f32 v[72:73], v[160:161], v[62:63] neg_lo:[0,1] neg_hi:[0,1]
    v_pk_add_f32 v[74:75], v[162:163], v[62:63] neg_lo:[0,1] neg_hi:[0,1]
    v_pk_add_f32 v[76:77], v[164:165], v[62:63] neg_lo:[0,1] neg_hi:[0,1]
    v_pk_add_f32 v[78:79], v[166:167], v[62:63] neg_lo:[0,1] neg_hi:[0,1]
    v_cvt_pk_bf16_f32 v80, v72, v73
    v_cvt_pk_bf16_f32 v81, v74, v75
    v_cvt_pk_bf16_f32 v82, v76, v77
    v_cvt_pk_bf16_f32 v83, v78, v79
    v_lshlrev_b32 v72, 16, v80
    v_and_b32 v73, 0xffff0000, v80
    v_lshlrev_b32 v74, 16, v81
    v_and_b32 v75, 0xffff0000, v81
    v_lshlrev_b32 v76, 16, v82
    v_and_b32 v77, 0xffff0000, v82
    v_lshlrev_b32 v78, 16, v83
    v_and_b32 v79, 0xffff0000, v83
    v_pk_mul_f32 v[72:73], v[72:73], v[66:67]
    v_pk_mul_f32 v[74:75], v[74:75], v[66:67]
    v_pk_mul_f32 v[76:77], v[76:77], v[66:67]
    v_pk_mul_f32 v[78:79], v[78:79], v[66:67]
    v_cvt_pk_bf16_f32 v84, v72, v73
    v_cvt_pk_bf16_f32 v85, v74, v75
    v_cvt_pk_bf16_f32 v86, v76, v77
    v_cvt_pk_bf16_f32 v87, v78, v79
    ds_write_b64 v68, v[84:85] offset:0
    ds_write_b64 v68, v[86:87] offset:16
    v_pk_add_f32 v[72:73], v[168:169], v[62:63] neg_lo:[0,1] neg_hi:[0,1]
    v_pk_add_f32 v[74:75], v[170:171], v[62:63] neg_lo:[0,1] neg_hi:[0,1]
    v_pk_add_f32 v[76:77], v[172:173], v[62:63] neg_lo:[0,1] neg_hi:[0,1]
    v_pk_add_f32 v[78:79], v[174:175], v[62:63] neg_lo:[0,1] neg_hi:[0,1]
    v_cvt_pk_bf16_f32 v80, v72, v73
    v_cvt_pk_bf16_f32 v81, v74, v75
    v_cvt_pk_bf16_f32 v82, v76, v77
    v_cvt_pk_bf16_f32 v83, v78, v79
    v_lshlrev_b32 v72, 16, v80
    v_and_b32 v73, 0xffff0000, v80
    v_lshlrev_b32 v74, 16, v81
    v_and_b32 v75, 0xffff0000, v81
    v_lshlrev_b32 v76, 16, v82
    v_and_b32 v77, 0xffff0000, v82
    v_lshlrev_b32 v78, 16, v83
    v_and_b32 v79, 0xffff0000, v83
    v_pk_mul_f32 v[72:73], v[72:73], v[66:67]
    v_pk_mul_f32 v[74:75], v[74:75], v[66:67]
    v_pk_mul_f32 v[76:77], v[76:77], v[66:67]
    v_pk_mul_f32 v[78:79], v[78:79], v[66:67]
    v_cvt_pk_bf16_f32 v84, v72, v73
    v_cvt_pk_bf16_f32 v85, v74, v75
    v_cvt_pk_bf16_f32 v86, v76, v77
    v_cvt_pk_bf16_f32 v87, v78, v79
    ds_write_b64 v68, v[84:85] offset:128
    ds_write_b64 v68, v[86:87] offset:144
    v_pk_add_f32 v[72:73], v[176:177], v[62:63] neg_lo:[0,1] neg_hi:[0,1]
    v_pk_add_f32 v[74:75], v[178:179], v[62:63] neg_lo:[0,1] neg_hi:[0,1]
    v_pk_add_f32 v[76:77], v[180:181], v[62:63] neg_lo:[0,1] neg_hi:[0,1]
    v_pk_add_f32 v[78:79], v[182:183], v[62:63] neg_lo:[0,1] neg_hi:[0,1]
    v_cvt_pk_bf16_f32 v80, v72, v73
    v_cvt_pk_bf16_f32 v81, v74, v75
    v_cvt_pk_bf16_f32 v82, v76, v77
    v_cvt_pk_bf16_f32 v83, v78, v79
    v_lshlrev_b32 v72, 16, v80
    v_and_b32 v73, 0xffff0000, v80
    v_lshlrev_b32 v74, 16, v81
    v_and_b32 v75, 0xffff0000, v81
    v_lshlrev_b32 v76, 16, v82
    v_and_b32 v77, 0xffff0000, v82
    v_lshlrev_b32 v78, 16, v83
    v_and_b32 v79, 0xffff0000, v83
    v_pk_mul_f32 v[72:73], v[72:73], v[66:67]
    v_pk_mul_f32 v[74:75], v[74:75], v[66:67]
    v_pk_mul_f32 v[76:77], v[76:77], v[66:67]
    v_pk_mul_f32 v[78:79], v[78:79], v[66:67]
    v_cvt_pk_bf16_f32 v84, v72, v73
    v_cvt_pk_bf16_f32 v85, v74, v75
    v_cvt_pk_bf16_f32 v86, v76, v77
    v_cvt_pk_bf16_f32 v87, v78, v79
    ds_write_b64 v68, v[84:85] offset:256
    ds_write_b64 v68, v[86:87] offset:272
    v_pk_add_f32 v[72:73], v[184:185], v[62:63] neg_lo:[0,1] neg_hi:[0,1]
    v_pk_add_f32 v[74:75], v[186:187], v[62:63] neg_lo:[0,1] neg_hi:[0,1]
    v_pk_add_f32 v[76:77], v[188:189], v[62:63] neg_lo:[0,1] neg_hi:[0,1]
    v_pk_add_f32 v[78:79], v[190:191], v[62:63] neg_lo:[0,1] neg_hi:[0,1]
    v_cvt_pk_bf16_f32 v80, v72, v73
    v_cvt_pk_bf16_f32 v81, v74, v75
    v_cvt_pk_bf16_f32 v82, v76, v77
    v_cvt_pk_bf16_f32 v83, v78, v79
    v_lshlrev_b32 v72, 16, v80
    v_and_b32 v73, 0xffff0000, v80
    v_lshlrev_b32 v74, 16, v81
    v_and_b32 v75, 0xffff0000, v81
    v_lshlrev_b32 v76, 16, v82
    v_and_b32 v77, 0xffff0000, v82
    v_lshlrev_b32 v78, 16, v83
    v_and_b32 v79, 0xffff0000, v83
    v_pk_mul_f32 v[72:73], v[72:73], v[66:67]
    v_pk_mul_f32 v[74:75], v[74:75], v[66:67]
    v_pk_mul_f32 v[76:77], v[76:77], v[66:67]
    v_pk_mul_f32 v[78:79], v[78:79], v[66:67]
    v_cvt_pk_bf16_f32 v84, v72, v73
    v_cvt_pk_bf16_f32 v85, v74, v75
    v_cvt_pk_bf16_f32 v86, v76, v77
    v_cvt_pk_bf16_f32 v87, v78, v79
    ds_write_b64 v68, v[84:85] offset:384
    ds_write_b64 v68, v[86:87] offset:400
    v_pk_add_f32 v[72:73], v[192:193], v[62:63] neg_lo:[0,1] neg_hi:[0,1]
    v_pk_add_f32 v[74:75], v[194:195], v[62:63] neg_lo:[0,1] neg_hi:[0,1]
    v_pk_add_f32 v[76:77], v[196:197], v[62:63] neg_lo:[0,1] neg_hi:[0,1]
    v_pk_add_f32 v[78:79], v[198:199], v[62:63] neg_lo:[0,1] neg_hi:[0,1]
    v_cvt_pk_bf16_f32 v80, v72, v73
    v_cvt_pk_bf16_f32 v81, v74, v75
    v_cvt_pk_bf16_f32 v82, v76, v77
    v_cvt_pk_bf16_f32 v83, v78, v79
    v_lshlrev_b32 v72, 16, v80
    v_and_b32 v73, 0xffff0000, v80
    v_lshlrev_b32 v74, 16, v81
    v_and_b32 v75, 0xffff0000, v81
    v_lshlrev_b32 v76, 16, v82
    v_and_b32 v77, 0xffff0000, v82
    v_lshlrev_b32 v78, 16, v83
    v_and_b32 v79, 0xffff0000, v83
    v_pk_mul_f32 v[72:73], v[72:73], v[66:67]
    v_pk_mul_f32 v[74:75], v[74:75], v[66:67]
    v_pk_mul_f32 v[76:77], v[76:77], v[66:67]
    v_pk_mul_f32 v[78:79], v[78:79], v[66:67]
    v_cvt_pk_bf16_f32 v84, v72, v73
    v_cvt_pk_bf16_f32 v85, v74, v75
    v_cvt_pk_bf16_f32 v86, v76, v77
    v_cvt_pk_bf16_f32 v87, v78, v79
    ds_write_b64 v68, v[84:85] offset:512
    ds_write_b64 v68, v[86:87] offset:528
    v_pk_add_f32 v[72:73], v[200:201], v[62:63] neg_lo:[0,1] neg_hi:[0,1]
    v_pk_add_f32 v[74:75], v[202:203], v[62:63] neg_lo:[0,1] neg_hi:[0,1]
    v_pk_add_f32 v[76:77], v[204:205], v[62:63] neg_lo:[0,1] neg_hi:[0,1]
    v_pk_add_f32 v[78:79], v[206:207], v[62:63] neg_lo:[0,1] neg_hi:[0,1]
    v_cvt_pk_bf16_f32 v80, v72, v73
    v_cvt_pk_bf16_f32 v81, v74, v75
    v_cvt_pk_bf16_f32 v82, v76, v77
    v_cvt_pk_bf16_f32 v83, v78, v79
    v_lshlrev_b32 v72, 16, v80
    v_and_b32 v73, 0xffff0000, v80
    v_lshlrev_b32 v74, 16, v81
    v_and_b32 v75, 0xffff0000, v81
    v_lshlrev_b32 v76, 16, v82
    v_and_b32 v77, 0xffff0000, v82
    v_lshlrev_b32 v78, 16, v83
    v_and_b32 v79, 0xffff0000, v83
    v_pk_mul_f32 v[72:73], v[72:73], v[66:67]
    v_pk_mul_f32 v[74:75], v[74:75], v[66:67]
    v_pk_mul_f32 v[76:77], v[76:77], v[66:67]
    v_pk_mul_f32 v[78:79], v[78:79], v[66:67]
    v_cvt_pk_bf16_f32 v84, v72, v73
    v_cvt_pk_bf16_f32 v85, v74, v75
    v_cvt_pk_bf16_f32 v86, v76, v77
    v_cvt_pk_bf16_f32 v87, v78, v79
    ds_write_b64 v68, v[84:85] offset:640
    ds_write_b64 v68, v[86:87] offset:656
    v_pk_add_f32 v[72:73], v[208:209], v[62:63] neg_lo:[0,1] neg_hi:[0,1]
    v_pk_add_f32 v[74:75], v[210:211], v[62:63] neg_lo:[0,1] neg_hi:[0,1]
    v_pk_add_f32 v[76:77], v[212:213], v[62:63] neg_lo:[0,1] neg_hi:[0,1]
    v_pk_add_f32 v[78:79], v[214:215], v[62:63] neg_lo:[0,1] neg_hi:[0,1]
    v_cvt_pk_bf16_f32 v80, v72, v73
    v_cvt_pk_bf16_f32 v81, v74, v75
    v_cvt_pk_bf16_f32 v82, v76, v77
    v_cvt_pk_bf16_f32 v83, v78, v79
    v_lshlrev_b32 v72, 16, v80
    v_and_b32 v73, 0xffff0000, v80
    v_lshlrev_b32 v74, 16, v81
    v_and_b32 v75, 0xffff0000, v81
    v_lshlrev_b32 v76, 16, v82
    v_and_b32 v77, 0xffff0000, v82
    v_lshlrev_b32 v78, 16, v83
    v_and_b32 v79, 0xffff0000, v83
    v_pk_mul_f32 v[72:73], v[72:73], v[66:67]
    v_pk_mul_f32 v[74:75], v[74:75], v[66:67]
    v_pk_mul_f32 v[76:77], v[76:77], v[66:67]
    v_pk_mul_f32 v[78:79], v[78:79], v[66:67]
    v_cvt_pk_bf16_f32 v84, v72, v73
    v_cvt_pk_bf16_f32 v85, v74, v75
    v_cvt_pk_bf16_f32 v86, v76, v77
    v_cvt_pk_bf16_f32 v87, v78, v79
    ds_write_b64 v68, v[84:85] offset:768
    ds_write_b64 v68, v[86:87] offset:784
    v_pk_add_f32 v[72:73], v[216:217], v[62:63] neg_lo:[0,1] neg_hi:[0,1]
    v_pk_add_f32 v[74:75], v[218:219], v[62:63] neg_lo:[0,1] neg_hi:[0,1]
    v_pk_add_f32 v[76:77], v[220:221], v[62:63] neg_lo:[0,1] neg_hi:[0,1]
    v_pk_add_f32 v[78:79], v[222:223], v[62:63] neg_lo:[0,1] neg_hi:[0,1]
    v_cvt_pk_bf16_f32 v80, v72, v73
    v_cvt_pk_bf16_f32 v81, v74, v75
    v_cvt_pk_bf16_f32 v82, v76, v77
    v_cvt_pk_bf16_f32 v83, v78, v79
    v_lshlrev_b32 v72, 16, v80
    v_and_b32 v73, 0xffff0000, v80
    v_lshlrev_b32 v74, 16, v81
    v_and_b32 v75, 0xffff0000, v81
    v_lshlrev_b32 v76, 16, v82
    v_and_b32 v77, 0xffff0000, v82
    v_lshlrev_b32 v78, 16, v83
    v_and_b32 v79, 0xffff0000, v83
    v_pk_mul_f32 v[72:73], v[72:73], v[66:67]
    v_pk_mul_f32 v[74:75], v[74:75], v[66:67]
    v_pk_mul_f32 v[76:77], v[76:77], v[66:67]
    v_pk_mul_f32 v[78:79], v[78:79], v[66:67]
    v_cvt_pk_bf16_f32 v84, v72, v73
    v_cvt_pk_bf16_f32 v85, v74, v75
    v_cvt_pk_bf16_f32 v86, v76, v77
    v_cvt_pk_bf16_f32 v87, v78, v79
    ds_write_b64 v68, v[84:85] offset:896
    ds_write_b64 v68, v[86:87] offset:912
    v_pk_add_f32 v[72:73], v[224:225], v[62:63] neg_lo:[0,1] neg_hi:[0,1]
    v_pk_add_f32 v[74:75], v[226:227], v[62:63] neg_lo:[0,1] neg_hi:[0,1]
    v_pk_add_f32 v[76:77], v[228:229], v[62:63] neg_lo:[0,1] neg_hi:[0,1]
    v_pk_add_f32 v[78:79], v[230:231], v[62:63] neg_lo:[0,1] neg_hi:[0,1]
    v_cvt_pk_bf16_f32 v80, v72, v73
    v_cvt_pk_bf16_f32 v81, v74, v75
    v_cvt_pk_bf16_f32 v82, v76, v77
    v_cvt_pk_bf16_f32 v83, v78, v79
    v_lshlrev_b32 v72, 16, v80
    v_and_b32 v73, 0xffff0000, v80
    v_lshlrev_b32 v74, 16, v81
    v_and_b32 v75, 0xffff0000, v81
    v_lshlrev_b32 v76, 16, v82
    v_and_b32 v77, 0xffff0000, v82
    v_lshlrev_b32 v78, 16, v83
    v_and_b32 v79, 0xffff0000, v83
    v_pk_mul_f32 v[72:73], v[72:73], v[66:67]
    v_pk_mul_f32 v[74:75], v[74:75], v[66:67]
    v_pk_mul_f32 v[76:77], v[76:77], v[66:67]
    v_pk_mul_f32 v[78:79], v[78:79], v[66:67]
    v_cvt_pk_bf16_f32 v84, v72, v73
    v_cvt_pk_bf16_f32 v85, v74, v75
    v_cvt_pk_bf16_f32 v86, v76, v77
    v_cvt_pk_bf16_f32 v87, v78, v79
    ds_write_b64 v68, v[84:85] offset:1024
    ds_write_b64 v68, v[86:87] offset:1040
    v_pk_add_f32 v[72:73], v[232:233], v[62:63] neg_lo:[0,1] neg_hi:[0,1]
    v_pk_add_f32 v[74:75], v[234:235], v[62:63] neg_lo:[0,1] neg_hi:[0,1]
    v_pk_add_f32 v[76:77], v[236:237], v[62:63] neg_lo:[0,1] neg_hi:[0,1]
    v_pk_add_f32 v[78:79], v[238:239], v[62:63] neg_lo:[0,1] neg_hi:[0,1]
    v_cvt_pk_bf16_f32 v80, v72, v73
    v_cvt_pk_bf16_f32 v81, v74, v75
    v_cvt_pk_bf16_f32 v82, v76, v77
    v_cvt_pk_bf16_f32 v83, v78, v79
    v_lshlrev_b32 v72, 16, v80
    v_and_b32 v73, 0xffff0000, v80
    v_lshlrev_b32 v74, 16, v81
    v_and_b32 v75, 0xffff0000, v81
    v_lshlrev_b32 v76, 16, v82
    v_and_b32 v77, 0xffff0000, v82
    v_lshlrev_b32 v78, 16, v83
    v_and_b32 v79, 0xffff0000, v83
    v_pk_mul_f32 v[72:73], v[72:73], v[66:67]
    v_pk_mul_f32 v[74:75], v[74:75], v[66:67]
    v_pk_mul_f32 v[76:77], v[76:77], v[66:67]
    v_pk_mul_f32 v[78:79], v[78:79], v[66:67]
    v_cvt_pk_bf16_f32 v84, v72, v73
    v_cvt_pk_bf16_f32 v85, v74, v75
    v_cvt_pk_bf16_f32 v86, v76, v77
    v_cvt_pk_bf16_f32 v87, v78, v79
    ds_write_b64 v68, v[84:85] offset:1152
    ds_write_b64 v68, v[86:87] offset:1168
    s_and_b32 s31, s30, 1
    s_lshr_b32 s32, s30, 1
    s_mul_i32 s33, s31, 41984
    v_mul_u32_u24 v10, 1312, v3
    v_lshl_add_u32 v10, v2, 4, v10
    v_add_u32 v10, s33, v10
    v_lshrrev_b32 v11, 2, v3
    v_lshl_add_u32 v11, v2, 2, v11
    v_mul_u32_u24 v11, 480, v11
    v_and_b32 v12, 3, v3
    v_lshl_add_u32 v11, v12, 3, v11
    s_lshl_b32 s33, s32, 7
    s_add_u32 s33, s33, 83968
    v_add_u32 v11, s33, v11
    v_add_u32 v13, 61440, v11
    v_mov_b32 v96, 0
    v_mov_b32 v97, 0
    v_mov_b32 v98, 0
    v_mov_b32 v99, 0
    v_mov_b32 v100, 0
    v_mov_b32 v101, 0
    v_mov_b32 v102, 0
    v_mov_b32 v103, 0
    v_mov_b32 v104, 0
    v_mov_b32 v105, 0
    v_mov_b32 v106, 0
    v_mov_b32 v107, 0
    v_mov_b32 v108, 0
    v_mov_b32 v109, 0
    v_mov_b32 v110, 0
    v_mov_b32 v111, 0
    v_mov_b32 v112, 0
    v_mov_b32 v113, 0
    v_mov_b32 v114, 0
    v_mov_b32 v115, 0
    v_mov_b32 v116, 0
    v_mov_b32 v117, 0
    v_mov_b32 v118, 0
    v_mov_b32 v119, 0
    v_mov_b32 v120, 0
    v_mov_b32 v121, 0
    v_mov_b32 v122, 0
    v_mov_b32 v123, 0
    v_mov_b32 v124, 0
    v_mov_b32 v125, 0
    v_mov_b32 v126, 0
    v_mov_b32 v127, 0
    s_waitcnt vmcnt(8)
    s_waitcnt lgkmcnt(0)
    s_barrier
    ds_read_b128 v[128:131], v10 offset:0
    ds_read_b128 v[132:135], v10 offset:20992
    ds_read_b64_tr_b16 v[144:145], v11 offset:0
    ds_read_b64_tr_b16 v[146:147], v11 offset:7680
    ds_read_b64_tr_b16 v[148:149], v11 offset:32
    ds_read_b64_tr_b16 v[150:151], v11 offset:7712
    ds_read_b64_tr_b16 v[152:153], v11 offset:64
    ds_read_b64_tr_b16 v[154:155], v11 offset:7744
    ds_read_b64_tr_b16 v[156:157], v11 offset:96
    ds_read_b64_tr_b16 v[158:159], v11 offset:7776
    s_waitcnt lgkmcnt(0)
    s_waitcnt vmcnt(6)
    s_barrier
    s_mov_b32 s33, 0x87000
    s_add_u32 s34, s35, 0x14800
    s_mov_b32 m0, s34
    s_nop 0
    buffer_load_dwordx4 v8, s[16:19], s33 offen lds
    s_add_u32 s34, s34, 1024
    s_mov_b32 m0, s34
    s_mov_b64 exec, s[36:37]
    buffer_load_dwordx4 v9, s[16:19], s33 offen lds
    s_mov_b64 exec, -1
    ds_read_b128 v[136:139], v10 offset:64
    ds_read_b128 v[140:143], v10 offset:21056
    ds_read_b64_tr_b16 v[160:161], v11 offset:15360
    ds_read_b64_tr_b16 v[162:163], v11 offset:23040
    ds_read_b64_tr_b16 v[164:165], v11 offset:15392
    ds_read_b64_tr_b16 v[166:167], v11 offset:23072
    ds_read_b64_tr_b16 v[168:169], v11 offset:15424
    ds_read_b64_tr_b16 v[170:171], v11 offset:23104
    ds_read_b64_tr_b16 v[172:173], v11 offset:15456
    ds_read_b64_tr_b16 v[174:175], v11 offset:23136
    v_mfma_f32_16x16x32_bf16 v[96:99], v[144:147], v[128:131], v[96:99]
    v_mfma_f32_16x16x32_bf16 v[100:103], v[148:151], v[128:131], v[100:103]
    v_mfma_f32_16x16x32_bf16 v[104:107], v[152:155], v[128:131], v[104:107]
    v_mfma_f32_16x16x32_bf16 v[108:111], v[156:159], v[128:131], v[108:111]
    v_mfma_f32_16x16x32_bf16 v[112:115], v[144:147], v[132:135], v[112:115]
    v_mfma_f32_16x16x32_bf16 v[116:119], v[148:151], v[132:135], v[116:119]
    v_mfma_f32_16x16x32_bf16 v[120:123], v[152:155], v[132:135], v[120:123]
    v_mfma_f32_16x16x32_bf16 v[124:127], v[156:159], v[132:135], v[124:127]
    s_waitcnt lgkmcnt(0)
    s_waitcnt vmcnt(6)
    s_barrier
    s_mov_b32 s33, 0xa2000
    s_add_u32 s34, s35, 0x18400
    s_mov_b32 m0, s34
    s_nop 0
    buffer_load_dwordx4 v8, s[16:19], s33 offen lds
    s_add_u32 s34, s34, 1024
    s_mov_b32 m0, s34
    s_mov_b64 exec, s[36:37]
    buffer_load_dwordx4 v9, s[16:19], s33 offen lds
    s_mov_b64 exec, -1
    ds_read_b128 v[128:131], v10 offset:128
    ds_read_b128 v[132:135], v10 offset:21120
    ds_read_b64_tr_b16 v[144:145], v11 offset:30720
    ds_read_b64_tr_b16 v[146:147], v11 offset:38400
    ds_read_b64_tr_b16 v[148:149], v11 offset:30752
    ds_read_b64_tr_b16 v[150:151], v11 offset:38432
    ds_read_b64_tr_b16 v[152:153], v11 offset:30784
    ds_read_b64_tr_b16 v[154:155], v11 offset:38464
    ds_read_b64_tr_b16 v[156:157], v11 offset:30816
    ds_read_b64_tr_b16 v[158:159], v11 offset:38496
    v_mfma_f32_16x16x32_bf16 v[96:99], v[160:163], v[136:139], v[96:99]
    v_mfma_f32_16x16x32_bf16 v[100:103], v[164:167], v[136:139], v[100:103]
    v_mfma_f32_16x16x32_bf16 v[104:107], v[168:171], v[136:139], v[104:107]
    v_mfma_f32_16x16x32_bf16 v[108:111], v[172:175], v[136:139], v[108:111]
    v_mfma_f32_16x16x32_bf16 v[112:115], v[160:163], v[140:143], v[112:115]
    v_mfma_f32_16x16x32_bf16 v[116:119], v[164:167], v[140:143], v[116:119]
    v_mfma_f32_16x16x32_bf16 v[120:123], v[168:171], v[140:143], v[120:123]
    v_mfma_f32_16x16x32_bf16 v[124:127], v[172:175], v[140:143], v[124:127]
    s_waitcnt lgkmcnt(0)
    s_waitcnt vmcnt(6)
    s_barrier
    s_mov_b32 s33, 0xbd000
    s_add_u32 s34, s35, 0x1c000
    s_mov_b32 m0, s34
    s_nop 0
    buffer_load_dwordx4 v8, s[16:19], s33 offen lds
    s_add_u32 s34, s34, 1024
    s_mov_b32 m0, s34
    s_mov_b64 exec, s[36:37]
    buffer_load_dwordx4 v9, s[16:19], s33 offen lds
    s_mov_b64 exec, -1
    ds_read_b128 v[136:139], v10 offset:192
    ds_read_b128 v[140:143], v10 offset:21184
    ds_read_b64_tr_b16 v[160:161], v11 offset:46080
    ds_read_b64_tr_b16 v[162:163], v11 offset:53760
    ds_read_b64_tr_b16 v[164:165], v11 offset:46112
    ds_read_b64_tr_b16 v[166:167], v11 offset:53792
    ds_read_b64_tr_b16 v[168:169], v11 offset:46144
    ds_read_b64_tr_b16 v[170:171], v11 offset:53824
    ds_read_b64_tr_b16 v[172:173], v11 offset:46176
    ds_read_b64_tr_b16 v[174:175], v11 offset:53856
    v_mfma_f32_16x16x32_bf16 v[96:99], v[144:147], v[128:131], v[96:99]
    v_mfma_f32_16x16x32_bf16 v[100:103], v[148:151], v[128:131], v[100:103]
    v_mfma_f32_16x16x32_bf16 v[104:107], v[152:155], v[128:131], v[104:107]
    v_mfma_f32_16x16x32_bf16 v[108:111], v[156:159], v[128:131], v[108:111]
    v_mfma_f32_16x16x32_bf16 v[112:115], v[144:147], v[132:135], v[112:115]
    v_mfma_f32_16x16x32_bf16 v[116:119], v[148:151], v[132:135], v[116:119]
    v_mfma_f32_16x16x32_bf16 v[120:123], v[152:155], v[132:135], v[120:123]
    v_mfma_f32_16x16x32_bf16 v[124:127], v[156:159], v[132:135], v[124:127]
    s_waitcnt lgkmcnt(0)
    s_waitcnt vmcnt(6)
    s_barrier
    s_mov_b32 s33, 0xd8000
    s_add_u32 s34, s35, 0x1fc00
    s_mov_b32 m0, s34
    s_nop 0
    buffer_load_dwordx4 v8, s[16:19], s33 offen lds
    s_add_u32 s34, s34, 1024
    s_mov_b32 m0, s34
    s_mov_b64 exec, s[36:37]
    buffer_load_dwordx4 v9, s[16:19], s33 offen lds
    s_mov_b64 exec, -1
    ds_read_b128 v[128:131], v10 offset:256
    ds_read_b128 v[132:135], v10 offset:21248
    ds_read_b64_tr_b16 v[144:145], v13 offset:0
    ds_read_b64_tr_b16 v[146:147], v13 offset:7680
    ds_read_b64_tr_b16 v[148:149], v13 offset:32
    ds_read_b64_tr_b16 v[150:151], v13 offset:7712
    ds_read_b64_tr_b16 v[152:153], v13 offset:64
    ds_read_b64_tr_b16 v[154:155], v13 offset:7744
    ds_read_b64_tr_b16 v[156:157], v13 offset:96
    ds_read_b64_tr_b16 v[158:159], v13 offset:7776
    v_mfma_f32_16x16x32_bf16 v[96:99], v[160:163], v[136:139], v[96:99]
    v_mfma_f32_16x16x32_bf16 v[100:103], v[164:167], v[136:139], v[100:103]
    v_mfma_f32_16x16x32_bf16 v[104:107], v[168:171], v[136:139], v[104:107]
    v_mfma_f32_16x16x32_bf16 v[108:111], v[172:175], v[136:139], v[108:111]
    v_mfma_f32_16x16x32_bf16 v[112:115], v[160:163], v[140:143], v[112:115]
    v_mfma_f32_16x16x32_bf16 v[116:119], v[164:167], v[140:143], v[116:119]
    v_mfma_f32_16x16x32_bf16 v[120:123], v[168:171], v[140:143], v[120:123]
    v_mfma_f32_16x16x32_bf16 v[124:127], v[172:175], v[140:143], v[124:127]
    s_waitcnt lgkmcnt(0)
    s_waitcnt vmcnt(6)
    s_barrier
    s_mov_b32 s33, 0xf3000
    s_add_u32 s34, s35, 0x23800
    s_mov_b32 m0, s34
    s_nop 0
    buffer_load_dwordx4 v8, s[16:19], s33 offen lds
    s_add_u32 s34, s34, 1024
    s_mov_b32 m0, s34
    s_mov_b64 exec, s[36:37]
    buffer_load_dwordx4 v9, s[16:19], s33 offen lds
    s_mov_b64 exec, -1
    ds_read_b128 v[136:139], v10 offset:320
    ds_read_b128 v[140:143], v10 offset:21312
    ds_read_b64_tr_b16 v[160:161], v11 offset:0
    ds_read_b64_tr_b16 v[162:163], v11 offset:7680
    ds_read_b64_tr_b16 v[164:165], v11 offset:32
    ds_read_b64_tr_b16 v[166:167], v11 offset:7712
    ds_read_b64_tr_b16 v[168:169], v11 offset:64
    ds_read_b64_tr_b16 v[170:171], v11 offset:7744
    ds_read_b64_tr_b16 v[172:173], v11 offset:96
    ds_read_b64_tr_b16 v[174:175], v11 offset:7776
    v_mfma_f32_16x16x32_bf16 v[96:99], v[144:147], v[128:131], v[96:99]
    v_mfma_f32_16x16x32_bf16 v[100:103], v[148:151], v[128:131], v[100:103]
    v_mfma_f32_16x16x32_bf16 v[104:107], v[152:155], v[128:131], v[104:107]
    v_mfma_f32_16x16x32_bf16 v[108:111], v[156:159], v[128:131], v[108:111]
    v_mfma_f32_16x16x32_bf16 v[112:115], v[144:147], v[132:135], v[112:115]
    v_mfma_f32_16x16x32_bf16 v[116:119], v[148:151], v[132:135], v[116:119]
    v_mfma_f32_16x16x32_bf16 v[120:123], v[152:155], v[132:135], v[120:123]
    v_mfma_f32_16x16x32_bf16 v[124:127], v[156:159], v[132:135], v[124:127]
    s_waitcnt lgkmcnt(0)
    s_waitcnt vmcnt(6)
    s_barrier
    s_mov_b32 s33, 0x10e000
    s_add_u32 s34, s35, 0x14800
    s_mov_b32 m0, s34
    s_nop 0
    buffer_load_dwordx4 v8, s[16:19], s33 offen lds
    s_add_u32 s34, s34, 1024
    s_mov_b32 m0, s34
    s_mov_b64 exec, s[36:37]
    buffer_load_dwordx4 v9, s[16:19], s33 offen lds
    s_mov_b64 exec, -1
    ds_read_b128 v[128:131], v10 offset:384
    ds_read_b128 v[132:135], v10 offset:21376
    ds_read_b64_tr_b16 v[144:145], v11 offset:15360
    ds_read_b64_tr_b16 v[146:147], v11 offset:23040
    ds_read_b64_tr_b16 v[148:149], v11 offset:15392
    ds_read_b64_tr_b16 v[150:151], v11 offset:23072
    ds_read_b64_tr_b16 v[152:153], v11 offset:15424
    ds_read_b64_tr_b16 v[154:155], v11 offset:23104
    ds_read_b64_tr_b16 v[156:157], v11 offset:15456
    ds_read_b64_tr_b16 v[158:159], v11 offset:23136
    v_mfma_f32_16x16x32_bf16 v[96:99], v[160:163], v[136:139], v[96:99]
    v_mfma_f32_16x16x32_bf16 v[100:103], v[164:167], v[136:139], v[100:103]
    v_mfma_f32_16x16x32_bf16 v[104:107], v[168:171], v[136:139], v[104:107]
    v_mfma_f32_16x16x32_bf16 v[108:111], v[172:175], v[136:139], v[108:111]
    v_mfma_f32_16x16x32_bf16 v[112:115], v[160:163], v[140:143], v[112:115]
    v_mfma_f32_16x16x32_bf16 v[116:119], v[164:167], v[140:143], v[116:119]
    v_mfma_f32_16x16x32_bf16 v[120:123], v[168:171], v[140:143], v[120:123]
    v_mfma_f32_16x16x32_bf16 v[124:127], v[172:175], v[140:143], v[124:127]
    s_waitcnt lgkmcnt(0)
    s_waitcnt vmcnt(6)
    s_barrier
    s_mov_b32 s33, 0x129000
    s_add_u32 s34, s35, 0x18400
    s_mov_b32 m0, s34
    s_nop 0
    buffer_load_dwordx4 v8, s[16:19], s33 offen lds
    s_add_u32 s34, s34, 1024
    s_mov_b32 m0, s34
    s_mov_b64 exec, s[36:37]
    buffer_load_dwordx4 v9, s[16:19], s33 offen lds
    s_mov_b64 exec, -1
    ds_read_b128 v[136:139], v10 offset:448
    ds_read_b128 v[140:143], v10 offset:21440
    ds_read_b64_tr_b16 v[160:161], v11 offset:30720
    ds_read_b64_tr_b16 v[162:163], v11 offset:38400
    ds_read_b64_tr_b16 v[164:165], v11 offset:30752
    ds_read_b64_tr_b16 v[166:167], v11 offset:38432
    ds_read_b64_tr_b16 v[168:169], v11 offset:30784
    ds_read_b64_tr_b16 v[170:171], v11 offset:38464
    ds_read_b64_tr_b16 v[172:173], v11 offset:30816
    ds_read_b64_tr_b16 v[174:175], v11 offset:38496
    v_mfma_f32_16x16x32_bf16 v[96:99], v[144:147], v[128:131], v[96:99]
    v_mfma_f32_16x16x32_bf16 v[100:103], v[148:151], v[128:131], v[100:103]
    v_mfma_f32_16x16x32_bf16 v[104:107], v[152:155], v[128:131], v[104:107]
    v_mfma_f32_16x16x32_bf16 v[108:111], v[156:159], v[128:131], v[108:111]
    v_mfma_f32_16x16x32_bf16 v[112:115], v[144:147], v[132:135], v[112:115]
    v_mfma_f32_16x16x32_bf16 v[116:119], v[148:151], v[132:135], v[116:119]
    v_mfma_f32_16x16x32_bf16 v[120:123], v[152:155], v[132:135], v[120:123]
    v_mfma_f32_16x16x32_bf16 v[124:127], v[156:159], v[132:135], v[124:127]
    s_waitcnt lgkmcnt(0)
    s_waitcnt vmcnt(6)
    s_barrier
    s_mov_b32 s33, 0x144000
    s_add_u32 s34, s35, 0x1c000
    s_mov_b32 m0, s34
    s_nop 0
    buffer_load_dwordx4 v8, s[16:19], s33 offen lds
    s_add_u32 s34, s34, 1024
    s_mov_b32 m0, s34
    s_mov_b64 exec, s[36:37]
    buffer_load_dwordx4 v9, s[16:19], s33 offen lds
    s_mov_b64 exec, -1
    ds_read_b128 v[128:131], v10 offset:512
    ds_read_b128 v[132:135], v10 offset:21504
    ds_read_b64_tr_b16 v[144:145], v11 offset:46080
    ds_read_b64_tr_b16 v[146:147], v11 offset:53760
    ds_read_b64_tr_b16 v[148:149], v11 offset:46112
    ds_read_b64_tr_b16 v[150:151], v11 offset:53792
    ds_read_b64_tr_b16 v[152:153], v11 offset:46144
    ds_read_b64_tr_b16 v[154:155], v11 offset:53824
    ds_read_b64_tr_b16 v[156:157], v11 offset:46176
    ds_read_b64_tr_b16 v[158:159], v11 offset:53856
    v_mfma_f32_16x16x32_bf16 v[96:99], v[160:163], v[136:139], v[96:99]
    v_mfma_f32_16x16x32_bf16 v[100:103], v[164:167], v[136:139], v[100:103]
    v_mfma_f32_16x16x32_bf16 v[104:107], v[168:171], v[136:139], v[104:107]
    v_mfma_f32_16x16x32_bf16 v[108:111], v[172:175], v[136:139], v[108:111]
    v_mfma_f32_16x16x32_bf16 v[112:115], v[160:163], v[140:143], v[112:115]
    v_mfma_f32_16x16x32_bf16 v[116:119], v[164:167], v[140:143], v[116:119]
    v_mfma_f32_16x16x32_bf16 v[120:123], v[168:171], v[140:143], v[120:123]
    v_mfma_f32_16x16x32_bf16 v[124:127], v[172:175], v[140:143], v[124:127]
    s_waitcnt lgkmcnt(0)
    s_waitcnt vmcnt(6)
    s_barrier
    s_mov_b32 s33, 0x15f000
    s_add_u32 s34, s35, 0x1fc00
    s_mov_b32 m0, s34
    s_nop 0
    buffer_load_dwordx4 v8, s[16:19], s33 offen lds
    s_add_u32 s34, s34, 1024
    s_mov_b32 m0, s34
    s_mov_b64 exec, s[36:37]
    buffer_load_dwordx4 v9, s[16:19], s33 offen lds
    s_mov_b64 exec, -1
    ds_read_b128 v[136:139], v10 offset:576
    ds_read_b128 v[140:143], v10 offset:21568
    ds_read_b64_tr_b16 v[160:161], v13 offset:0
    ds_read_b64_tr_b16 v[162:163], v13 offset:7680
    ds_read_b64_tr_b16 v[164:165], v13 offset:32
    ds_read_b64_tr_b16 v[166:167], v13 offset:7712
    ds_read_b64_tr_b16 v[168:169], v13 offset:64
    ds_read_b64_tr_b16 v[170:171], v13 offset:7744
    ds_read_b64_tr_b16 v[172:173], v13 offset:96
    ds_read_b64_tr_b16 v[174:175], v13 offset:7776
    v_mfma_f32_16x16x32_bf16 v[96:99], v[144:147], v[128:131], v[96:99]
    v_mfma_f32_16x16x32_bf16 v[100:103], v[148:151], v[128:131], v[100:103]
    v_mfma_f32_16x16x32_bf16 v[104:107], v[152:155], v[128:131], v[104:107]
    v_mfma_f32_16x16x32_bf16 v[108:111], v[156:159], v[128:131], v[108:111]
    v_mfma_f32_16x16x32_bf16 v[112:115], v[144:147], v[132:135], v[112:115]
    v_mfma_f32_16x16x32_bf16 v[116:119], v[148:151], v[132:135], v[116:119]
    v_mfma_f32_16x16x32_bf16 v[120:123], v[152:155], v[132:135], v[120:123]
    v_mfma_f32_16x16x32_bf16 v[124:127], v[156:159], v[132:135], v[124:127]
    s_waitcnt lgkmcnt(0)
    s_waitcnt vmcnt(6)
    s_barrier
    s_mov_b32 s33, 0x17a000
    s_add_u32 s34, s35, 0x23800
    s_mov_b32 m0, s34
    s_nop 0
    buffer_load_dwordx4 v8, s[16:19], s33 offen lds
    s_add_u32 s34, s34, 1024
    s_mov_b32 m0, s34
    s_mov_b64 exec, s[36:37]
    buffer_load_dwordx4 v9, s[16:19], s33 offen lds
    s_mov_b64 exec, -1
    ds_read_b128 v[128:131], v10 offset:640
    ds_read_b128 v[132:135], v10 offset:21632
    ds_read_b64_tr_b16 v[144:145], v11 offset:0
    ds_read_b64_tr_b16 v[146:147], v11 offset:7680
    ds_read_b64_tr_b16 v[148:149], v11 offset:32
    ds_read_b64_tr_b16 v[150:151], v11 offset:7712
    ds_read_b64_tr_b16 v[152:153], v11 offset:64
    ds_read_b64_tr_b16 v[154:155], v11 offset:7744
    ds_read_b64_tr_b16 v[156:157], v11 offset:96
    ds_read_b64_tr_b16 v[158:159], v11 offset:7776
    v_mfma_f32_16x16x32_bf16 v[96:99], v[160:163], v[136:139], v[96:99]
    v_mfma_f32_16x16x32_bf16 v[100:103], v[164:167], v[136:139], v[100:103]
    v_mfma_f32_16x16x32_bf16 v[104:107], v[168:171], v[136:139], v[104:107]
    v_mfma_f32_16x16x32_bf16 v[108:111], v[172:175], v[136:139], v[108:111]
    v_mfma_f32_16x16x32_bf16 v[112:115], v[160:163], v[140:143], v[112:115]
    v_mfma_f32_16x16x32_bf16 v[116:119], v[164:167], v[140:143], v[116:119]
    v_mfma_f32_16x16x32_bf16 v[120:123], v[168:171], v[140:143], v[120:123]
    v_mfma_f32_16x16x32_bf16 v[124:127], v[172:175], v[140:143], v[124:127]
    s_waitcnt lgkmcnt(0)
    s_waitcnt vmcnt(6)
    s_barrier
    s_mov_b32 s33, 0x195000
    s_add_u32 s34, s35, 0x14800
    s_mov_b32 m0, s34
    s_nop 0
    buffer_load_dwordx4 v8, s[16:19], s33 offen lds
    s_add_u32 s34, s34, 1024
    s_mov_b32 m0, s34
    s_mov_b64 exec, s[36:37]
    buffer_load_dwordx4 v9, s[16:19], s33 offen lds
    s_mov_b64 exec, -1
    ds_read_b128 v[136:139], v10 offset:704
    ds_read_b128 v[140:143], v10 offset:21696
    ds_read_b64_tr_b16 v[160:161], v11 offset:15360
    ds_read_b64_tr_b16 v[162:163], v11 offset:23040
    ds_read_b64_tr_b16 v[164:165], v11 offset:15392
    ds_read_b64_tr_b16 v[166:167], v11 offset:23072
    ds_read_b64_tr_b16 v[168:169], v11 offset:15424
    ds_read_b64_tr_b16 v[170:171], v11 offset:23104
    ds_read_b64_tr_b16 v[172:173], v11 offset:15456
    ds_read_b64_tr_b16 v[174:175], v11 offset:23136
    v_mfma_f32_16x16x32_bf16 v[96:99], v[144:147], v[128:131], v[96:99]
    v_mfma_f32_16x16x32_bf16 v[100:103], v[148:151], v[128:131], v[100:103]
    v_mfma_f32_16x16x32_bf16 v[104:107], v[152:155], v[128:131], v[104:107]
    v_mfma_f32_16x16x32_bf16 v[108:111], v[156:159], v[128:131], v[108:111]
    v_mfma_f32_16x16x32_bf16 v[112:115], v[144:147], v[132:135], v[112:115]
    v_mfma_f32_16x16x32_bf16 v[116:119], v[148:151], v[132:135], v[116:119]
    v_mfma_f32_16x16x32_bf16 v[120:123], v[152:155], v[132:135], v[120:123]
    v_mfma_f32_16x16x32_bf16 v[124:127], v[156:159], v[132:135], v[124:127]
    s_waitcnt lgkmcnt(0)
    s_waitcnt vmcnt(6)
    s_barrier
    s_mov_b32 s33, 0x1b0000
    s_add_u32 s34, s35, 0x18400
    s_mov_b32 m0, s34
    s_nop 0
    buffer_load_dwordx4 v8, s[16:19], s33 offen lds
    s_add_u32 s34, s34, 1024
    s_mov_b32 m0, s34
    s_mov_b64 exec, s[36:37]
    buffer_load_dwordx4 v9, s[16:19], s33 offen lds
    s_mov_b64 exec, -1
    ds_read_b128 v[128:131], v10 offset:768
    ds_read_b128 v[132:135], v10 offset:21760
    ds_read_b64_tr_b16 v[144:145], v11 offset:30720
    ds_read_b64_tr_b16 v[146:147], v11 offset:38400
    ds_read_b64_tr_b16 v[148:149], v11 offset:30752
    ds_read_b64_tr_b16 v[150:151], v11 offset:38432
    ds_read_b64_tr_b16 v[152:153], v11 offset:30784
    ds_read_b64_tr_b16 v[154:155], v11 offset:38464
    ds_read_b64_tr_b16 v[156:157], v11 offset:30816
    ds_read_b64_tr_b16 v[158:159], v11 offset:38496
    v_mfma_f32_16x16x32_bf16 v[96:99], v[160:163], v[136:139], v[96:99]
    v_mfma_f32_16x16x32_bf16 v[100:103], v[164:167], v[136:139], v[100:103]
    v_mfma_f32_16x16x32_bf16 v[104:107], v[168:171], v[136:139], v[104:107]
    v_mfma_f32_16x16x32_bf16 v[108:111], v[172:175], v[136:139], v[108:111]
    v_mfma_f32_16x16x32_bf16 v[112:115], v[160:163], v[140:143], v[112:115]
    v_mfma_f32_16x16x32_bf16 v[116:119], v[164:167], v[140:143], v[116:119]
    v_mfma_f32_16x16x32_bf16 v[120:123], v[168:171], v[140:143], v[120:123]
    v_mfma_f32_16x16x32_bf16 v[124:127], v[172:175], v[140:143], v[124:127]
    s_waitcnt lgkmcnt(0)
    s_waitcnt vmcnt(6)
    s_barrier
    s_mov_b32 s33, 0x1cb000
    s_add_u32 s34, s35, 0x1c000
    s_mov_b32 m0, s34
    s_nop 0
    buffer_load_dwordx4 v8, s[16:19], s33 offen lds
    s_add_u32 s34, s34, 1024
    s_mov_b32 m0, s34
    s_mov_b64 exec, s[36:37]
    buffer_load_dwordx4 v9, s[16:19], s33 offen lds
    s_mov_b64 exec, -1
    ds_read_b128 v[136:139], v10 offset:832
    ds_read_b128 v[140:143], v10 offset:21824
    ds_read_b64_tr_b16 v[160:161], v11 offset:46080
    ds_read_b64_tr_b16 v[162:163], v11 offset:53760
    ds_read_b64_tr_b16 v[164:165], v11 offset:46112
    ds_read_b64_tr_b16 v[166:167], v11 offset:53792
    ds_read_b64_tr_b16 v[168:169], v11 offset:46144
    ds_read_b64_tr_b16 v[170:171], v11 offset:53824
    ds_read_b64_tr_b16 v[172:173], v11 offset:46176
    ds_read_b64_tr_b16 v[174:175], v11 offset:53856
    v_mfma_f32_16x16x32_bf16 v[96:99], v[144:147], v[128:131], v[96:99]
    v_mfma_f32_16x16x32_bf16 v[100:103], v[148:151], v[128:131], v[100:103]
    v_mfma_f32_16x16x32_bf16 v[104:107], v[152:155], v[128:131], v[104:107]
    v_mfma_f32_16x16x32_bf16 v[108:111], v[156:159], v[128:131], v[108:111]
    v_mfma_f32_16x16x32_bf16 v[112:115], v[144:147], v[132:135], v[112:115]
    v_mfma_f32_16x16x32_bf16 v[116:119], v[148:151], v[132:135], v[116:119]
    v_mfma_f32_16x16x32_bf16 v[120:123], v[152:155], v[132:135], v[120:123]
    v_mfma_f32_16x16x32_bf16 v[124:127], v[156:159], v[132:135], v[124:127]
    s_waitcnt lgkmcnt(0)
    s_waitcnt vmcnt(6)
    s_barrier
    s_mov_b32 s33, 0x1e6000
    s_add_u32 s34, s35, 0x1fc00
    s_mov_b32 m0, s34
    s_nop 0
    buffer_load_dwordx4 v8, s[16:19], s33 offen lds
    s_add_u32 s34, s34, 1024
    s_mov_b32 m0, s34
    s_mov_b64 exec, s[36:37]
    buffer_load_dwordx4 v9, s[16:19], s33 offen lds
    s_mov_b64 exec, -1
    ds_read_b128 v[128:131], v10 offset:896
    ds_read_b128 v[132:135], v10 offset:21888
    ds_read_b64_tr_b16 v[144:145], v13 offset:0
    ds_read_b64_tr_b16 v[146:147], v13 offset:7680
    ds_read_b64_tr_b16 v[148:149], v13 offset:32
    ds_read_b64_tr_b16 v[150:151], v13 offset:7712
    ds_read_b64_tr_b16 v[152:153], v13 offset:64
    ds_read_b64_tr_b16 v[154:155], v13 offset:7744
    ds_read_b64_tr_b16 v[156:157], v13 offset:96
    ds_read_b64_tr_b16 v[158:159], v13 offset:7776
    v_mfma_f32_16x16x32_bf16 v[96:99], v[160:163], v[136:139], v[96:99]
    v_mfma_f32_16x16x32_bf16 v[100:103], v[164:167], v[136:139], v[100:103]
    v_mfma_f32_16x16x32_bf16 v[104:107], v[168:171], v[136:139], v[104:107]
    v_mfma_f32_16x16x32_bf16 v[108:111], v[172:175], v[136:139], v[108:111]
    v_mfma_f32_16x16x32_bf16 v[112:115], v[160:163], v[140:143], v[112:115]
    v_mfma_f32_16x16x32_bf16 v[116:119], v[164:167], v[140:143], v[116:119]
    v_mfma_f32_16x16x32_bf16 v[120:123], v[168:171], v[140:143], v[120:123]
    v_mfma_f32_16x16x32_bf16 v[124:127], v[172:175], v[140:143], v[124:127]
    s_waitcnt lgkmcnt(0)
    s_waitcnt vmcnt(6)
    s_barrier
    s_mov_b32 s33, 0x201000
    s_add_u32 s34, s35, 0x23800
    s_mov_b32 m0, s34
    s_nop 0
    buffer_load_dwordx4 v8, s[16:19], s33 offen lds
    s_add_u32 s34, s34, 1024
    s_mov_b32 m0, s34
    s_mov_b64 exec, s[36:37]
    buffer_load_dwordx4 v9, s[16:19], s33 offen lds
    s_mov_b64 exec, -1
    ds_read_b128 v[136:139], v10 offset:960
    ds_read_b128 v[140:143], v10 offset:21952
    ds_read_b64_tr_b16 v[160:161], v11 offset:0
    ds_read_b64_tr_b16 v[162:163], v11 offset:7680
    ds_read_b64_tr_b16 v[164:165], v11 offset:32
    ds_read_b64_tr_b16 v[166:167], v11 offset:7712
    ds_read_b64_tr_b16 v[168:169], v11 offset:64
    ds_read_b64_tr_b16 v[170:171], v11 offset:7744
    ds_read_b64_tr_b16 v[172:173], v11 offset:96
    ds_read_b64_tr_b16 v[174:175], v11 offset:7776
    v_mfma_f32_16x16x32_bf16 v[96:99], v[144:147], v[128:131], v[96:99]
    v_mfma_f32_16x16x32_bf16 v[100:103], v[148:151], v[128:131], v[100:103]
    v_mfma_f32_16x16x32_bf16 v[104:107], v[152:155], v[128:131], v[104:107]
    v_mfma_f32_16x16x32_bf16 v[108:111], v[156:159], v[128:131], v[108:111]
    v_mfma_f32_16x16x32_bf16 v[112:115], v[144:147], v[132:135], v[112:115]
    v_mfma_f32_16x16x32_bf16 v[116:119], v[148:151], v[132:135], v[116:119]
    v_mfma_f32_16x16x32_bf16 v[120:123], v[152:155], v[132:135], v[120:123]
    v_mfma_f32_16x16x32_bf16 v[124:127], v[156:159], v[132:135], v[124:127]
    s_waitcnt lgkmcnt(0)
    s_waitcnt vmcnt(6)
    s_barrier
    ds_read_b128 v[128:131], v10 offset:1024
    ds_read_b128 v[132:135], v10 offset:22016
    ds_read_b64_tr_b16 v[144:145], v11 offset:15360
    ds_read_b64_tr_b16 v[146:147], v11 offset:23040
    ds_read_b64_tr_b16 v[148:149], v11 offset:15392
    ds_read_b64_tr_b16 v[150:151], v11 offset:23072
    ds_read_b64_tr_b16 v[152:153], v11 offset:15424
    ds_read_b64_tr_b16 v[154:155], v11 offset:23104
    ds_read_b64_tr_b16 v[156:157], v11 offset:15456
    ds_read_b64_tr_b16 v[158:159], v11 offset:23136
    v_mfma_f32_16x16x32_bf16 v[96:99], v[160:163], v[136:139], v[96:99]
    v_mfma_f32_16x16x32_bf16 v[100:103], v[164:167], v[136:139], v[100:103]
    v_mfma_f32_16x16x32_bf16 v[104:107], v[168:171], v[136:139], v[104:107]
    v_mfma_f32_16x16x32_bf16 v[108:111], v[172:175], v[136:139], v[108:111]
    v_mfma_f32_16x16x32_bf16 v[112:115], v[160:163], v[140:143], v[112:115]
    v_mfma_f32_16x16x32_bf16 v[116:119], v[164:167], v[140:143], v[116:119]
    v_mfma_f32_16x16x32_bf16 v[120:123], v[168:171], v[140:143], v[120:123]
    v_mfma_f32_16x16x32_bf16 v[124:127], v[172:175], v[140:143], v[124:127]
    s_waitcnt lgkmcnt(0)
    s_waitcnt vmcnt(4)
    s_barrier
    ds_read_b128 v[136:139], v10 offset:1088
    ds_read_b128 v[140:143], v10 offset:22080
    ds_read_b64_tr_b16 v[160:161], v11 offset:30720
    ds_read_b64_tr_b16 v[162:163], v11 offset:38400
    ds_read_b64_tr_b16 v[164:165], v11 offset:30752
    ds_read_b64_tr_b16 v[166:167], v11 offset:38432
    ds_read_b64_tr_b16 v[168:169], v11 offset:30784
    ds_read_b64_tr_b16 v[170:171], v11 offset:38464
    ds_read_b64_tr_b16 v[172:173], v11 offset:30816
    ds_read_b64_tr_b16 v[174:175], v11 offset:38496
    v_mfma_f32_16x16x32_bf16 v[96:99], v[144:147], v[128:131], v[96:99]
    v_mfma_f32_16x16x32_bf16 v[100:103], v[148:151], v[128:131], v[100:103]
    v_mfma_f32_16x16x32_bf16 v[104:107], v[152:155], v[128:131], v[104:107]
    v_mfma_f32_16x16x32_bf16 v[108:111], v[156:159], v[128:131], v[108:111]
    v_mfma_f32_16x16x32_bf16 v[112:115], v[144:147], v[132:135], v[112:115]
    v_mfma_f32_16x16x32_bf16 v[116:119], v[148:151], v[132:135], v[116:119]
    v_mfma_f32_16x16x32_bf16 v[120:123], v[152:155], v[132:135], v[120:123]
    v_mfma_f32_16x16x32_bf16 v[124:127], v[156:159], v[132:135], v[124:127]
    s_waitcnt lgkmcnt(0)
    s_waitcnt vmcnt(2)
    s_barrier
    ds_read_b128 v[128:131], v10 offset:1152
    ds_read_b128 v[132:135], v10 offset:22144
    ds_read_b64_tr_b16 v[144:145], v11 offset:46080
    ds_read_b64_tr_b16 v[146:147], v11 offset:53760
    ds_read_b64_tr_b16 v[148:149], v11 offset:46112
    ds_read_b64_tr_b16 v[150:151], v11 offset:53792
    ds_read_b64_tr_b16 v[152:153], v11 offset:46144
    ds_read_b64_tr_b16 v[154:155], v11 offset:53824
    ds_read_b64_tr_b16 v[156:157], v11 offset:46176
    ds_read_b64_tr_b16 v[158:159], v11 offset:53856
    v_mfma_f32_16x16x32_bf16 v[96:99], v[160:163], v[136:139], v[96:99]
    v_mfma_f32_16x16x32_bf16 v[100:103], v[164:167], v[136:139], v[100:103]
    v_mfma_f32_16x16x32_bf16 v[104:107], v[168:171], v[136:139], v[104:107]
    v_mfma_f32_16x16x32_bf16 v[108:111], v[172:175], v[136:139], v[108:111]
    v_mfma_f32_16x16x32_bf16 v[112:115], v[160:163], v[140:143], v[112:115]
    v_mfma_f32_16x16x32_bf16 v[116:119], v[164:167], v[140:143], v[116:119]
    v_mfma_f32_16x16x32_bf16 v[120:123], v[168:171], v[140:143], v[120:123]
    v_mfma_f32_16x16x32_bf16 v[124:127], v[172:175], v[140:143], v[124:127]
    s_waitcnt lgkmcnt(0)
    s_waitcnt vmcnt(0)
    s_barrier
    ds_read_b128 v[136:139], v10 offset:1216
    ds_read_b128 v[140:143], v10 offset:22208
    ds_read_b64_tr_b16 v[160:161], v13 offset:0
    ds_read_b64_tr_b16 v[162:163], v13 offset:7680
    ds_read_b64_tr_b16 v[164:165], v13 offset:32
    ds_read_b64_tr_b16 v[166:167], v13 offset:7712
    ds_read_b64_tr_b16 v[168:169], v13 offset:64
    ds_read_b64_tr_b16 v[170:171], v13 offset:7744
    ds_read_b64_tr_b16 v[172:173], v13 offset:96
    ds_read_b64_tr_b16 v[174:175], v13 offset:7776
    v_mfma_f32_16x16x32_bf16 v[96:99], v[144:147], v[128:131], v[96:99]
    v_mfma_f32_16x16x32_bf16 v[100:103], v[148:151], v[128:131], v[100:103]
    v_mfma_f32_16x16x32_bf16 v[104:107], v[152:155], v[128:131], v[104:107]
    v_mfma_f32_16x16x32_bf16 v[108:111], v[156:159], v[128:131], v[108:111]
    v_mfma_f32_16x16x32_bf16 v[112:115], v[144:147], v[132:135], v[112:115]
    v_mfma_f32_16x16x32_bf16 v[116:119], v[148:151], v[132:135], v[116:119]
    v_mfma_f32_16x16x32_bf16 v[120:123], v[152:155], v[132:135], v[120:123]
    v_mfma_f32_16x16x32_bf16 v[124:127], v[156:159], v[132:135], v[124:127]
    s_waitcnt lgkmcnt(0)
    s_barrier
    v_mfma_f32_16x16x32_bf16 v[96:99], v[160:163], v[136:139], v[96:99]
    v_mfma_f32_16x16x32_bf16 v[100:103], v[164:167], v[136:139], v[100:103]
    v_mfma_f32_16x16x32_bf16 v[104:107], v[168:171], v[136:139], v[104:107]
    v_mfma_f32_16x16x32_bf16 v[108:111], v[172:175], v[136:139], v[108:111]
    v_mfma_f32_16x16x32_bf16 v[112:115], v[160:163], v[140:143], v[112:115]
    v_mfma_f32_16x16x32_bf16 v[116:119], v[164:167], v[140:143], v[116:119]
    v_mfma_f32_16x16x32_bf16 v[120:123], v[168:171], v[140:143], v[120:123]
    v_mfma_f32_16x16x32_bf16 v[124:127], v[172:175], v[140:143], v[124:127]
    s_nop 7
    s_nop 7
    s_lshl_b32 s33, s31, 5
    s_add_u32 s33, s33, s42
    v_add_u32 v12, s33, v3
    v_mul_u32_u24 v12, 3456, v12
    v_lshl_add_u32 v12, v2, 3, v12
    s_mul_i32 s34, s29, 432
    s_lshl_b32 s33, s32, 7
    s_add_u32 s33, s33, s34
    v_add_u32 v12, s33, v12
    s_lshl_b32 s33, s32, 6
    v_lshl_add_u32 v13, v2, 2, s33
    s_mov_b32 s47, 0x3fb8aa3b
    v_add_u32 v14, 0, v13
    v_cmp_gt_u32 vcc, 216, v14
    s_and_saveexec_b64 s[44:45], vcc
    v_cvt_pk_bf16_f32 v16, v96, v97
    v_cvt_pk_bf16_f32 v17, v98, v99
    v_lshlrev_b32 v18, 16, v16
    v_and_b32 v19, 0xffff0000, v16
    v_mul_f32 v20, s47, v18
    v_mul_f32 v21, s47, v19
    v_exp_f32 v20, -v20
    v_exp_f32 v21, -v21
    s_nop 0
    v_add_f32 v20, 1.0, v20
    v_add_f32 v21, 1.0, v21
    v_rcp_f32 v20, v20
    v_rcp_f32 v21, v21
    s_nop 0
    v_mul_f32 v18, v18, v20
    v_mul_f32 v19, v19, v21
    v_cvt_pk_bf16_f32 v22, v18, v19
    v_lshlrev_b32 v18, 16, v17
    v_and_b32 v19, 0xffff0000, v17
    v_mul_f32 v20, s47, v18
    v_mul_f32 v21, s47, v19
    v_exp_f32 v20, -v20
    v_exp_f32 v21, -v21
    s_nop 0
    v_add_f32 v20, 1.0, v20
    v_add_f32 v21, 1.0, v21
    v_rcp_f32 v20, v20
    v_rcp_f32 v21, v21
    s_nop 0
    v_mul_f32 v18, v18, v20
    v_mul_f32 v19, v19, v21
    v_cvt_pk_bf16_f32 v23, v18, v19
    s_mov_b32 s35, 0
    buffer_store_dwordx2 v[22:23], v12, s[20:23], s35 offen offset:0
    s_nop 1
    v_cvt_pk_bf16_f32 v16, v112, v113
    v_cvt_pk_bf16_f32 v17, v114, v115
    v_lshlrev_b32 v18, 16, v16
    v_and_b32 v19, 0xffff0000, v16
    v_mul_f32 v20, s47, v18
    v_mul_f32 v21, s47, v19
    v_exp_f32 v20, -v20
    v_exp_f32 v21, -v21
    s_nop 0
    v_add_f32 v20, 1.0, v20
    v_add_f32 v21, 1.0, v21
    v_rcp_f32 v20, v20
    v_rcp_f32 v21, v21
    s_nop 0
    v_mul_f32 v18, v18, v20
    v_mul_f32 v19, v19, v21
    v_cvt_pk_bf16_f32 v22, v18, v19
    v_lshlrev_b32 v18, 16, v17
    v_and_b32 v19, 0xffff0000, v17
    v_mul_f32 v20, s47, v18
    v_mul_f32 v21, s47, v19
    v_exp_f32 v20, -v20
    v_exp_f32 v21, -v21
    s_nop 0
    v_add_f32 v20, 1.0, v20
    v_add_f32 v21, 1.0, v21
    v_rcp_f32 v20, v20
    v_rcp_f32 v21, v21
    s_nop 0
    v_mul_f32 v18, v18, v20
    v_mul_f32 v19, v19, v21
    v_cvt_pk_bf16_f32 v23, v18, v19
    s_mov_b32 s35, 55296
    buffer_store_dwordx2 v[22:23], v12, s[20:23], s35 offen offset:0
    s_nop 1
    s_mov_b64 exec, s[44:45]
    v_add_u32 v14, 16, v13
    v_cmp_gt_u32 vcc, 216, v14
    s_and_saveexec_b64 s[44:45], vcc
    v_cvt_pk_bf16_f32 v16, v100, v101
    v_cvt_pk_bf16_f32 v17, v102, v103
    v_lshlrev_b32 v18, 16, v16
    v_and_b32 v19, 0xffff0000, v16
    v_mul_f32 v20, s47, v18
    v_mul_f32 v21, s47, v19
    v_exp_f32 v20, -v20
    v_exp_f32 v21, -v21
    s_nop 0
    v_add_f32 v20, 1.0, v20
    v_add_f32 v21, 1.0, v21
    v_rcp_f32 v20, v20
    v_rcp_f32 v21, v21
    s_nop 0
    v_mul_f32 v18, v18, v20
    v_mul_f32 v19, v19, v21
    v_cvt_pk_bf16_f32 v22, v18, v19
    v_lshlrev_b32 v18, 16, v17
    v_and_b32 v19, 0xffff0000, v17
    v_mul_f32 v20, s47, v18
    v_mul_f32 v21, s47, v19
    v_exp_f32 v20, -v20
    v_exp_f32 v21, -v21
    s_nop 0
    v_add_f32 v20, 1.0, v20
    v_add_f32 v21, 1.0, v21
    v_rcp_f32 v20, v20
    v_rcp_f32 v21, v21
    s_nop 0
    v_mul_f32 v18, v18, v20
    v_mul_f32 v19, v19, v21
    v_cvt_pk_bf16_f32 v23, v18, v19
    s_mov_b32 s35, 0
    buffer_store_dwordx2 v[22:23], v12, s[20:23], s35 offen offset:32
    s_nop 1
    v_cvt_pk_bf16_f32 v16, v116, v117
    v_cvt_pk_bf16_f32 v17, v118, v119
    v_lshlrev_b32 v18, 16, v16
    v_and_b32 v19, 0xffff0000, v16
    v_mul_f32 v20, s47, v18
    v_mul_f32 v21, s47, v19
    v_exp_f32 v20, -v20
    v_exp_f32 v21, -v21
    s_nop 0
    v_add_f32 v20, 1.0, v20
    v_add_f32 v21, 1.0, v21
    v_rcp_f32 v20, v20
    v_rcp_f32 v21, v21
    s_nop 0
    v_mul_f32 v18, v18, v20
    v_mul_f32 v19, v19, v21
    v_cvt_pk_bf16_f32 v22, v18, v19
    v_lshlrev_b32 v18, 16, v17
    v_and_b32 v19, 0xffff0000, v17
    v_mul_f32 v20, s47, v18
    v_mul_f32 v21, s47, v19
    v_exp_f32 v20, -v20
    v_exp_f32 v21, -v21
    s_nop 0
    v_add_f32 v20, 1.0, v20
    v_add_f32 v21, 1.0, v21
    v_rcp_f32 v20, v20
    v_rcp_f32 v21, v21
    s_nop 0
    v_mul_f32 v18, v18, v20
    v_mul_f32 v19, v19, v21
    v_cvt_pk_bf16_f32 v23, v18, v19
    s_mov_b32 s35, 55296
    buffer_store_dwordx2 v[22:23], v12, s[20:23], s35 offen offset:32
    s_nop 1
    s_mov_b64 exec, s[44:45]
    v_add_u32 v14, 32, v13
    v_cmp_gt_u32 vcc, 216, v14
    s_and_saveexec_b64 s[44:45], vcc
    v_cvt_pk_bf16_f32 v16, v104, v105
    v_cvt_pk_bf16_f32 v17, v106, v107
    v_lshlrev_b32 v18, 16, v16
    v_and_b32 v19, 0xffff0000, v16
    v_mul_f32 v20, s47, v18
    v_mul_f32 v21, s47, v19
    v_exp_f32 v20, -v20
    v_exp_f32 v21, -v21
    s_nop 0
    v_add_f32 v20, 1.0, v20
    v_add_f32 v21, 1.0, v21
    v_rcp_f32 v20, v20
    v_rcp_f32 v21, v21
    s_nop 0
    v_mul_f32 v18, v18, v20
    v_mul_f32 v19, v19, v21
    v_cvt_pk_bf16_f32 v22, v18, v19
    v_lshlrev_b32 v18, 16, v17
    v_and_b32 v19, 0xffff0000, v17
    v_mul_f32 v20, s47, v18
    v_mul_f32 v21, s47, v19
    v_exp_f32 v20, -v20
    v_exp_f32 v21, -v21
    s_nop 0
    v_add_f32 v20, 1.0, v20
    v_add_f32 v21, 1.0, v21
    v_rcp_f32 v20, v20
    v_rcp_f32 v21, v21
    s_nop 0
    v_mul_f32 v18, v18, v20
    v_mul_f32 v19, v19, v21
    v_cvt_pk_bf16_f32 v23, v18, v19
    s_mov_b32 s35, 0
    buffer_store_dwordx2 v[22:23], v12, s[20:23], s35 offen offset:64
    s_nop 1
    v_cvt_pk_bf16_f32 v16, v120, v121
    v_cvt_pk_bf16_f32 v17, v122, v123
    v_lshlrev_b32 v18, 16, v16
    v_and_b32 v19, 0xffff0000, v16
    v_mul_f32 v20, s47, v18
    v_mul_f32 v21, s47, v19
    v_exp_f32 v20, -v20
    v_exp_f32 v21, -v21
    s_nop 0
    v_add_f32 v20, 1.0, v20
    v_add_f32 v21, 1.0, v21
    v_rcp_f32 v20, v20
    v_rcp_f32 v21, v21
    s_nop 0
    v_mul_f32 v18, v18, v20
    v_mul_f32 v19, v19, v21
    v_cvt_pk_bf16_f32 v22, v18, v19
    v_lshlrev_b32 v18, 16, v17
    v_and_b32 v19, 0xffff0000, v17
    v_mul_f32 v20, s47, v18
    v_mul_f32 v21, s47, v19
    v_exp_f32 v20, -v20
    v_exp_f32 v21, -v21
    s_nop 0
    v_add_f32 v20, 1.0, v20
    v_add_f32 v21, 1.0, v21
    v_rcp_f32 v20, v20
    v_rcp_f32 v21, v21
    s_nop 0
    v_mul_f32 v18, v18, v20
    v_mul_f32 v19, v19, v21
    v_cvt_pk_bf16_f32 v23, v18, v19
    s_mov_b32 s35, 55296
    buffer_store_dwordx2 v[22:23], v12, s[20:23], s35 offen offset:64
    s_nop 1
    s_mov_b64 exec, s[44:45]
    v_add_u32 v14, 48, v13
    v_cmp_gt_u32 vcc, 216, v14
    s_and_saveexec_b64 s[44:45], vcc
    v_cvt_pk_bf16_f32 v16, v108, v109
    v_cvt_pk_bf16_f32 v17, v110, v111
    v_lshlrev_b32 v18, 16, v16
    v_and_b32 v19, 0xffff0000, v16
    v_mul_f32 v20, s47, v18
    v_mul_f32 v21, s47, v19
    v_exp_f32 v20, -v20
    v_exp_f32 v21, -v21
    s_nop 0
    v_add_f32 v20, 1.0, v20
    v_add_f32 v21, 1.0, v21
    v_rcp_f32 v20, v20
    v_rcp_f32 v21, v21
    s_nop 0
    v_mul_f32 v18, v18, v20
    v_mul_f32 v19, v19, v21
    v_cvt_pk_bf16_f32 v22, v18, v19
    v_lshlrev_b32 v18, 16, v17
    v_and_b32 v19, 0xffff0000, v17
    v_mul_f32 v20, s47, v18
    v_mul_f32 v21, s47, v19
    v_exp_f32 v20, -v20
    v_exp_f32 v21, -v21
    s_nop 0
    v_add_f32 v20, 1.0, v20
    v_add_f32 v21, 1.0, v21
    v_rcp_f32 v20, v20
    v_rcp_f32 v21, v21
    s_nop 0
    v_mul_f32 v18, v18, v20
    v_mul_f32 v19, v19, v21
    v_cvt_pk_bf16_f32 v23, v18, v19
    s_mov_b32 s35, 0
    buffer_store_dwordx2 v[22:23], v12, s[20:23], s35 offen offset:96
    s_nop 1
    v_cvt_pk_bf16_f32 v16, v124, v125
    v_cvt_pk_bf16_f32 v17, v126, v127
    v_lshlrev_b32 v18, 16, v16
    v_and_b32 v19, 0xffff0000, v16
    v_mul_f32 v20, s47, v18
    v_mul_f32 v21, s47, v19
    v_exp_f32 v20, -v20
    v_exp_f32 v21, -v21
    s_nop 0
    v_add_f32 v20, 1.0, v20
    v_add_f32 v21, 1.0, v21
    v_rcp_f32 v20, v20
    v_rcp_f32 v21, v21
    s_nop 0
    v_mul_f32 v18, v18, v20
    v_mul_f32 v19, v19, v21
    v_cvt_pk_bf16_f32 v22, v18, v19
    v_lshlrev_b32 v18, 16, v17
    v_and_b32 v19, 0xffff0000, v17
    v_mul_f32 v20, s47, v18
    v_mul_f32 v21, s47, v19
    v_exp_f32 v20, -v20
    v_exp_f32 v21, -v21
    s_nop 0
    v_add_f32 v20, 1.0, v20
    v_add_f32 v21, 1.0, v21
    v_rcp_f32 v20, v20
    v_rcp_f32 v21, v21
    s_nop 0
    v_mul_f32 v18, v18, v20
    v_mul_f32 v19, v19, v21
    v_cvt_pk_bf16_f32 v23, v18, v19
    s_mov_b32 s35, 55296
    buffer_store_dwordx2 v[22:23], v12, s[20:23], s35 offen offset:96
    s_nop 1
    s_mov_b64 exec, s[44:45]
L_k3_end:
    s_endpgm

.text
.globl hh_k4_kernel
.p2align 8
.type hh_k4_kernel,@function
hh_k4_kernel:
    s_cmp_ge_u32 s2, 256
    s_cbranch_scc1 L_hh_k4_kernel_end
    s_load_dwordx2 s[4:5], s[0:1], 48
    s_load_dwordx2 s[6:7], s[0:1], 72
    s_load_dwordx2 s[38:39], s[0:1], 56
    s_load_dwordx2 s[40:41], s[0:1], 72
    s_and_b32 s28, s2, 7
    s_lshl_b32 s28, s28, 2
    s_bfe_u32 s29, s2, 0x20003
    s_add_u32 s28, s28, s29
    s_lshr_b32 s29, s2, 5
    v_and_b32 v1, 63, v0
    v_lshrrev_b32 v2, 4, v1
    v_and_b32 v3, 15, v1
    v_lshrrev_b32 v4, 6, v0
    s_nop 0
    v_readfirstlane_b32 s30, v4
    s_mul_i32 s33, s30, 320
    s_mul_i32 s34, s29, 160
    v_add_u32 v12, s33, v1
    v_mul_u32_u24 v13, 6554, v12
    v_lshrrev_b32 v13, 16, v13
    v_mul_u32_u24 v14, 10, v13
    v_sub_u32 v14, v12, v14
    v_mul_u32_u24 v4, 1280, v13
    v_lshl_add_u32 v4, v14, 4, v4
    v_add_u32 v4, s34, v4
    v_add_u32 v12, s33, v1
    v_add_u32 v12, 64, v12
    v_mul_u32_u24 v13, 6554, v12
    v_lshrrev_b32 v13, 16, v13
    v_mul_u32_u24 v14, 10, v13
    v_sub_u32 v14, v12, v14
    v_mul_u32_u24 v5, 1280, v13
    v_lshl_add_u32 v5, v14, 4, v5
    v_add_u32 v5, s34, v5
    v_add_u32 v12, s33, v1
    v_add_u32 v12, 128, v12
    v_mul_u32_u24 v13, 6554, v12
    v_lshrrev_b32 v13, 16, v13
    v_mul_u32_u24 v14, 10, v13
    v_sub_u32 v14, v12, v14
    v_mul_u32_u24 v6, 1280, v13
    v_lshl_add_u32 v6, v14, 4, v6
    v_add_u32 v6, s34, v6
    v_add_u32 v12, s33, v1
    v_add_u32 v12, 192, v12
    v_mul_u32_u24 v13, 6554, v12
    v_lshrrev_b32 v13, 16, v13
    v_mul_u32_u24 v14, 10, v13
    v_sub_u32 v14, v12, v14
    v_mul_u32_u24 v7, 1280, v13
    v_lshl_add_u32 v7, v14, 4, v7
    v_add_u32 v7, s34, v7
    v_add_u32 v12, s33, v1
    v_add_u32 v12, 256, v12
    v_mul_u32_u24 v13, 6554, v12
    v_lshrrev_b32 v13, 16, v13
    v_mul_u32_u24 v14, 10, v13
    v_sub_u32 v14, v12, v14
    v_mul_u32_u24 v8, 1280, v13
    v_lshl_add_u32 v8, v14, 4, v8
    v_add_u32 v8, s34, v8
    s_lshl_b32 s33, s28, 6
    s_lshl_b32 s34, s30, 4
    s_add_u32 s33, s33, s34
    v_add_u32 v12, 0, v2
    v_xor_b32 v13, v12, v3
    v_add_u32 v12, s33, v12
    v_mul_u32_u24 v20, 3456, v12
    v_lshl_add_u32 v20, v13, 4, v20
    v_add_u32 v12, 4, v2
    v_xor_b32 v13, v12, v3
    v_add_u32 v12, s33, v12
    v_mul_u32_u24 v21, 3456, v12
    v_lshl_add_u32 v21, v13, 4, v21
    v_add_u32 v12, 8, v2
    v_xor_b32 v13, v12, v3
    v_add_u32 v12, s33, v12
    v_mul_u32_u24 v22, 3456, v12
    v_lshl_add_u32 v22, v13, 4, v22
    v_add_u32 v12, 12, v2
    v_xor_b32 v13, v12, v3
    v_add_u32 v12, s33, v12
    v_mul_u32_u24 v23, 3456, v12
    v_lshl_add_u32 v23, v13, 4, v23
    s_waitcnt lgkmcnt(0)
    s_add_u32 s8, s40, 0x1000000
    s_addc_u32 s9, s41, 0
    s_mov_b32 s10, 0x6c0000
    s_mov_b32 s11, 0x00020000
    s_mov_b32 s12, s4
    s_mov_b32 s13, s5
    s_mov_b32 s14, 0x21c000
    s_mov_b32 s15, 0x00020000
    s_add_u32 s16, s6, 0xd00000
    s_addc_u32 s17, s7, 0
    s_mov_b32 s18, 0x280000
    s_mov_b32 s19, 0x00020000
    s_mov_b32 s20, s38
    s_mov_b32 s21, s39
    s_mov_b32 s22, 0x280000
    s_mov_b32 s23, 0x00020000
    s_lshl_b32 s35, s30, 10
    s_mul_i32 s42, s30, 5120
    s_mov_b32 s36, 0x0
    s_add_u32 s37, s42, 16384
    s_mov_b32 m0, s37
    s_nop 0
    buffer_load_dwordx4 v4, s[12:15], s36 offen lds
    s_add_u32 s37, s37, 1024
    s_mov_b32 m0, s37
    s_nop 0
    buffer_load_dwordx4 v5, s[12:15], s36 offen lds
    s_add_u32 s37, s37, 1024
    s_mov_b32 m0, s37
    s_nop 0
    buffer_load_dwordx4 v6, s[12:15], s36 offen lds
    s_add_u32 s37, s37, 1024
    s_mov_b32 m0, s37
    s_nop 0
    buffer_load_dwordx4 v7, s[12:15], s36 offen lds
    s_add_u32 s37, s37, 1024
    s_mov_b32 m0, s37
    s_nop 0
    buffer_load_dwordx4 v8, s[12:15], s36 offen lds
    s_mov_b32 s36, 0x0
    s_lshl_b32 s37, s35, 2
    s_add_u32 s37, s37, 0
    s_mov_b32 m0, s37
    s_nop 0
    buffer_load_dwordx4 v20, s[8:11], s36 offen lds
    s_add_u32 s37, s37, 1024
    s_mov_b32 m0, s37
    s_nop 0
    buffer_load_dwordx4 v21, s[8:11], s36 offen lds
    s_add_u32 s37, s37, 1024
    s_mov_b32 m0, s37
    s_nop 0
    buffer_load_dwordx4 v22, s[8:11], s36 offen lds
    s_add_u32 s37, s37, 1024
    s_mov_b32 m0, s37
    s_nop 0
    buffer_load_dwordx4 v23, s[8:11], s36 offen lds
    s_mov_b32 s36, 0x28000
    s_add_u32 s37, s42, 53248
    s_mov_b32 m0, s37
    s_nop 0
    buffer_load_dwordx4 v4, s[12:15], s36 offen lds
    s_add_u32 s37, s37, 1024
    s_mov_b32 m0, s37
    s_nop 0
    buffer_load_dwordx4 v5, s[12:15], s36 offen lds
    s_add_u32 s37, s37, 1024
    s_mov_b32 m0, s37
    s_nop 0
    buffer_load_dwordx4 v6, s[12:15], s36 offen lds
    s_add_u32 s37, s37, 1024
    s_mov_b32 m0, s37
    s_nop 0
    buffer_load_dwordx4 v7, s[12:15], s36 offen lds
    s_add_u32 s37, s37, 1024
    s_mov_b32 m0, s37
    s_nop 0
    buffer_load_dwordx4 v8, s[12:15], s36 offen lds
    s_mov_b32 s36, 0x100
    s_lshl_b32 s37, s35, 2
    s_add_u32 s37, s37, 36864
    s_mov_b32 m0, s37
    s_nop 0
    buffer_load_dwordx4 v20, s[8:11], s36 offen lds
    s_add_u32 s37, s37, 1024
    s_mov_b32 m0, s37
    s_nop 0
    buffer_load_dwordx4 v21, s[8:11], s36 offen lds
    s_add_u32 s37, s37, 1024
    s_mov_b32 m0, s37
    s_nop 0
    buffer_load_dwordx4 v22, s[8:11], s36 offen lds
    s_add_u32 s37, s37, 1024
    s_mov_b32 m0, s37
    s_nop 0
    buffer_load_dwordx4 v23, s[8:11], s36 offen lds
    s_mov_b32 s36, 0x50000
    s_add_u32 s37, s42, 90112
    s_mov_b32 m0, s37
    s_nop 0
    buffer_load_dwordx4 v4, s[12:15], s36 offen lds
    s_add_u32 s37, s37, 1024
    s_mov_b32 m0, s37
    s_nop 0
    buffer_load_dwordx4 v5, s[12:15], s36 offen lds
    s_add_u32 s37, s37, 1024
    s_mov_b32 m0, s37
    s_nop 0
    buffer_load_dwordx4 v6, s[12:15], s36 offen lds
    s_add_u32 s37, s37, 1024
    s_mov_b32 m0, s37
    s_nop 0
    buffer_load_dwordx4 v7, s[12:15], s36 offen lds
    s_add_u32 s37, s37, 1024
    s_mov_b32 m0, s37
    s_nop 0
    buffer_load_dwordx4 v8, s[12:15], s36 offen lds
    s_mov_b32 s36, 0x200
    s_lshl_b32 s37, s35, 2
    s_add_u32 s37, s37, 73728
    s_mov_b32 m0, s37
    s_nop 0
    buffer_load_dwordx4 v20, s[8:11], s36 offen lds
    s_add_u32 s37, s37, 1024
    s_mov_b32 m0, s37
    s_nop 0
    buffer_load_dwordx4 v21, s[8:11], s36 offen lds
    s_add_u32 s37, s37, 1024
    s_mov_b32 m0, s37
    s_nop 0
    buffer_load_dwordx4 v22, s[8:11], s36 offen lds
    s_add_u32 s37, s37, 1024
    s_mov_b32 m0, s37
    s_nop 0
    buffer_load_dwordx4 v23, s[8:11], s36 offen lds
    s_mov_b32 s36, 0x78000
    s_add_u32 s37, s42, 126976
    s_mov_b32 m0, s37
    s_nop 0
    buffer_load_dwordx4 v4, s[12:15], s36 offen lds
    s_add_u32 s37, s37, 1024
    s_mov_b32 m0, s37
    s_nop 0
    buffer_load_dwordx4 v5, s[12:15], s36 offen lds
    s_add_u32 s37, s37, 1024
    s_mov_b32 m0, s37
    s_nop 0
    buffer_load_dwordx4 v6, s[12:15], s36 offen lds
    s_add_u32 s37, s37, 1024
    s_mov_b32 m0, s37
    s_nop 0
    buffer_load_dwordx4 v7, s[12:15], s36 offen lds
    s_add_u32 s37, s37, 1024
    s_mov_b32 m0, s37
    s_nop 0
    buffer_load_dwordx4 v8, s[12:15], s36 offen lds
    s_mov_b32 s36, 0x300
    s_lshl_b32 s37, s35, 2
    s_add_u32 s37, s37, 110592
    s_mov_b32 m0, s37
    s_nop 0
    buffer_load_dwordx4 v20, s[8:11], s36 offen lds
    s_add_u32 s37, s37, 1024
    s_mov_b32 m0, s37
    s_nop 0
    buffer_load_dwordx4 v21, s[8:11], s36 offen lds
    s_add_u32 s37, s37, 1024
    s_mov_b32 m0, s37
    s_nop 0
    buffer_load_dwordx4 v22, s[8:11], s36 offen lds
    s_add_u32 s37, s37, 1024
    s_mov_b32 m0, s37
    s_nop 0
    buffer_load_dwordx4 v23, s[8:11], s36 offen lds
    v_add_u32 v9, s33, v3
    v_mul_u32_u24 v11, 1280, v9
    s_mul_i32 s34, s29, 160
    v_lshl_add_u32 v11, v2, 3, v11
    v_add_u32 v11, s34, v11
    buffer_load_dwordx2 v[96:97], v11, s[16:19], 0 offen offset:0
    buffer_load_dwordx2 v[98:99], v11, s[16:19], 0 offen offset:32
    buffer_load_dwordx2 v[100:101], v11, s[16:19], 0 offen offset:64
    buffer_load_dwordx2 v[102:103], v11, s[16:19], 0 offen offset:96
    buffer_load_dwordx2 v[104:105], v11, s[16:19], 0 offen offset:128
    v_lshrrev_b32 v12, 2, v3
    v_lshl_add_u32 v12, v2, 2, v12
    v_mul_u32_u24 v12, 160, v12
    v_and_b32 v13, 3, v3
    v_lshl_add_u32 v12, v13, 3, v12
    v_add_u32 v12, 16384, v12
    v_lshrrev_b32 v13, 1, v2
    v_and_b32 v14, 1, v2
    s_lshl_b32 s34, s30, 12
    v_lshl_add_u32 v15, v3, 8, s34
    v_lshl_add_u32 v15, v14, 3, v15
    v_add_u32 v24, 0, v13
    v_xor_b32 v24, v24, v3
    v_lshl_add_u32 v24, v24, 4, v15
    v_add_u32 v25, 2, v13
    v_xor_b32 v25, v25, v3
    v_lshl_add_u32 v25, v25, 4, v15
    v_add_u32 v26, 4, v13
    v_xor_b32 v26, v26, v3
    v_lshl_add_u32 v26, v26, 4, v15
    v_add_u32 v27, 6, v13
    v_xor_b32 v27, v27, v3
    v_lshl_add_u32 v27, v27, 4, v15
    v_add_u32 v28, 8, v13
    v_xor_b32 v28, v28, v3
    v_lshl_add_u32 v28, v28, 4, v15
    v_add_u32 v29, 10, v13
    v_xor_b32 v29, v29, v3
    v_lshl_add_u32 v29, v29, 4, v15
    v_add_u32 v30, 12, v13
    v_xor_b32 v30, v30, v3
    v_lshl_add_u32 v30, v30, 4, v15
    v_add_u32 v31, 14, v13
    v_xor_b32 v31, v31, v3
    v_lshl_add_u32 v31, v31, 4, v15
    v_add_u32 v120, 73728, v24
    v_add_u32 v121, 73728, v25
    v_add_u32 v122, 73728, v26
    v_add_u32 v123, 73728, v27
    v_add_u32 v124, 73728, v28
    v_add_u32 v125, 73728, v29
    v_add_u32 v126, 73728, v30
    v_add_u32 v127, 73728, v31
    v_add_u32 v10, 73728, v12
    v_mov_b32 v32, 0
    v_mov_b32 v33, 0
    v_mov_b32 v34, 0
    v_mov_b32 v35, 0
    v_mov_b32 v36, 0
    v_mov_b32 v37, 0
    v_mov_b32 v38, 0
    v_mov_b32 v39, 0
    v_mov_b32 v40, 0
    v_mov_b32 v41, 0
    v_mov_b32 v42, 0
    v_mov_b32 v43, 0
    v_mov_b32 v44, 0
    v_mov_b32 v45, 0
    v_mov_b32 v46, 0
    v_mov_b32 v47, 0
    v_mov_b32 v48, 0
    v_mov_b32 v49, 0
    v_mov_b32 v50, 0
    v_mov_b32 v51, 0
    s_waitcnt vmcnt(32)
    s_barrier
    ds_read_b64 v[108:109], v24 offset:0
    ds_read_b64 v[110:111], v25 offset:0
    ds_read_b64_tr_b16 v[52:53], v12 offset:0
    ds_read_b64_tr_b16 v[54:55], v12 offset:2560
    ds_read_b64_tr_b16 v[56:57], v12 offset:32
    ds_read_b64_tr_b16 v[58:59], v12 offset:2592
    ds_read_b64_tr_b16 v[60:61], v12 offset:64
    ds_read_b64_tr_b16 v[62:63], v12 offset:2624
    ds_read_b64_tr_b16 v[64:65], v12 offset:96
    ds_read_b64_tr_b16 v[66:67], v12 offset:2656
    ds_read_b64_tr_b16 v[68:69], v12 offset:128
    ds_read_b64_tr_b16 v[70:71], v12 offset:2688
    s_waitcnt lgkmcnt(0)
    ds_read_b64 v[112:113], v26 offset:0
    ds_read_b64 v[114:115], v27 offset:0
    ds_read_b64_tr_b16 v[72:73], v12 offset:5120
    ds_read_b64_tr_b16 v[74:75], v12 offset:7680
    ds_read_b64_tr_b16 v[76:77], v12 offset:5152
    ds_read_b64_tr_b16 v[78:79], v12 offset:7712
    ds_read_b64_tr_b16 v[80:81], v12 offset:5184
    ds_read_b64_tr_b16 v[82:83], v12 offset:7744
    ds_read_b64_tr_b16 v[84:85], v12 offset:5216
    ds_read_b64_tr_b16 v[86:87], v12 offset:7776
    ds_read_b64_tr_b16 v[88:89], v12 offset:5248
    ds_read_b64_tr_b16 v[90:91], v12 offset:7808
    v_mfma_f32_16x16x32_bf16 v[32:35], v[52:55], v[108:111], v[32:35]
    v_mfma_f32_16x16x32_bf16 v[36:39], v[56:59], v[108:111], v[36:39]
    v_mfma_f32_16x16x32_bf16 v[40:43], v[60:63], v[108:111], v[40:43]
    v_mfma_f32_16x16x32_bf16 v[44:47], v[64:67], v[108:111], v[44:47]
    v_mfma_f32_16x16x32_bf16 v[48:51], v[68:71], v[108:111], v[48:51]
    s_waitcnt lgkmcnt(0)
    ds_read_b64 v[108:109], v28 offset:0
    ds_read_b64 v[110:111], v29 offset:0
    ds_read_b64_tr_b16 v[52:53], v12 offset:10240
    ds_read_b64_tr_b16 v[54:55], v12 offset:12800
    ds_read_b64_tr_b16 v[56:57], v12 offset:10272
    ds_read_b64_tr_b16 v[58:59], v12 offset:12832
    ds_read_b64_tr_b16 v[60:61], v12 offset:10304
    ds_read_b64_tr_b16 v[62:63], v12 offset:12864
    ds_read_b64_tr_b16 v[64:65], v12 offset:10336
    ds_read_b64_tr_b16 v[66:67], v12 offset:12896
    ds_read_b64_tr_b16 v[68:69], v12 offset:10368
    ds_read_b64_tr_b16 v[70:71], v12 offset:12928
    v_mfma_f32_16x16x32_bf16 v[32:35], v[72:75], v[112:115], v[32:35]
    v_mfma_f32_16x16x32_bf16 v[36:39], v[76:79], v[112:115], v[36:39]
    v_mfma_f32_16x16x32_bf16 v[40:43], v[80:83], v[112:115], v[40:43]
    v_mfma_f32_16x16x32_bf16 v[44:47], v[84:87], v[112:115], v[44:47]
    v_mfma_f32_16x16x32_bf16 v[48:51], v[88:91], v[112:115], v[48:51]
    s_waitcnt lgkmcnt(0)
    ds_read_b64 v[112:113], v30 offset:0
    ds_read_b64 v[114:115], v31 offset:0
    ds_read_b64_tr_b16 v[72:73], v12 offset:15360
    ds_read_b64_tr_b16 v[74:75], v12 offset:17920
    ds_read_b64_tr_b16 v[76:77], v12 offset:15392
    ds_read_b64_tr_b16 v[78:79], v12 offset:17952
    ds_read_b64_tr_b16 v[80:81], v12 offset:15424
    ds_read_b64_tr_b16 v[82:83], v12 offset:17984
    ds_read_b64_tr_b16 v[84:85], v12 offset:15456
    ds_read_b64_tr_b16 v[86:87], v12 offset:18016
    ds_read_b64_tr_b16 v[88:89], v12 offset:15488
    ds_read_b64_tr_b16 v[90:91], v12 offset:18048
    v_mfma_f32_16x16x32_bf16 v[32:35], v[52:55], v[108:111], v[32:35]
    v_mfma_f32_16x16x32_bf16 v[36:39], v[56:59], v[108:111], v[36:39]
    v_mfma_f32_16x16x32_bf16 v[40:43], v[60:63], v[108:111], v[40:43]
    v_mfma_f32_16x16x32_bf16 v[44:47], v[64:67], v[108:111], v[44:47]
    v_mfma_f32_16x16x32_bf16 v[48:51], v[68:71], v[108:111], v[48:51]
    s_waitcnt lgkmcnt(0)
    s_waitcnt vmcnt(23)
    s_barrier
    s_mov_b32 s36, 0xa0000
    s_add_u32 s37, s42, 16384
    s_mov_b32 m0, s37
    s_nop 0
    buffer_load_dwordx4 v4, s[12:15], s36 offen lds
    s_add_u32 s37, s37, 1024
    s_mov_b32 m0, s37
    s_nop 0
    buffer_load_dwordx4 v5, s[12:15], s36 offen lds
    s_add_u32 s37, s37, 1024
    s_mov_b32 m0, s37
    s_nop 0
    buffer_load_dwordx4 v6, s[12:15], s36 offen lds
    s_add_u32 s37, s37, 1024
    s_mov_b32 m0, s37
    s_nop 0
    buffer_load_dwordx4 v7, s[12:15], s36 offen lds
    s_add_u32 s37, s37, 1024
    s_mov_b32 m0, s37
    s_nop 0
    buffer_load_dwordx4 v8, s[12:15], s36 offen lds
    s_mov_b32 s36, 0x400
    s_lshl_b32 s37, s35, 2
    s_add_u32 s37, s37, 0
    s_mov_b32 m0, s37
    s_nop 0
    buffer_load_dwordx4 v20, s[8:11], s36 offen lds
    s_add_u32 s37, s37, 1024
    s_mov_b32 m0, s37
    s_nop 0
    buffer_load_dwordx4 v21, s[8:11], s36 offen lds
    s_add_u32 s37, s37, 1024
    s_mov_b32 m0, s37
    s_nop 0
    buffer_load_dwordx4 v22, s[8:11], s36 offen lds
    s_add_u32 s37, s37, 1024
    s_mov_b32 m0, s37
    s_nop 0
    buffer_load_dwordx4 v23, s[8:11], s36 offen lds
    ds_read_b64 v[108:109], v24 offset:36864
    ds_read_b64 v[110:111], v25 offset:36864
    ds_read_b64_tr_b16 v[52:53], v12 offset:36864
    ds_read_b64_tr_b16 v[54:55], v12 offset:39424
    ds_read_b64_tr_b16 v[56:57], v12 offset:36896
    ds_read_b64_tr_b16 v[58:59], v12 offset:39456
    ds_read_b64_tr_b16 v[60:61], v12 offset:36928
    ds_read_b64_tr_b16 v[62:63], v12 offset:39488
    ds_read_b64_tr_b16 v[64:65], v12 offset:36960
    ds_read_b64_tr_b16 v[66:67], v12 offset:39520
    ds_read_b64_tr_b16 v[68:69], v12 offset:36992
    ds_read_b64_tr_b16 v[70:71], v12 offset:39552
    v_mfma_f32_16x16x32_bf16 v[32:35], v[72:75], v[112:115], v[32:35]
    v_mfma_f32_16x16x32_bf16 v[36:39], v[76:79], v[112:115], v[36:39]
    v_mfma_f32_16x16x32_bf16 v[40:43], v[80:83], v[112:115], v[40:43]
    v_mfma_f32_16x16x32_bf16 v[44:47], v[84:87], v[112:115], v[44:47]
    v_mfma_f32_16x16x32_bf16 v[48:51], v[88:91], v[112:115], v[48:51]
    s_waitcnt lgkmcnt(0)
    ds_read_b64 v[112:113], v26 offset:36864
    ds_read_b64 v[114:115], v27 offset:36864
    ds_read_b64_tr_b16 v[72:73], v12 offset:41984
    ds_read_b64_tr_b16 v[74:75], v12 offset:44544
    ds_read_b64_tr_b16 v[76:77], v12 offset:42016
    ds_read_b64_tr_b16 v[78:79], v12 offset:44576
    ds_read_b64_tr_b16 v[80:81], v12 offset:42048
    ds_read_b64_tr_b16 v[82:83], v12 offset:44608
    ds_read_b64_tr_b16 v[84:85], v12 offset:42080
    ds_read_b64_tr_b16 v[86:87], v12 offset:44640
    ds_read_b64_tr_b16 v[88:89], v12 offset:42112
    ds_read_b64_tr_b16 v[90:91], v12 offset:44672
    v_mfma_f32_16x16x32_bf16 v[32:35], v[52:55], v[108:111], v[32:35]
    v_mfma_f32_16x16x32_bf16 v[36:39], v[56:59], v[108:111], v[36:39]
    v_mfma_f32_16x16x32_bf16 v[40:43], v[60:63], v[108:111], v[40:43]
    v_mfma_f32_16x16x32_bf16 v[44:47], v[64:67], v[108:111], v[44:47]
    v_mfma_f32_16x16x32_bf16 v[48:51], v[68:71], v[108:111], v[48:51]
    s_waitcnt lgkmcnt(0)
    ds_read_b64 v[108:109], v28 offset:36864
    ds_read_b64 v[110:111], v29 offset:36864
    ds_read_b64_tr_b16 v[52:53], v12 offset:47104
    ds_read_b64_tr_b16 v[54:55], v12 offset:49664
    ds_read_b64_tr_b16 v[56:57], v12 offset:47136
    ds_read_b64_tr_b16 v[58:59], v12 offset:49696
    ds_read_b64_tr_b16 v[60:61], v12 offset:47168
    ds_read_b64_tr_b16 v[62:63], v12 offset:49728
    ds_read_b64_tr_b16 v[64:65], v12 offset:47200
    ds_read_b64_tr_b16 v[66:67], v12 offset:49760
    ds_read_b64_tr_b16 v[68:69], v12 offset:47232
    ds_read_b64_tr_b16 v[70:71], v12 offset:49792
    v_mfma_f32_16x16x32_bf16 v[32:35], v[72:75], v[112:115], v[32:35]
    v_mfma_f32_16x16x32_bf16 v[36:39], v[76:79], v[112:115], v[36:39]
    v_mfma_f32_16x16x32_bf16 v[40:43], v[80:83], v[112:115], v[40:43]
    v_mfma_f32_16x16x32_bf16 v[44:47], v[84:87], v[112:115], v[44:47]
    v_mfma_f32_16x16x32_bf16 v[48:51], v[88:91], v[112:115], v[48:51]
    s_waitcnt lgkmcnt(0)
    ds_read_b64 v[112:113], v30 offset:36864
    ds_read_b64 v[114:115], v31 offset:36864
    ds_read_b64_tr_b16 v[72:73], v12 offset:52224
    ds_read_b64_tr_b16 v[74:75], v12 offset:54784
    ds_read_b64_tr_b16 v[76:77], v12 offset:52256
    ds_read_b64_tr_b16 v[78:79], v12 offset:54816
    ds_read_b64_tr_b16 v[80:81], v12 offset:52288
    ds_read_b64_tr_b16 v[82:83], v12 offset:54848
    ds_read_b64_tr_b16 v[84:85], v12 offset:52320
    ds_read_b64_tr_b16 v[86:87], v12 offset:54880
    ds_read_b64_tr_b16 v[88:89], v12 offset:52352
    ds_read_b64_tr_b16 v[90:91], v12 offset:54912
    v_mfma_f32_16x16x32_bf16 v[32:35], v[52:55], v[108:111], v[32:35]
    v_mfma_f32_16x16x32_bf16 v[36:39], v[56:59], v[108:111], v[36:39]
    v_mfma_f32_16x16x32_bf16 v[40:43], v[60:63], v[108:111], v[40:43]
    v_mfma_f32_16x16x32_bf16 v[44:47], v[64:67], v[108:111], v[44:47]
    v_mfma_f32_16x16x32_bf16 v[48:51], v[68:71], v[108:111], v[48:51]
    s_waitcnt lgkmcnt(0)
    s_waitcnt vmcnt(23)
    s_barrier
    s_mov_b32 s36, 0xc8000
    s_add_u32 s37, s42, 53248
    s_mov_b32 m0, s37
    s_nop 0
    buffer_load_dwordx4 v4, s[12:15], s36 offen lds
    s_add_u32 s37, s37, 1024
    s_mov_b32 m0, s37
    s_nop 0
    buffer_load_dwordx4 v5, s[12:15], s36 offen lds
    s_add_u32 s37, s37, 1024
    s_mov_b32 m0, s37
    s_nop 0
    buffer_load_dwordx4 v6, s[12:15], s36 offen lds
    s_add_u32 s37, s37, 1024
    s_mov_b32 m0, s37
    s_nop 0
    buffer_load_dwordx4 v7, s[12:15], s36 offen lds
    s_add_u32 s37, s37, 1024
    s_mov_b32 m0, s37
    s_nop 0
    buffer_load_dwordx4 v8, s[12:15], s36 offen lds
    s_mov_b32 s36, 0x500
    s_lshl_b32 s37, s35, 2
    s_add_u32 s37, s37, 36864
    s_mov_b32 m0, s37
    s_nop 0
    buffer_load_dwordx4 v20, s[8:11], s36 offen lds
    s_add_u32 s37, s37, 1024
    s_mov_b32 m0, s37
    s_nop 0
    buffer_load_dwordx4 v21, s[8:11], s36 offen lds
    s_add_u32 s37, s37, 1024
    s_mov_b32 m0, s37
    s_nop 0
    buffer_load_dwordx4 v22, s[8:11], s36 offen lds
    s_add_u32 s37, s37, 1024
    s_mov_b32 m0, s37
    s_nop 0
    buffer_load_dwordx4 v23, s[8:11], s36 offen lds
    ds_read_b64 v[108:109], v120 offset:0
    ds_read_b64 v[110:111], v121 offset:0
    ds_read_b64_tr_b16 v[52:53], v10 offset:0
    ds_read_b64_tr_b16 v[54:55], v10 offset:2560
    ds_read_b64_tr_b16 v[56:57], v10 offset:32
    ds_read_b64_tr_b16 v[58:59], v10 offset:2592
    ds_read_b64_tr_b16 v[60:61], v10 offset:64
    ds_read_b64_tr_b16 v[62:63], v10 offset:2624
    ds_read_b64_tr_b16 v[64:65], v10 offset:96
    ds_read_b64_tr_b16 v[66:67], v10 offset:2656
    ds_read_b64_tr_b16 v[68:69], v10 offset:128
    ds_read_b64_tr_b16 v[70:71], v10 offset:2688
    v_mfma_f32_16x16x32_bf16 v[32:35], v[72:75], v[112:115], v[32:35]
    v_mfma_f32_16x16x32_bf16 v[36:39], v[76:79], v[112:115], v[36:39]
    v_mfma_f32_16x16x32_bf16 v[40:43], v[80:83], v[112:115], v[40:43]
    v_mfma_f32_16x16x32_bf16 v[44:47], v[84:87], v[112:115], v[44:47]
    v_mfma_f32_16x16x32_bf16 v[48:51], v[88:91], v[112:115], v[48:51]
    s_waitcnt lgkmcnt(0)
    ds_read_b64 v[112:113], v122 offset:0
    ds_read_b64 v[114:115], v123 offset:0
    ds_read_b64_tr_b16 v[72:73], v10 offset:5120
    ds_read_b64_tr_b16 v[74:75], v10 offset:7680
    ds_read_b64_tr_b16 v[76:77], v10 offset:5152
    ds_read_b64_tr_b16 v[78:79], v10 offset:7712
    ds_read_b64_tr_b16 v[80:81], v10 offset:5184
    ds_read_b64_tr_b16 v[82:83], v10 offset:7744
    ds_read_b64_tr_b16 v[84:85], v10 offset:5216
    ds_read_b64_tr_b16 v[86:87], v10 offset:7776
    ds_read_b64_tr_b16 v[88:89], v10 offset:5248
    ds_read_b64_tr_b16 v[90:91], v10 offset:7808
    v_mfma_f32_16x16x32_bf16 v[32:35], v[52:55], v[108:111], v[32:35]
    v_mfma_f32_16x16x32_bf16 v[36:39], v[56:59], v[108:111], v[36:39]
    v_mfma_f32_16x16x32_bf16 v[40:43], v[60:63], v[108:111], v[40:43]
    v_mfma_f32_16x16x32_bf16 v[44:47], v[64:67], v[108:111], v[44:47]
    v_mfma_f32_16x16x32_bf16 v[48:51], v[68:71], v[108:111], v[48:51]
    s_waitcnt lgkmcnt(0)
    ds_read_b64 v[108:109], v124 offset:0
    ds_read_b64 v[110:111], v125 offset:0
    ds_read_b64_tr_b16 v[52:53], v10 offset:10240
    ds_read_b64_tr_b16 v[54:55], v10 offset:12800
    ds_read_b64_tr_b16 v[56:57], v10 offset:10272
    ds_read_b64_tr_b16 v[58:59], v10 offset:12832
    ds_read_b64_tr_b16 v[60:61], v10 offset:10304
    ds_read_b64_tr_b16 v[62:63], v10 offset:12864
    ds_read_b64_tr_b16 v[64:65], v10 offset:10336
    ds_read_b64_tr_b16 v[66:67], v10 offset:12896
    ds_read_b64_tr_b16 v[68:69], v10 offset:10368
    ds_read_b64_tr_b16 v[70:71], v10 offset:12928
    v_mfma_f32_16x16x32_bf16 v[32:35], v[72:75], v[112:115], v[32:35]
    v_mfma_f32_16x16x32_bf16 v[36:39], v[76:79], v[112:115], v[36:39]
    v_mfma_f32_16x16x32_bf16 v[40:43], v[80:83], v[112:115], v[40:43]
    v_mfma_f32_16x16x32_bf16 v[44:47], v[84:87], v[112:115], v[44:47]
    v_mfma_f32_16x16x32_bf16 v[48:51], v[88:91], v[112:115], v[48:51]
    s_waitcnt lgkmcnt(0)
    ds_read_b64 v[112:113], v126 offset:0
    ds_read_b64 v[114:115], v127 offset:0
    ds_read_b64_tr_b16 v[72:73], v10 offset:15360
    ds_read_b64_tr_b16 v[74:75], v10 offset:17920
    ds_read_b64_tr_b16 v[76:77], v10 offset:15392
    ds_read_b64_tr_b16 v[78:79], v10 offset:17952
    ds_read_b64_tr_b16 v[80:81], v10 offset:15424
    ds_read_b64_tr_b16 v[82:83], v10 offset:17984
    ds_read_b64_tr_b16 v[84:85], v10 offset:15456
    ds_read_b64_tr_b16 v[86:87], v10 offset:18016
    ds_read_b64_tr_b16 v[88:89], v10 offset:15488
    ds_read_b64_tr_b16 v[90:91], v10 offset:18048
    v_mfma_f32_16x16x32_bf16 v[32:35], v[52:55], v[108:111], v[32:35]
    v_mfma_f32_16x16x32_bf16 v[36:39], v[56:59], v[108:111], v[36:39]
    v_mfma_f32_16x16x32_bf16 v[40:43], v[60:63], v[108:111], v[40:43]
    v_mfma_f32_16x16x32_bf16 v[44:47], v[64:67], v[108:111], v[44:47]
    v_mfma_f32_16x16x32_bf16 v[48:51], v[68:71], v[108:111], v[48:51]
    s_waitcnt lgkmcnt(0)
    s_waitcnt vmcnt(23)
    s_barrier
    s_mov_b32 s36, 0xf0000
    s_add_u32 s37, s42, 90112
    s_mov_b32 m0, s37
    s_nop 0
    buffer_load_dwordx4 v4, s[12:15], s36 offen lds
    s_add_u32 s37, s37, 1024
    s_mov_b32 m0, s37
    s_nop 0
    buffer_load_dwordx4 v5, s[12:15], s36 offen lds
    s_add_u32 s37, s37, 1024
    s_mov_b32 m0, s37
    s_nop 0
    buffer_load_dwordx4 v6, s[12:15], s36 offen lds
    s_add_u32 s37, s37, 1024
    s_mov_b32 m0, s37
    s_nop 0
    buffer_load_dwordx4 v7, s[12:15], s36 offen lds
    s_add_u32 s37, s37, 1024
    s_mov_b32 m0, s37
    s_nop 0
    buffer_load_dwordx4 v8, s[12:15], s36 offen lds
    s_mov_b32 s36, 0x600
    s_lshl_b32 s37, s35, 2
    s_add_u32 s37, s37, 73728
    s_mov_b32 m0, s37
    s_nop 0
    buffer_load_dwordx4 v20, s[8:11], s36 offen lds
    s_add_u32 s37, s37, 1024
    s_mov_b32 m0, s37
    s_nop 0
    buffer_load_dwordx4 v21, s[8:11], s36 offen lds
    s_add_u32 s37, s37, 1024
    s_mov_b32 m0, s37
    s_nop 0
    buffer_load_dwordx4 v22, s[8:11], s36 offen lds
    s_add_u32 s37, s37, 1024
    s_mov_b32 m0, s37
    s_nop 0
    buffer_load_dwordx4 v23, s[8:11], s36 offen lds
    ds_read_b64 v[108:109], v120 offset:36864
    ds_read_b64 v[110:111], v121 offset:36864
    ds_read_b64_tr_b16 v[52:53], v10 offset:36864
    ds_read_b64_tr_b16 v[54:55], v10 offset:39424
    ds_read_b64_tr_b16 v[56:57], v10 offset:36896
    ds_read_b64_tr_b16 v[58:59], v10 offset:39456
    ds_read_b64_tr_b16 v[60:61], v10 offset:36928
    ds_read_b64_tr_b16 v[62:63], v10 offset:39488
    ds_read_b64_tr_b16 v[64:65], v10 offset:36960
    ds_read_b64_tr_b16 v[66:67], v10 offset:39520
    ds_read_b64_tr_b16 v[68:69], v10 offset:36992
    ds_read_b64_tr_b16 v[70:71], v10 offset:39552
    v_mfma_f32_16x16x32_bf16 v[32:35], v[72:75], v[112:115], v[32:35]
    v_mfma_f32_16x16x32_bf16 v[36:39], v[76:79], v[112:115], v[36:39]
    v_mfma_f32_16x16x32_bf16 v[40:43], v[80:83], v[112:115], v[40:43]
    v_mfma_f32_16x16x32_bf16 v[44:47], v[84:87], v[112:115], v[44:47]
    v_mfma_f32_16x16x32_bf16 v[48:51], v[88:91], v[112:115], v[48:51]
    s_waitcnt lgkmcnt(0)
    ds_read_b64 v[112:113], v122 offset:36864
    ds_read_b64 v[114:115], v123 offset:36864
    ds_read_b64_tr_b16 v[72:73], v10 offset:41984
    ds_read_b64_tr_b16 v[74:75], v10 offset:44544
    ds_read_b64_tr_b16 v[76:77], v10 offset:42016
    ds_read_b64_tr_b16 v[78:79], v10 offset:44576
    ds_read_b64_tr_b16 v[80:81], v10 offset:42048
    ds_read_b64_tr_b16 v[82:83], v10 offset:44608
    ds_read_b64_tr_b16 v[84:85], v10 offset:42080
    ds_read_b64_tr_b16 v[86:87], v10 offset:44640
    ds_read_b64_tr_b16 v[88:89], v10 offset:42112
    ds_read_b64_tr_b16 v[90:91], v10 offset:44672
    v_mfma_f32_16x16x32_bf16 v[32:35], v[52:55], v[108:111], v[32:35]
    v_mfma_f32_16x16x32_bf16 v[36:39], v[56:59], v[108:111], v[36:39]
    v_mfma_f32_16x16x32_bf16 v[40:43], v[60:63], v[108:111], v[40:43]
    v_mfma_f32_16x16x32_bf16 v[44:47], v[64:67], v[108:111], v[44:47]
    v_mfma_f32_16x16x32_bf16 v[48:51], v[68:71], v[108:111], v[48:51]
    s_waitcnt lgkmcnt(0)
    ds_read_b64 v[108:109], v124 offset:36864
    ds_read_b64 v[110:111], v125 offset:36864
    ds_read_b64_tr_b16 v[52:53], v10 offset:47104
    ds_read_b64_tr_b16 v[54:55], v10 offset:49664
    ds_read_b64_tr_b16 v[56:57], v10 offset:47136
    ds_read_b64_tr_b16 v[58:59], v10 offset:49696
    ds_read_b64_tr_b16 v[60:61], v10 offset:47168
    ds_read_b64_tr_b16 v[62:63], v10 offset:49728
    ds_read_b64_tr_b16 v[64:65], v10 offset:47200
    ds_read_b64_tr_b16 v[66:67], v10 offset:49760
    ds_read_b64_tr_b16 v[68:69], v10 offset:47232
    ds_read_b64_tr_b16 v[70:71], v10 offset:49792
    v_mfma_f32_16x16x32_bf16 v[32:35], v[72:75], v[112:115], v[32:35]
    v_mfma_f32_16x16x32_bf16 v[36:39], v[76:79], v[112:115], v[36:39]
    v_mfma_f32_16x16x32_bf16 v[40:43], v[80:83], v[112:115], v[40:43]
    v_mfma_f32_16x16x32_bf16 v[44:47], v[84:87], v[112:115], v[44:47]
    v_mfma_f32_16x16x32_bf16 v[48:51], v[88:91], v[112:115], v[48:51]
    s_waitcnt lgkmcnt(0)
    ds_read_b64 v[112:113], v126 offset:36864
    ds_read_b64 v[114:115], v127 offset:36864
    ds_read_b64_tr_b16 v[72:73], v10 offset:52224
    ds_read_b64_tr_b16 v[74:75], v10 offset:54784
    ds_read_b64_tr_b16 v[76:77], v10 offset:52256
    ds_read_b64_tr_b16 v[78:79], v10 offset:54816
    ds_read_b64_tr_b16 v[80:81], v10 offset:52288
    ds_read_b64_tr_b16 v[82:83], v10 offset:54848
    ds_read_b64_tr_b16 v[84:85], v10 offset:52320
    ds_read_b64_tr_b16 v[86:87], v10 offset:54880
    ds_read_b64_tr_b16 v[88:89], v10 offset:52352
    ds_read_b64_tr_b16 v[90:91], v10 offset:54912
    v_mfma_f32_16x16x32_bf16 v[32:35], v[52:55], v[108:111], v[32:35]
    v_mfma_f32_16x16x32_bf16 v[36:39], v[56:59], v[108:111], v[36:39]
    v_mfma_f32_16x16x32_bf16 v[40:43], v[60:63], v[108:111], v[40:43]
    v_mfma_f32_16x16x32_bf16 v[44:47], v[64:67], v[108:111], v[44:47]
    v_mfma_f32_16x16x32_bf16 v[48:51], v[68:71], v[108:111], v[48:51]
    s_waitcnt lgkmcnt(0)
    s_waitcnt vmcnt(18)
    s_barrier
    s_mov_b32 s36, 0x118000
    s_add_u32 s37, s42, 126976
    s_mov_b32 m0, s37
    s_nop 0
    buffer_load_dwordx4 v4, s[12:15], s36 offen lds
    s_add_u32 s37, s37, 1024
    s_mov_b32 m0, s37
    s_nop 0
    buffer_load_dwordx4 v5, s[12:15], s36 offen lds
    s_add_u32 s37, s37, 1024
    s_mov_b32 m0, s37
    s_nop 0
    buffer_load_dwordx4 v6, s[12:15], s36 offen lds
    s_add_u32 s37, s37, 1024
    s_mov_b32 m0, s37
    s_nop 0
    buffer_load_dwordx4 v7, s[12:15], s36 offen lds
    s_add_u32 s37, s37, 1024
    s_mov_b32 m0, s37
    s_nop 0
    buffer_load_dwordx4 v8, s[12:15], s36 offen lds
    s_mov_b32 s36, 0x700
    s_lshl_b32 s37, s35, 2
    s_add_u32 s37, s37, 110592
    s_mov_b32 m0, s37
    s_nop 0
    buffer_load_dwordx4 v20, s[8:11], s36 offen lds
    s_add_u32 s37, s37, 1024
    s_mov_b32 m0, s37
    s_nop 0
    buffer_load_dwordx4 v21, s[8:11], s36 offen lds
    s_add_u32 s37, s37, 1024
    s_mov_b32 m0, s37
    s_nop 0
    buffer_load_dwordx4 v22, s[8:11], s36 offen lds
    s_add_u32 s37, s37, 1024
    s_mov_b32 m0, s37
    s_nop 0
    buffer_load_dwordx4 v23, s[8:11], s36 offen lds
    ds_read_b64 v[108:109], v24 offset:0
    ds_read_b64 v[110:111], v25 offset:0
    ds_read_b64_tr_b16 v[52:53], v12 offset:0
    ds_read_b64_tr_b16 v[54:55], v12 offset:2560
    ds_read_b64_tr_b16 v[56:57], v12 offset:32
    ds_read_b64_tr_b16 v[58:59], v12 offset:2592
    ds_read_b64_tr_b16 v[60:61], v12 offset:64
    ds_read_b64_tr_b16 v[62:63], v12 offset:2624
    ds_read_b64_tr_b16 v[64:65], v12 offset:96
    ds_read_b64_tr_b16 v[66:67], v12 offset:2656
    ds_read_b64_tr_b16 v[68:69], v12 offset:128
    ds_read_b64_tr_b16 v[70:71], v12 offset:2688
    v_mfma_f32_16x16x32_bf16 v[32:35], v[72:75], v[112:115], v[32:35]
    v_mfma_f32_16x16x32_bf16 v[36:39], v[76:79], v[112:115], v[36:39]
    v_mfma_f32_16x16x32_bf16 v[40:43], v[80:83], v[112:115], v[40:43]
    v_mfma_f32_16x16x32_bf16 v[44:47], v[84:87], v[112:115], v[44:47]
    v_mfma_f32_16x16x32_bf16 v[48:51], v[88:91], v[112:115], v[48:51]
    s_waitcnt lgkmcnt(0)
    ds_read_b64 v[112:113], v26 offset:0
    ds_read_b64 v[114:115], v27 offset:0
    ds_read_b64_tr_b16 v[72:73], v12 offset:5120
    ds_read_b64_tr_b16 v[74:75], v12 offset:7680
    ds_read_b64_tr_b16 v[76:77], v12 offset:5152
    ds_read_b64_tr_b16 v[78:79], v12 offset:7712
    ds_read_b64_tr_b16 v[80:81], v12 offset:5184
    ds_read_b64_tr_b16 v[82:83], v12 offset:7744
    ds_read_b64_tr_b16 v[84:85], v12 offset:5216
    ds_read_b64_tr_b16 v[86:87], v12 offset:7776
    ds_read_b64_tr_b16 v[88:89], v12 offset:5248
    ds_read_b64_tr_b16 v[90:91], v12 offset:7808
    v_mfma_f32_16x16x32_bf16 v[32:35], v[52:55], v[108:111], v[32:35]
    v_mfma_f32_16x16x32_bf16 v[36:39], v[56:59], v[108:111], v[36:39]
    v_mfma_f32_16x16x32_bf16 v[40:43], v[60:63], v[108:111], v[40:43]
    v_mfma_f32_16x16x32_bf16 v[44:47], v[64:67], v[108:111], v[44:47]
    v_mfma_f32_16x16x32_bf16 v[48:51], v[68:71], v[108:111], v[48:51]
    s_waitcnt lgkmcnt(0)
    ds_read_b64 v[108:109], v28 offset:0
    ds_read_b64 v[110:111], v29 offset:0
    ds_read_b64_tr_b16 v[52:53], v12 offset:10240
    ds_read_b64_tr_b16 v[54:55], v12 offset:12800
    ds_read_b64_tr_b16 v[56:57], v12 offset:10272
    ds_read_b64_tr_b16 v[58:59], v12 offset:12832
    ds_read_b64_tr_b16 v[60:61], v12 offset:10304
    ds_read_b64_tr_b16 v[62:63], v12 offset:12864
    ds_read_b64_tr_b16 v[64:65], v12 offset:10336
    ds_read_b64_tr_b16 v[66:67], v12 offset:12896
    ds_read_b64_tr_b16 v[68:69], v12 offset:10368
    ds_read_b64_tr_b16 v[70:71], v12 offset:12928
    v_mfma_f32_16x16x32_bf16 v[32:35], v[72:75], v[112:115], v[32:35]
    v_mfma_f32_16x16x32_bf16 v[36:39], v[76:79], v[112:115], v[36:39]
    v_mfma_f32_16x16x32_bf16 v[40:43], v[80:83], v[112:115], v[40:43]
    v_mfma_f32_16x16x32_bf16 v[44:47], v[84:87], v[112:115], v[44:47]
    v_mfma_f32_16x16x32_bf16 v[48:51], v[88:91], v[112:115], v[48:51]
    s_waitcnt lgkmcnt(0)
    ds_read_b64 v[112:113], v30 offset:0
    ds_read_b64 v[114:115], v31 offset:0
    ds_read_b64_tr_b16 v[72:73], v12 offset:15360
    ds_read_b64_tr_b16 v[74:75], v12 offset:17920
    ds_read_b64_tr_b16 v[76:77], v12 offset:15392
    ds_read_b64_tr_b16 v[78:79], v12 offset:17952
    ds_read_b64_tr_b16 v[80:81], v12 offset:15424
    ds_read_b64_tr_b16 v[82:83], v12 offset:17984
    ds_read_b64_tr_b16 v[84:85], v12 offset:15456
    ds_read_b64_tr_b16 v[86:87], v12 offset:18016
    ds_read_b64_tr_b16 v[88:89], v12 offset:15488
    ds_read_b64_tr_b16 v[90:91], v12 offset:18048
    v_mfma_f32_16x16x32_bf16 v[32:35], v[52:55], v[108:111], v[32:35]
    v_mfma_f32_16x16x32_bf16 v[36:39], v[56:59], v[108:111], v[36:39]
    v_mfma_f32_16x16x32_bf16 v[40:43], v[60:63], v[108:111], v[40:43]
    v_mfma_f32_16x16x32_bf16 v[44:47], v[64:67], v[108:111], v[44:47]
    v_mfma_f32_16x16x32_bf16 v[48:51], v[68:71], v[108:111], v[48:51]
    s_waitcnt lgkmcnt(0)
    s_waitcnt vmcnt(18)
    s_barrier
    s_mov_b32 s36, 0x140000
    s_add_u32 s37, s42, 16384
    s_mov_b32 m0, s37
    s_nop 0
    buffer_load_dwordx4 v4, s[12:15], s36 offen lds
    s_add_u32 s37, s37, 1024
    s_mov_b32 m0, s37
    s_nop 0
    buffer_load_dwordx4 v5, s[12:15], s36 offen lds
    s_add_u32 s37, s37, 1024
    s_mov_b32 m0, s37
    s_nop 0
    buffer_load_dwordx4 v6, s[12:15], s36 offen lds
    s_add_u32 s37, s37, 1024
    s_mov_b32 m0, s37
    s_nop 0
    buffer_load_dwordx4 v7, s[12:15], s36 offen lds
    s_add_u32 s37, s37, 1024
    s_mov_b32 m0, s37
    s_nop 0
    buffer_load_dwordx4 v8, s[12:15], s36 offen lds
    s_mov_b32 s36, 0x800
    s_lshl_b32 s37, s35, 2
    s_add_u32 s37, s37, 0
    s_mov_b32 m0, s37
    s_nop 0
    buffer_load_dwordx4 v20, s[8:11], s36 offen lds
    s_add_u32 s37, s37, 1024
    s_mov_b32 m0, s37
    s_nop 0
    buffer_load_dwordx4 v21, s[8:11], s36 offen lds
    s_add_u32 s37, s37, 1024
    s_mov_b32 m0, s37
    s_nop 0
    buffer_load_dwordx4 v22, s[8:11], s36 offen lds
    s_add_u32 s37, s37, 1024
    s_mov_b32 m0, s37
    s_nop 0
    buffer_load_dwordx4 v23, s[8:11], s36 offen lds
    ds_read_b64 v[108:109], v24 offset:36864
    ds_read_b64 v[110:111], v25 offset:36864
    ds_read_b64_tr_b16 v[52:53], v12 offset:36864
    ds_read_b64_tr_b16 v[54:55], v12 offset:39424
    ds_read_b64_tr_b16 v[56:57], v12 offset:36896
    ds_read_b64_tr_b16 v[58:59], v12 offset:39456
    ds_read_b64_tr_b16 v[60:61], v12 offset:36928
    ds_read_b64_tr_b16 v[62:63], v12 offset:39488
    ds_read_b64_tr_b16 v[64:65], v12 offset:36960
    ds_read_b64_tr_b16 v[66:67], v12 offset:39520
    ds_read_b64_tr_b16 v[68:69], v12 offset:36992
    ds_read_b64_tr_b16 v[70:71], v12 offset:39552
    v_mfma_f32_16x16x32_bf16 v[32:35], v[72:75], v[112:115], v[32:35]
    v_mfma_f32_16x16x32_bf16 v[36:39], v[76:79], v[112:115], v[36:39]
    v_mfma_f32_16x16x32_bf16 v[40:43], v[80:83], v[112:115], v[40:43]
    v_mfma_f32_16x16x32_bf16 v[44:47], v[84:87], v[112:115], v[44:47]
    v_mfma_f32_16x16x32_bf16 v[48:51], v[88:91], v[112:115], v[48:51]
    s_waitcnt lgkmcnt(0)
    ds_read_b64 v[112:113], v26 offset:36864
    ds_read_b64 v[114:115], v27 offset:36864
    ds_read_b64_tr_b16 v[72:73], v12 offset:41984
    ds_read_b64_tr_b16 v[74:75], v12 offset:44544
    ds_read_b64_tr_b16 v[76:77], v12 offset:42016
    ds_read_b64_tr_b16 v[78:79], v12 offset:44576
    ds_read_b64_tr_b16 v[80:81], v12 offset:42048
    ds_read_b64_tr_b16 v[82:83], v12 offset:44608
    ds_read_b64_tr_b16 v[84:85], v12 offset:42080
    ds_read_b64_tr_b16 v[86:87], v12 offset:44640
    ds_read_b64_tr_b16 v[88:89], v12 offset:42112
    ds_read_b64_tr_b16 v[90:91], v12 offset:44672
    v_mfma_f32_16x16x32_bf16 v[32:35], v[52:55], v[108:111], v[32:35]
    v_mfma_f32_16x16x32_bf16 v[36:39], v[56:59], v[108:111], v[36:39]
    v_mfma_f32_16x16x32_bf16 v[40:43], v[60:63], v[108:111], v[40:43]
    v_mfma_f32_16x16x32_bf16 v[44:47], v[64:67], v[108:111], v[44:47]
    v_mfma_f32_16x16x32_bf16 v[48:51], v[68:71], v[108:111], v[48:51]
    s_waitcnt lgkmcnt(0)
    ds_read_b64 v[108:109], v28 offset:36864
    ds_read_b64 v[110:111], v29 offset:36864
    ds_read_b64_tr_b16 v[52:53], v12 offset:47104
    ds_read_b64_tr_b16 v[54:55], v12 offset:49664
    ds_read_b64_tr_b16 v[56:57], v12 offset:47136
    ds_read_b64_tr_b16 v[58:59], v12 offset:49696
    ds_read_b64_tr_b16 v[60:61], v12 offset:47168
    ds_read_b64_tr_b16 v[62:63], v12 offset:49728
    ds_read_b64_tr_b16 v[64:65], v12 offset:47200
    ds_read_b64_tr_b16 v[66:67], v12 offset:49760
    ds_read_b64_tr_b16 v[68:69], v12 offset:47232
    ds_read_b64_tr_b16 v[70:71], v12 offset:49792
    v_mfma_f32_16x16x32_bf16 v[32:35], v[72:75], v[112:115], v[32:35]
    v_mfma_f32_16x16x32_bf16 v[36:39], v[76:79], v[112:115], v[36:39]
    v_mfma_f32_16x16x32_bf16 v[40:43], v[80:83], v[112:115], v[40:43]
    v_mfma_f32_16x16x32_bf16 v[44:47], v[84:87], v[112:115], v[44:47]
    v_mfma_f32_16x16x32_bf16 v[48:51], v[88:91], v[112:115], v[48:51]
    s_waitcnt lgkmcnt(0)
    ds_read_b64 v[112:113], v30 offset:36864
    ds_read_b64 v[114:115], v31 offset:36864
    ds_read_b64_tr_b16 v[72:73], v12 offset:52224
    ds_read_b64_tr_b16 v[74:75], v12 offset:54784
    ds_read_b64_tr_b16 v[76:77], v12 offset:52256
    ds_read_b64_tr_b16 v[78:79], v12 offset:54816
    ds_read_b64_tr_b16 v[80:81], v12 offset:52288
    ds_read_b64_tr_b16 v[82:83], v12 offset:54848
    ds_read_b64_tr_b16 v[84:85], v12 offset:52320
    ds_read_b64_tr_b16 v[86:87], v12 offset:54880
    ds_read_b64_tr_b16 v[88:89], v12 offset:52352
    ds_read_b64_tr_b16 v[90:91], v12 offset:54912
    v_mfma_f32_16x16x32_bf16 v[32:35], v[52:55], v[108:111], v[32:35]
    v_mfma_f32_16x16x32_bf16 v[36:39], v[56:59], v[108:111], v[36:39]
    v_mfma_f32_16x16x32_bf16 v[40:43], v[60:63], v[108:111], v[40:43]
    v_mfma_f32_16x16x32_bf16 v[44:47], v[64:67], v[108:111], v[44:47]
    v_mfma_f32_16x16x32_bf16 v[48:51], v[68:71], v[108:111], v[48:51]
    s_waitcnt lgkmcnt(0)
    s_waitcnt vmcnt(18)
    s_barrier
    s_mov_b32 s36, 0x168000
    s_add_u32 s37, s42, 53248
    s_mov_b32 m0, s37
    s_nop 0
    buffer_load_dwordx4 v4, s[12:15], s36 offen lds
    s_add_u32 s37, s37, 1024
    s_mov_b32 m0, s37
    s_nop 0
    buffer_load_dwordx4 v5, s[12:15], s36 offen lds
    s_add_u32 s37, s37, 1024
    s_mov_b32 m0, s37
    s_nop 0
    buffer_load_dwordx4 v6, s[12:15], s36 offen lds
    s_add_u32 s37, s37, 1024
    s_mov_b32 m0, s37
    s_nop 0
    buffer_load_dwordx4 v7, s[12:15], s36 offen lds
    s_add_u32 s37, s37, 1024
    s_mov_b32 m0, s37
    s_nop 0
    buffer_load_dwordx4 v8, s[12:15], s36 offen lds
    s_mov_b32 s36, 0x900
    s_lshl_b32 s37, s35, 2
    s_add_u32 s37, s37, 36864
    s_mov_b32 m0, s37
    s_nop 0
    buffer_load_dwordx4 v20, s[8:11], s36 offen lds
    s_add_u32 s37, s37, 1024
    s_mov_b32 m0, s37
    s_nop 0
    buffer_load_dwordx4 v21, s[8:11], s36 offen lds
    s_add_u32 s37, s37, 1024
    s_mov_b32 m0, s37
    s_nop 0
    buffer_load_dwordx4 v22, s[8:11], s36 offen lds
    s_add_u32 s37, s37, 1024
    s_mov_b32 m0, s37
    s_nop 0
    buffer_load_dwordx4 v23, s[8:11], s36 offen lds
    ds_read_b64 v[108:109], v120 offset:0
    ds_read_b64 v[110:111], v121 offset:0
    ds_read_b64_tr_b16 v[52:53], v10 offset:0
    ds_read_b64_tr_b16 v[54:55], v10 offset:2560
    ds_read_b64_tr_b16 v[56:57], v10 offset:32
    ds_read_b64_tr_b16 v[58:59], v10 offset:2592
    ds_read_b64_tr_b16 v[60:61], v10 offset:64
    ds_read_b64_tr_b16 v[62:63], v10 offset:2624
    ds_read_b64_tr_b16 v[64:65], v10 offset:96
    ds_read_b64_tr_b16 v[66:67], v10 offset:2656
    ds_read_b64_tr_b16 v[68:69], v10 offset:128
    ds_read_b64_tr_b16 v[70:71], v10 offset:2688
    v_mfma_f32_16x16x32_bf16 v[32:35], v[72:75], v[112:115], v[32:35]
    v_mfma_f32_16x16x32_bf16 v[36:39], v[76:79], v[112:115], v[36:39]
    v_mfma_f32_16x16x32_bf16 v[40:43], v[80:83], v[112:115], v[40:43]
    v_mfma_f32_16x16x32_bf16 v[44:47], v[84:87], v[112:115], v[44:47]
    v_mfma_f32_16x16x32_bf16 v[48:51], v[88:91], v[112:115], v[48:51]
    s_waitcnt lgkmcnt(0)
    ds_read_b64 v[112:113], v122 offset:0
    ds_read_b64 v[114:115], v123 offset:0
    ds_read_b64_tr_b16 v[72:73], v10 offset:5120
    ds_read_b64_tr_b16 v[74:75], v10 offset:7680
    ds_read_b64_tr_b16 v[76:77], v10 offset:5152
    ds_read_b64_tr_b16 v[78:79], v10 offset:7712
    ds_read_b64_tr_b16 v[80:81], v10 offset:5184
    ds_read_b64_tr_b16 v[82:83], v10 offset:7744
    ds_read_b64_tr_b16 v[84:85], v10 offset:5216
    ds_read_b64_tr_b16 v[86:87], v10 offset:7776
    ds_read_b64_tr_b16 v[88:89], v10 offset:5248
    ds_read_b64_tr_b16 v[90:91], v10 offset:7808
    v_mfma_f32_16x16x32_bf16 v[32:35], v[52:55], v[108:111], v[32:35]
    v_mfma_f32_16x16x32_bf16 v[36:39], v[56:59], v[108:111], v[36:39]
    v_mfma_f32_16x16x32_bf16 v[40:43], v[60:63], v[108:111], v[40:43]
    v_mfma_f32_16x16x32_bf16 v[44:47], v[64:67], v[108:111], v[44:47]
    v_mfma_f32_16x16x32_bf16 v[48:51], v[68:71], v[108:111], v[48:51]
    s_waitcnt lgkmcnt(0)
    ds_read_b64 v[108:109], v124 offset:0
    ds_read_b64 v[110:111], v125 offset:0
    ds_read_b64_tr_b16 v[52:53], v10 offset:10240
    ds_read_b64_tr_b16 v[54:55], v10 offset:12800
    ds_read_b64_tr_b16 v[56:57], v10 offset:10272
    ds_read_b64_tr_b16 v[58:59], v10 offset:12832
    ds_read_b64_tr_b16 v[60:61], v10 offset:10304
    ds_read_b64_tr_b16 v[62:63], v10 offset:12864
    ds_read_b64_tr_b16 v[64:65], v10 offset:10336
    ds_read_b64_tr_b16 v[66:67], v10 offset:12896
    ds_read_b64_tr_b16 v[68:69], v10 offset:10368
    ds_read_b64_tr_b16 v[70:71], v10 offset:12928
    v_mfma_f32_16x16x32_bf16 v[32:35], v[72:75], v[112:115], v[32:35]
    v_mfma_f32_16x16x32_bf16 v[36:39], v[76:79], v[112:115], v[36:39]
    v_mfma_f32_16x16x32_bf16 v[40:43], v[80:83], v[112:115], v[40:43]
    v_mfma_f32_16x16x32_bf16 v[44:47], v[84:87], v[112:115], v[44:47]
    v_mfma_f32_16x16x32_bf16 v[48:51], v[88:91], v[112:115], v[48:51]
    s_waitcnt lgkmcnt(0)
    ds_read_b64 v[112:113], v126 offset:0
    ds_read_b64 v[114:115], v127 offset:0
    ds_read_b64_tr_b16 v[72:73], v10 offset:15360
    ds_read_b64_tr_b16 v[74:75], v10 offset:17920
    ds_read_b64_tr_b16 v[76:77], v10 offset:15392
    ds_read_b64_tr_b16 v[78:79], v10 offset:17952
    ds_read_b64_tr_b16 v[80:81], v10 offset:15424
    ds_read_b64_tr_b16 v[82:83], v10 offset:17984
    ds_read_b64_tr_b16 v[84:85], v10 offset:15456
    ds_read_b64_tr_b16 v[86:87], v10 offset:18016
    ds_read_b64_tr_b16 v[88:89], v10 offset:15488
    ds_read_b64_tr_b16 v[90:91], v10 offset:18048
    v_mfma_f32_16x16x32_bf16 v[32:35], v[52:55], v[108:111], v[32:35]
    v_mfma_f32_16x16x32_bf16 v[36:39], v[56:59], v[108:111], v[36:39]
    v_mfma_f32_16x16x32_bf16 v[40:43], v[60:63], v[108:111], v[40:43]
    v_mfma_f32_16x16x32_bf16 v[44:47], v[64:67], v[108:111], v[44:47]
    v_mfma_f32_16x16x32_bf16 v[48:51], v[68:71], v[108:111], v[48:51]
    s_waitcnt lgkmcnt(0)
    s_waitcnt vmcnt(18)
    s_barrier
    s_mov_b32 s36, 0x190000
    s_add_u32 s37, s42, 90112
    s_mov_b32 m0, s37
    s_nop 0
    buffer_load_dwordx4 v4, s[12:15], s36 offen lds
    s_add_u32 s37, s37, 1024
    s_mov_b32 m0, s37
    s_nop 0
    buffer_load_dwordx4 v5, s[12:15], s36 offen lds
    s_add_u32 s37, s37, 1024
    s_mov_b32 m0, s37
    s_nop 0
    buffer_load_dwordx4 v6, s[12:15], s36 offen lds
    s_add_u32 s37, s37, 1024
    s_mov_b32 m0, s37
    s_nop 0
    buffer_load_dwordx4 v7, s[12:15], s36 offen lds
    s_add_u32 s37, s37, 1024
    s_mov_b32 m0, s37
    s_nop 0
    buffer_load_dwordx4 v8, s[12:15], s36 offen lds
    s_mov_b32 s36, 0xa00
    s_lshl_b32 s37, s35, 2
    s_add_u32 s37, s37, 73728
    s_mov_b32 m0, s37
    s_nop 0
    buffer_load_dwordx4 v20, s[8:11], s36 offen lds
    s_add_u32 s37, s37, 1024
    s_mov_b32 m0, s37
    s_nop 0
    buffer_load_dwordx4 v21, s[8:11], s36 offen lds
    s_add_u32 s37, s37, 1024
    s_mov_b32 m0, s37
    s_nop 0
    buffer_load_dwordx4 v22, s[8:11], s36 offen lds
    s_add_u32 s37, s37, 1024
    s_mov_b32 m0, s37
    s_nop 0
    buffer_load_dwordx4 v23, s[8:11], s36 offen lds
    ds_read_b64 v[108:109], v120 offset:36864
    ds_read_b64 v[110:111], v121 offset:36864
    ds_read_b64_tr_b16 v[52:53], v10 offset:36864
    ds_read_b64_tr_b16 v[54:55], v10 offset:39424
    ds_read_b64_tr_b16 v[56:57], v10 offset:36896
    ds_read_b64_tr_b16 v[58:59], v10 offset:39456
    ds_read_b64_tr_b16 v[60:61], v10 offset:36928
    ds_read_b64_tr_b16 v[62:63], v10 offset:39488
    ds_read_b64_tr_b16 v[64:65], v10 offset:36960
    ds_read_b64_tr_b16 v[66:67], v10 offset:39520
    ds_read_b64_tr_b16 v[68:69], v10 offset:36992
    ds_read_b64_tr_b16 v[70:71], v10 offset:39552
    v_mfma_f32_16x16x32_bf16 v[32:35], v[72:75], v[112:115], v[32:35]
    v_mfma_f32_16x16x32_bf16 v[36:39], v[76:79], v[112:115], v[36:39]
    v_mfma_f32_16x16x32_bf16 v[40:43], v[80:83], v[112:115], v[40:43]
    v_mfma_f32_16x16x32_bf16 v[44:47], v[84:87], v[112:115], v[44:47]
    v_mfma_f32_16x16x32_bf16 v[48:51], v[88:91], v[112:115], v[48:51]
    s_waitcnt lgkmcnt(0)
    ds_read_b64 v[112:113], v122 offset:36864
    ds_read_b64 v[114:115], v123 offset:36864
    ds_read_b64_tr_b16 v[72:73], v10 offset:41984
    ds_read_b64_tr_b16 v[74:75], v10 offset:44544
    ds_read_b64_tr_b16 v[76:77], v10 offset:42016
    ds_read_b64_tr_b16 v[78:79], v10 offset:44576
    ds_read_b64_tr_b16 v[80:81], v10 offset:42048
    ds_read_b64_tr_b16 v[82:83], v10 offset:44608
    ds_read_b64_tr_b16 v[84:85], v10 offset:42080
    ds_read_b64_tr_b16 v[86:87], v10 offset:44640
    ds_read_b64_tr_b16 v[88:89], v10 offset:42112
    ds_read_b64_tr_b16 v[90:91], v10 offset:44672
    v_mfma_f32_16x16x32_bf16 v[32:35], v[52:55], v[108:111], v[32:35]
    v_mfma_f32_16x16x32_bf16 v[36:39], v[56:59], v[108:111], v[36:39]
    v_mfma_f32_16x16x32_bf16 v[40:43], v[60:63], v[108:111], v[40:43]
    v_mfma_f32_16x16x32_bf16 v[44:47], v[64:67], v[108:111], v[44:47]
    v_mfma_f32_16x16x32_bf16 v[48:51], v[68:71], v[108:111], v[48:51]
    s_waitcnt lgkmcnt(0)
    ds_read_b64 v[108:109], v124 offset:36864
    ds_read_b64 v[110:111], v125 offset:36864
    ds_read_b64_tr_b16 v[52:53], v10 offset:47104
    ds_read_b64_tr_b16 v[54:55], v10 offset:49664
    ds_read_b64_tr_b16 v[56:57], v10 offset:47136
    ds_read_b64_tr_b16 v[58:59], v10 offset:49696
    ds_read_b64_tr_b16 v[60:61], v10 offset:47168
    ds_read_b64_tr_b16 v[62:63], v10 offset:49728
    ds_read_b64_tr_b16 v[64:65], v10 offset:47200
    ds_read_b64_tr_b16 v[66:67], v10 offset:49760
    ds_read_b64_tr_b16 v[68:69], v10 offset:47232
    ds_read_b64_tr_b16 v[70:71], v10 offset:49792
    v_mfma_f32_16x16x32_bf16 v[32:35], v[72:75], v[112:115], v[32:35]
    v_mfma_f32_16x16x32_bf16 v[36:39], v[76:79], v[112:115], v[36:39]
    v_mfma_f32_16x16x32_bf16 v[40:43], v[80:83], v[112:115], v[40:43]
    v_mfma_f32_16x16x32_bf16 v[44:47], v[84:87], v[112:115], v[44:47]
    v_mfma_f32_16x16x32_bf16 v[48:51], v[88:91], v[112:115], v[48:51]
    s_waitcnt lgkmcnt(0)
    ds_read_b64 v[112:113], v126 offset:36864
    ds_read_b64 v[114:115], v127 offset:36864
    ds_read_b64_tr_b16 v[72:73], v10 offset:52224
    ds_read_b64_tr_b16 v[74:75], v10 offset:54784
    ds_read_b64_tr_b16 v[76:77], v10 offset:52256
    ds_read_b64_tr_b16 v[78:79], v10 offset:54816
    ds_read_b64_tr_b16 v[80:81], v10 offset:52288
    ds_read_b64_tr_b16 v[82:83], v10 offset:54848
    ds_read_b64_tr_b16 v[84:85], v10 offset:52320
    ds_read_b64_tr_b16 v[86:87], v10 offset:54880
    ds_read_b64_tr_b16 v[88:89], v10 offset:52352
    ds_read_b64_tr_b16 v[90:91], v10 offset:54912
    v_mfma_f32_16x16x32_bf16 v[32:35], v[52:55], v[108:111], v[32:35]
    v_mfma_f32_16x16x32_bf16 v[36:39], v[56:59], v[108:111], v[36:39]
    v_mfma_f32_16x16x32_bf16 v[40:43], v[60:63], v[108:111], v[40:43]
    v_mfma_f32_16x16x32_bf16 v[44:47], v[64:67], v[108:111], v[44:47]
    v_mfma_f32_16x16x32_bf16 v[48:51], v[68:71], v[108:111], v[48:51]
    s_waitcnt lgkmcnt(0)
    s_waitcnt vmcnt(18)
    s_barrier
    s_mov_b32 s36, 0x1b8000
    s_add_u32 s37, s42, 126976
    s_mov_b32 m0, s37
    s_nop 0
    buffer_load_dwordx4 v4, s[12:15], s36 offen lds
    s_add_u32 s37, s37, 1024
    s_mov_b32 m0, s37
    s_nop 0
    buffer_load_dwordx4 v5, s[12:15], s36 offen lds
    s_add_u32 s37, s37, 1024
    s_mov_b32 m0, s37
    s_nop 0
    buffer_load_dwordx4 v6, s[12:15], s36 offen lds
    s_add_u32 s37, s37, 1024
    s_mov_b32 m0, s37
    s_nop 0
    buffer_load_dwordx4 v7, s[12:15], s36 offen lds
    s_add_u32 s37, s37, 1024
    s_mov_b32 m0, s37
    s_nop 0
    buffer_load_dwordx4 v8, s[12:15], s36 offen lds
    s_mov_b32 s36, 0xb00
    s_lshl_b32 s37, s35, 2
    s_add_u32 s37, s37, 110592
    s_mov_b32 m0, s37
    s_nop 0
    buffer_load_dwordx4 v20, s[8:11], s36 offen lds
    s_add_u32 s37, s37, 1024
    s_mov_b32 m0, s37
    s_nop 0
    buffer_load_dwordx4 v21, s[8:11], s36 offen lds
    s_add_u32 s37, s37, 1024
    s_mov_b32 m0, s37
    s_nop 0
    buffer_load_dwordx4 v22, s[8:11], s36 offen lds
    s_add_u32 s37, s37, 1024
    s_mov_b32 m0, s37
    s_nop 0
    buffer_load_dwordx4 v23, s[8:11], s36 offen lds
    ds_read_b64 v[108:109], v24 offset:0
    ds_read_b64 v[110:111], v25 offset:0
    ds_read_b64_tr_b16 v[52:53], v12 offset:0
    ds_read_b64_tr_b16 v[54:55], v12 offset:2560
    ds_read_b64_tr_b16 v[56:57], v12 offset:32
    ds_read_b64_tr_b16 v[58:59], v12 offset:2592
    ds_read_b64_tr_b16 v[60:61], v12 offset:64
    ds_read_b64_tr_b16 v[62:63], v12 offset:2624
    ds_read_b64_tr_b16 v[64:65], v12 offset:96
    ds_read_b64_tr_b16 v[66:67], v12 offset:2656
    ds_read_b64_tr_b16 v[68:69], v12 offset:128
    ds_read_b64_tr_b16 v[70:71], v12 offset:2688
    v_mfma_f32_16x16x32_bf16 v[32:35], v[72:75], v[112:115], v[32:35]
    v_mfma_f32_16x16x32_bf16 v[36:39], v[76:79], v[112:115], v[36:39]
    v_mfma_f32_16x16x32_bf16 v[40:43], v[80:83], v[112:115], v[40:43]
    v_mfma_f32_16x16x32_bf16 v[44:47], v[84:87], v[112:115], v[44:47]
    v_mfma_f32_16x16x32_bf16 v[48:51], v[88:91], v[112:115], v[48:51]
    s_waitcnt lgkmcnt(0)
    ds_read_b64 v[112:113], v26 offset:0
    ds_read_b64 v[114:115], v27 offset:0
    ds_read_b64_tr_b16 v[72:73], v12 offset:5120
    ds_read_b64_tr_b16 v[74:75], v12 offset:7680
    ds_read_b64_tr_b16 v[76:77], v12 offset:5152
    ds_read_b64_tr_b16 v[78:79], v12 offset:7712
    ds_read_b64_tr_b16 v[80:81], v12 offset:5184
    ds_read_b64_tr_b16 v[82:83], v12 offset:7744
    ds_read_b64_tr_b16 v[84:85], v12 offset:5216
    ds_read_b64_tr_b16 v[86:87], v12 offset:7776
    ds_read_b64_tr_b16 v[88:89], v12 offset:5248
    ds_read_b64_tr_b16 v[90:91], v12 offset:7808
    v_mfma_f32_16x16x32_bf16 v[32:35], v[52:55], v[108:111], v[32:35]
    v_mfma_f32_16x16x32_bf16 v[36:39], v[56:59], v[108:111], v[36:39]
    v_mfma_f32_16x16x32_bf16 v[40:43], v[60:63], v[108:111], v[40:43]
    v_mfma_f32_16x16x32_bf16 v[44:47], v[64:67], v[108:111], v[44:47]
    v_mfma_f32_16x16x32_bf16 v[48:51], v[68:71], v[108:111], v[48:51]
    s_waitcnt lgkmcnt(0)
    ds_read_b64 v[108:109], v28 offset:0
    ds_read_b64 v[110:111], v29 offset:0
    ds_read_b64_tr_b16 v[52:53], v12 offset:10240
    ds_read_b64_tr_b16 v[54:55], v12 offset:12800
    ds_read_b64_tr_b16 v[56:57], v12 offset:10272
    ds_read_b64_tr_b16 v[58:59], v12 offset:12832
    ds_read_b64_tr_b16 v[60:61], v12 offset:10304
    ds_read_b64_tr_b16 v[62:63], v12 offset:12864
    ds_read_b64_tr_b16 v[64:65], v12 offset:10336
    ds_read_b64_tr_b16 v[66:67], v12 offset:12896
    ds_read_b64_tr_b16 v[68:69], v12 offset:10368
    ds_read_b64_tr_b16 v[70:71], v12 offset:12928
    v_mfma_f32_16x16x32_bf16 v[32:35], v[72:75], v[112:115], v[32:35]
    v_mfma_f32_16x16x32_bf16 v[36:39], v[76:79], v[112:115], v[36:39]
    v_mfma_f32_16x16x32_bf16 v[40:43], v[80:83], v[112:115], v[40:43]
    v_mfma_f32_16x16x32_bf16 v[44:47], v[84:87], v[112:115], v[44:47]
    v_mfma_f32_16x16x32_bf16 v[48:51], v[88:91], v[112:115], v[48:51]
    s_waitcnt lgkmcnt(0)
    ds_read_b64 v[112:113], v30 offset:0
    ds_read_b64 v[114:115], v31 offset:0
    ds_read_b64_tr_b16 v[72:73], v12 offset:15360
    ds_read_b64_tr_b16 v[74:75], v12 offset:17920
    ds_read_b64_tr_b16 v[76:77], v12 offset:15392
    ds_read_b64_tr_b16 v[78:79], v12 offset:17952
    ds_read_b64_tr_b16 v[80:81], v12 offset:15424
    ds_read_b64_tr_b16 v[82:83], v12 offset:17984
    ds_read_b64_tr_b16 v[84:85], v12 offset:15456
    ds_read_b64_tr_b16 v[86:87], v12 offset:18016
    ds_read_b64_tr_b16 v[88:89], v12 offset:15488
    ds_read_b64_tr_b16 v[90:91], v12 offset:18048
    v_mfma_f32_16x16x32_bf16 v[32:35], v[52:55], v[108:111], v[32:35]
    v_mfma_f32_16x16x32_bf16 v[36:39], v[56:59], v[108:111], v[36:39]
    v_mfma_f32_16x16x32_bf16 v[40:43], v[60:63], v[108:111], v[40:43]
    v_mfma_f32_16x16x32_bf16 v[44:47], v[64:67], v[108:111], v[44:47]
    v_mfma_f32_16x16x32_bf16 v[48:51], v[68:71], v[108:111], v[48:51]
    s_waitcnt lgkmcnt(0)
    s_waitcnt vmcnt(18)
    s_barrier
    s_mov_b32 s36, 0x1e0000
    s_add_u32 s37, s42, 16384
    s_mov_b32 m0, s37
    s_nop 0
    buffer_load_dwordx4 v4, s[12:15], s36 offen lds
    s_add_u32 s37, s37, 1024
    s_mov_b32 m0, s37
    s_nop 0
    buffer_load_dwordx4 v5, s[12:15], s36 offen lds
    s_add_u32 s37, s37, 1024
    s_mov_b32 m0, s37
    s_nop 0
    buffer_load_dwordx4 v6, s[12:15], s36 offen lds
    s_add_u32 s37, s37, 1024
    s_mov_b32 m0, s37
    s_nop 0
    buffer_load_dwordx4 v7, s[12:15], s36 offen lds
    s_add_u32 s37, s37, 1024
    s_mov_b32 m0, s37
    s_nop 0
    buffer_load_dwordx4 v8, s[12:15], s36 offen lds
    s_mov_b32 s36, 0xc00
    s_lshl_b32 s37, s35, 2
    s_add_u32 s37, s37, 0
    s_mov_b32 m0, s37
    s_nop 0
    buffer_load_dwordx4 v20, s[8:11], s36 offen lds
    s_add_u32 s37, s37, 1024
    s_mov_b32 m0, s37
    s_nop 0
    buffer_load_dwordx4 v21, s[8:11], s36 offen lds
    s_add_u32 s37, s37, 1024
    s_mov_b32 m0, s37
    s_nop 0
    buffer_load_dwordx4 v22, s[8:11], s36 offen lds
    s_add_u32 s37, s37, 1024
    s_mov_b32 m0, s37
    s_nop 0
    buffer_load_dwordx4 v23, s[8:11], s36 offen lds
    ds_read_b64 v[108:109], v24 offset:36864
    ds_read_b64 v[110:111], v25 offset:36864
    ds_read_b64_tr_b16 v[52:53], v12 offset:36864
    ds_read_b64_tr_b16 v[54:55], v12 offset:39424
    ds_read_b64_tr_b16 v[56:57], v12 offset:36896
    ds_read_b64_tr_b16 v[58:59], v12 offset:39456
    ds_read_b64_tr_b16 v[60:61], v12 offset:36928
    ds_read_b64_tr_b16 v[62:63], v12 offset:39488
    ds_read_b64_tr_b16 v[64:65], v12 offset:36960
    ds_read_b64_tr_b16 v[66:67], v12 offset:39520
    ds_read_b64_tr_b16 v[68:69], v12 offset:36992
    ds_read_b64_tr_b16 v[70:71], v12 offset:39552
    v_mfma_f32_16x16x32_bf16 v[32:35], v[72:75], v[112:115], v[32:35]
    v_mfma_f32_16x16x32_bf16 v[36:39], v[76:79], v[112:115], v[36:39]
    v_mfma_f32_16x16x32_bf16 v[40:43], v[80:83], v[112:115], v[40:43]
    v_mfma_f32_16x16x32_bf16 v[44:47], v[84:87], v[112:115], v[44:47]
    v_mfma_f32_16x16x32_bf16 v[48:51], v[88:91], v[112:115], v[48:51]
    s_waitcnt lgkmcnt(0)
    ds_read_b64 v[112:113], v26 offset:36864
    ds_read_b64 v[114:115], v27 offset:36864
    ds_read_b64_tr_b16 v[72:73], v12 offset:41984
    ds_read_b64_tr_b16 v[74:75], v12 offset:44544
    ds_read_b64_tr_b16 v[76:77], v12 offset:42016
    ds_read_b64_tr_b16 v[78:79], v12 offset:44576
    ds_read_b64_tr_b16 v[80:81], v12 offset:42048
    ds_read_b64_tr_b16 v[82:83], v12 offset:44608
    ds_read_b64_tr_b16 v[84:85], v12 offset:42080
    ds_read_b64_tr_b16 v[86:87], v12 offset:44640
    ds_read_b64_tr_b16 v[88:89], v12 offset:42112
    ds_read_b64_tr_b16 v[90:91], v12 offset:44672
    v_mfma_f32_16x16x32_bf16 v[32:35], v[52:55], v[108:111], v[32:35]
    v_mfma_f32_16x16x32_bf16 v[36:39], v[56:59], v[108:111], v[36:39]
    v_mfma_f32_16x16x32_bf16 v[40:43], v[60:63], v[108:111], v[40:43]
    v_mfma_f32_16x16x32_bf16 v[44:47], v[64:67], v[108:111], v[44:47]
    v_mfma_f32_16x16x32_bf16 v[48:51], v[68:71], v[108:111], v[48:51]
    s_waitcnt lgkmcnt(0)
    ds_read_b64 v[108:109], v28 offset:36864
    ds_read_b64 v[110:111], v29 offset:36864
    ds_read_b64_tr_b16 v[52:53], v12 offset:47104
    ds_read_b64_tr_b16 v[54:55], v12 offset:49664
    ds_read_b64_tr_b16 v[56:57], v12 offset:47136
    ds_read_b64_tr_b16 v[58:59], v12 offset:49696
    ds_read_b64_tr_b16 v[60:61], v12 offset:47168
    ds_read_b64_tr_b16 v[62:63], v12 offset:49728
    ds_read_b64_tr_b16 v[64:65], v12 offset:47200
    ds_read_b64_tr_b16 v[66:67], v12 offset:49760
    ds_read_b64_tr_b16 v[68:69], v12 offset:47232
    ds_read_b64_tr_b16 v[70:71], v12 offset:49792
    v_mfma_f32_16x16x32_bf16 v[32:35], v[72:75], v[112:115], v[32:35]
    v_mfma_f32_16x16x32_bf16 v[36:39], v[76:79], v[112:115], v[36:39]
    v_mfma_f32_16x16x32_bf16 v[40:43], v[80:83], v[112:115], v[40:43]
    v_mfma_f32_16x16x32_bf16 v[44:47], v[84:87], v[112:115], v[44:47]
    v_mfma_f32_16x16x32_bf16 v[48:51], v[88:91], v[112:115], v[48:51]
    s_waitcnt lgkmcnt(0)
    ds_read_b64 v[112:113], v30 offset:36864
    ds_read_b64 v[114:115], v31 offset:36864
    ds_read_b64_tr_b16 v[72:73], v12 offset:52224
    ds_read_b64_tr_b16 v[74:75], v12 offset:54784
    ds_read_b64_tr_b16 v[76:77], v12 offset:52256
    ds_read_b64_tr_b16 v[78:79], v12 offset:54816
    ds_read_b64_tr_b16 v[80:81], v12 offset:52288
    ds_read_b64_tr_b16 v[82:83], v12 offset:54848
    ds_read_b64_tr_b16 v[84:85], v12 offset:52320
    ds_read_b64_tr_b16 v[86:87], v12 offset:54880
    ds_read_b64_tr_b16 v[88:89], v12 offset:52352
    ds_read_b64_tr_b16 v[90:91], v12 offset:54912
    v_mfma_f32_16x16x32_bf16 v[32:35], v[52:55], v[108:111], v[32:35]
    v_mfma_f32_16x16x32_bf16 v[36:39], v[56:59], v[108:111], v[36:39]
    v_mfma_f32_16x16x32_bf16 v[40:43], v[60:63], v[108:111], v[40:43]
    v_mfma_f32_16x16x32_bf16 v[44:47], v[64:67], v[108:111], v[44:47]
    v_mfma_f32_16x16x32_bf16 v[48:51], v[68:71], v[108:111], v[48:51]
    s_waitcnt lgkmcnt(0)
    s_waitcnt vmcnt(18)
    s_barrier
    s_mov_b32 s36, 0x208000
    s_add_u32 s37, s42, 53248
    s_mov_b32 m0, s37
    s_nop 0
    buffer_load_dwordx4 v4, s[12:15], s36 offen lds
    s_add_u32 s37, s37, 1024
    s_mov_b32 m0, s37
    s_nop 0
    buffer_load_dwordx4 v5, s[12:15], s36 offen lds
    s_add_u32 s37, s37, 1024
    s_mov_b32 m0, s37
    s_nop 0
    buffer_load_dwordx4 v6, s[12:15], s36 offen lds
    s_add_u32 s37, s37, 1024
    s_mov_b32 m0, s37
    s_nop 0
    buffer_load_dwordx4 v7, s[12:15], s36 offen lds
    s_add_u32 s37, s37, 1024
    s_mov_b32 m0, s37
    s_nop 0
    buffer_load_dwordx4 v8, s[12:15], s36 offen lds
    s_mov_b32 s36, 0xd00
    s_lshl_b32 s37, s35, 2
    s_add_u32 s37, s37, 36864
    s_mov_b32 m0, s37
    s_nop 0
    buffer_load_dwordx4 v20, s[8:11], s36 offen lds
    s_add_u32 s37, s37, 1024
    s_mov_b32 m0, s37
    s_nop 0
    buffer_load_dwordx4 v21, s[8:11], s36 offen lds
    s_add_u32 s37, s37, 1024
    s_mov_b32 m0, s37
    s_nop 0
    buffer_load_dwordx4 v22, s[8:11], s36 offen lds
    s_add_u32 s37, s37, 1024
    s_mov_b32 m0, s37
    s_nop 0
    buffer_load_dwordx4 v23, s[8:11], s36 offen lds
    ds_read_b64 v[108:109], v120 offset:0
    ds_read_b64 v[110:111], v121 offset:0
    ds_read_b64_tr_b16 v[52:53], v10 offset:0
    ds_read_b64_tr_b16 v[54:55], v10 offset:2560
    ds_read_b64_tr_b16 v[56:57], v10 offset:32
    ds_read_b64_tr_b16 v[58:59], v10 offset:2592
    ds_read_b64_tr_b16 v[60:61], v10 offset:64
    ds_read_b64_tr_b16 v[62:63], v10 offset:2624
    ds_read_b64_tr_b16 v[64:65], v10 offset:96
    ds_read_b64_tr_b16 v[66:67], v10 offset:2656
    ds_read_b64_tr_b16 v[68:69], v10 offset:128
    ds_read_b64_tr_b16 v[70:71], v10 offset:2688
    v_mfma_f32_16x16x32_bf16 v[32:35], v[72:75], v[112:115], v[32:35]
    v_mfma_f32_16x16x32_bf16 v[36:39], v[76:79], v[112:115], v[36:39]
    v_mfma_f32_16x16x32_bf16 v[40:43], v[80:83], v[112:115], v[40:43]
    v_mfma_f32_16x16x32_bf16 v[44:47], v[84:87], v[112:115], v[44:47]
    v_mfma_f32_16x16x32_bf16 v[48:51], v[88:91], v[112:115], v[48:51]
    s_waitcnt lgkmcnt(0)
    ds_read_b64 v[112:113], v122 offset:0
    ds_read_b64 v[114:115], v123 offset:0
    ds_read_b64_tr_b16 v[72:73], v10 offset:5120
    ds_read_b64_tr_b16 v[74:75], v10 offset:7680
    ds_read_b64_tr_b16 v[76:77], v10 offset:5152
    ds_read_b64_tr_b16 v[78:79], v10 offset:7712
    ds_read_b64_tr_b16 v[80:81], v10 offset:5184
    ds_read_b64_tr_b16 v[82:83], v10 offset:7744
    ds_read_b64_tr_b16 v[84:85], v10 offset:5216
    ds_read_b64_tr_b16 v[86:87], v10 offset:7776
    ds_read_b64_tr_b16 v[88:89], v10 offset:5248
    ds_read_b64_tr_b16 v[90:91], v10 offset:7808
    v_mfma_f32_16x16x32_bf16 v[32:35], v[52:55], v[108:111], v[32:35]
    v_mfma_f32_16x16x32_bf16 v[36:39], v[56:59], v[108:111], v[36:39]
    v_mfma_f32_16x16x32_bf16 v[40:43], v[60:63], v[108:111], v[40:43]
    v_mfma_f32_16x16x32_bf16 v[44:47], v[64:67], v[108:111], v[44:47]
    v_mfma_f32_16x16x32_bf16 v[48:51], v[68:71], v[108:111], v[48:51]
    s_waitcnt lgkmcnt(0)
    ds_read_b64 v[108:109], v124 offset:0
    ds_read_b64 v[110:111], v125 offset:0
    ds_read_b64_tr_b16 v[52:53], v10 offset:10240
    ds_read_b64_tr_b16 v[54:55], v10 offset:12800
    ds_read_b64_tr_b16 v[56:57], v10 offset:10272
    ds_read_b64_tr_b16 v[58:59], v10 offset:12832
    ds_read_b64_tr_b16 v[60:61], v10 offset:10304
    ds_read_b64_tr_b16 v[62:63], v10 offset:12864
    ds_read_b64_tr_b16 v[64:65], v10 offset:10336
    ds_read_b64_tr_b16 v[66:67], v10 offset:12896
    ds_read_b64_tr_b16 v[68:69], v10 offset:10368
    ds_read_b64_tr_b16 v[70:71], v10 offset:12928
    v_mfma_f32_16x16x32_bf16 v[32:35], v[72:75], v[112:115], v[32:35]
    v_mfma_f32_16x16x32_bf16 v[36:39], v[76:79], v[112:115], v[36:39]
    v_mfma_f32_16x16x32_bf16 v[40:43], v[80:83], v[112:115], v[40:43]
    v_mfma_f32_16x16x32_bf16 v[44:47], v[84:87], v[112:115], v[44:47]
    v_mfma_f32_16x16x32_bf16 v[48:51], v[88:91], v[112:115], v[48:51]
    s_waitcnt lgkmcnt(0)
    ds_read_b64 v[112:113], v126 offset:0
    ds_read_b64 v[114:115], v127 offset:0
    ds_read_b64_tr_b16 v[72:73], v10 offset:15360
    ds_read_b64_tr_b16 v[74:75], v10 offset:17920
    ds_read_b64_tr_b16 v[76:77], v10 offset:15392
    ds_read_b64_tr_b16 v[78:79], v10 offset:17952
    ds_read_b64_tr_b16 v[80:81], v10 offset:15424
    ds_read_b64_tr_b16 v[82:83], v10 offset:17984
    ds_read_b64_tr_b16 v[84:85], v10 offset:15456
    ds_read_b64_tr_b16 v[86:87], v10 offset:18016
    ds_read_b64_tr_b16 v[88:89], v10 offset:15488
    ds_read_b64_tr_b16 v[90:91], v10 offset:18048
    v_mfma_f32_16x16x32_bf16 v[32:35], v[52:55], v[108:111], v[32:35]
    v_mfma_f32_16x16x32_bf16 v[36:39], v[56:59], v[108:111], v[36:39]
    v_mfma_f32_16x16x32_bf16 v[40:43], v[60:63], v[108:111], v[40:43]
    v_mfma_f32_16x16x32_bf16 v[44:47], v[64:67], v[108:111], v[44:47]
    v_mfma_f32_16x16x32_bf16 v[48:51], v[68:71], v[108:111], v[48:51]
    s_waitcnt lgkmcnt(0)
    s_waitcnt vmcnt(18)
    s_barrier
    ds_read_b64 v[108:109], v120 offset:36864
    ds_read_b64 v[110:111], v121 offset:36864
    ds_read_b64_tr_b16 v[52:53], v10 offset:36864
    ds_read_b64_tr_b16 v[54:55], v10 offset:39424
    ds_read_b64_tr_b16 v[56:57], v10 offset:36896
    ds_read_b64_tr_b16 v[58:59], v10 offset:39456
    ds_read_b64_tr_b16 v[60:61], v10 offset:36928
    ds_read_b64_tr_b16 v[62:63], v10 offset:39488
    ds_read_b64_tr_b16 v[64:65], v10 offset:36960
    ds_read_b64_tr_b16 v[66:67], v10 offset:39520
    ds_read_b64_tr_b16 v[68:69], v10 offset:36992
    ds_read_b64_tr_b16 v[70:71], v10 offset:39552
    v_mfma_f32_16x16x32_bf16 v[32:35], v[72:75], v[112:115], v[32:35]
    v_mfma_f32_16x16x32_bf16 v[36:39], v[76:79], v[112:115], v[36:39]
    v_mfma_f32_16x16x32_bf16 v[40:43], v[80:83], v[112:115], v[40:43]
    v_mfma_f32_16x16x32_bf16 v[44:47], v[84:87], v[112:115], v[44:47]
    v_mfma_f32_16x16x32_bf16 v[48:51], v[88:91], v[112:115], v[48:51]
    s_waitcnt lgkmcnt(0)
    ds_read_b64 v[112:113], v122 offset:36864
    ds_read_b64 v[114:115], v123 offset:36864
    ds_read_b64_tr_b16 v[72:73], v10 offset:41984
    ds_read_b64_tr_b16 v[74:75], v10 offset:44544
    ds_read_b64_tr_b16 v[76:77], v10 offset:42016
    ds_read_b64_tr_b16 v[78:79], v10 offset:44576
    ds_read_b64_tr_b16 v[80:81], v10 offset:42048
    ds_read_b64_tr_b16 v[82:83], v10 offset:44608
    ds_read_b64_tr_b16 v[84:85], v10 offset:42080
    ds_read_b64_tr_b16 v[86:87], v10 offset:44640
    ds_read_b64_tr_b16 v[88:89], v10 offset:42112
    ds_read_b64_tr_b16 v[90:91], v10 offset:44672
    v_mfma_f32_16x16x32_bf16 v[32:35], v[52:55], v[108:111], v[32:35]
    v_mfma_f32_16x16x32_bf16 v[36:39], v[56:59], v[108:111], v[36:39]
    v_mfma_f32_16x16x32_bf16 v[40:43], v[60:63], v[108:111], v[40:43]
    v_mfma_f32_16x16x32_bf16 v[44:47], v[64:67], v[108:111], v[44:47]
    v_mfma_f32_16x16x32_bf16 v[48:51], v[68:71], v[108:111], v[48:51]
    s_waitcnt lgkmcnt(0)
    ds_read_b64 v[108:109], v124 offset:36864
    ds_read_b64 v[110:111], v125 offset:36864
    ds_read_b64_tr_b16 v[52:53], v10 offset:47104
    ds_read_b64_tr_b16 v[54:55], v10 offset:49664
    ds_read_b64_tr_b16 v[56:57], v10 offset:47136
    ds_read_b64_tr_b16 v[58:59], v10 offset:49696
    ds_read_b64_tr_b16 v[60:61], v10 offset:47168
    ds_read_b64_tr_b16 v[62:63], v10 offset:49728
    ds_read_b64_tr_b16 v[64:65], v10 offset:47200
    ds_read_b64_tr_b16 v[66:67], v10 offset:49760
    ds_read_b64_tr_b16 v[68:69], v10 offset:47232
    ds_read_b64_tr_b16 v[70:71], v10 offset:49792
    v_mfma_f32_16x16x32_bf16 v[32:35], v[72:75], v[112:115], v[32:35]
    v_mfma_f32_16x16x32_bf16 v[36:39], v[76:79], v[112:115], v[36:39]
    v_mfma_f32_16x16x32_bf16 v[40:43], v[80:83], v[112:115], v[40:43]
    v_mfma_f32_16x16x32_bf16 v[44:47], v[84:87], v[112:115], v[44:47]
    v_mfma_f32_16x16x32_bf16 v[48:51], v[88:91], v[112:115], v[48:51]
    s_waitcnt lgkmcnt(0)
    ds_read_b64 v[112:113], v126 offset:36864
    ds_read_b64 v[114:115], v127 offset:36864
    ds_read_b64_tr_b16 v[72:73], v10 offset:52224
    ds_read_b64_tr_b16 v[74:75], v10 offset:54784
    ds_read_b64_tr_b16 v[76:77], v10 offset:52256
    ds_read_b64_tr_b16 v[78:79], v10 offset:54816
    ds_read_b64_tr_b16 v[80:81], v10 offset:52288
    ds_read_b64_tr_b16 v[82:83], v10 offset:54848
    ds_read_b64_tr_b16 v[84:85], v10 offset:52320
    ds_read_b64_tr_b16 v[86:87], v10 offset:54880
    ds_read_b64_tr_b16 v[88:89], v10 offset:52352
    ds_read_b64_tr_b16 v[90:91], v10 offset:54912
    v_mfma_f32_16x16x32_bf16 v[32:35], v[52:55], v[108:111], v[32:35]
    v_mfma_f32_16x16x32_bf16 v[36:39], v[56:59], v[108:111], v[36:39]
    v_mfma_f32_16x16x32_bf16 v[40:43], v[60:63], v[108:111], v[40:43]
    v_mfma_f32_16x16x32_bf16 v[44:47], v[64:67], v[108:111], v[44:47]
    v_mfma_f32_16x16x32_bf16 v[48:51], v[68:71], v[108:111], v[48:51]
    s_waitcnt lgkmcnt(0)
    s_waitcnt vmcnt(9)
    s_barrier
    ds_read_b64 v[108:109], v24 offset:0
    ds_read_b64 v[110:111], v25 offset:0
    ds_read_b64_tr_b16 v[52:53], v12 offset:0
    ds_read_b64_tr_b16 v[54:55], v12 offset:2560
    ds_read_b64_tr_b16 v[56:57], v12 offset:32
    ds_read_b64_tr_b16 v[58:59], v12 offset:2592
    ds_read_b64_tr_b16 v[60:61], v12 offset:64
    ds_read_b64_tr_b16 v[62:63], v12 offset:2624
    ds_read_b64_tr_b16 v[64:65], v12 offset:96
    ds_read_b64_tr_b16 v[66:67], v12 offset:2656
    ds_read_b64_tr_b16 v[68:69], v12 offset:128
    ds_read_b64_tr_b16 v[70:71], v12 offset:2688
    v_mfma_f32_16x16x32_bf16 v[32:35], v[72:75], v[112:115], v[32:35]
    v_mfma_f32_16x16x32_bf16 v[36:39], v[76:79], v[112:115], v[36:39]
    v_mfma_f32_16x16x32_bf16 v[40:43], v[80:83], v[112:115], v[40:43]
    v_mfma_f32_16x16x32_bf16 v[44:47], v[84:87], v[112:115], v[44:47]
    v_mfma_f32_16x16x32_bf16 v[48:51], v[88:91], v[112:115], v[48:51]
    s_waitcnt lgkmcnt(0)
    ds_read_b64 v[112:113], v26 offset:0
    ds_read_b64 v[114:115], v27 offset:0
    ds_read_b64_tr_b16 v[72:73], v12 offset:5120
    ds_read_b64_tr_b16 v[74:75], v12 offset:7680
    ds_read_b64_tr_b16 v[76:77], v12 offset:5152
    ds_read_b64_tr_b16 v[78:79], v12 offset:7712
    ds_read_b64_tr_b16 v[80:81], v12 offset:5184
    ds_read_b64_tr_b16 v[82:83], v12 offset:7744
    ds_read_b64_tr_b16 v[84:85], v12 offset:5216
    ds_read_b64_tr_b16 v[86:87], v12 offset:7776
    ds_read_b64_tr_b16 v[88:89], v12 offset:5248
    ds_read_b64_tr_b16 v[90:91], v12 offset:7808
    v_mfma_f32_16x16x32_bf16 v[32:35], v[52:55], v[108:111], v[32:35]
    v_mfma_f32_16x16x32_bf16 v[36:39], v[56:59], v[108:111], v[36:39]
    v_mfma_f32_16x16x32_bf16 v[40:43], v[60:63], v[108:111], v[40:43]
    v_mfma_f32_16x16x32_bf16 v[44:47], v[64:67], v[108:111], v[44:47]
    v_mfma_f32_16x16x32_bf16 v[48:51], v[68:71], v[108:111], v[48:51]
    s_waitcnt lgkmcnt(0)
    ds_read_b64 v[108:109], v28 offset:0
    ds_read_b64 v[110:111], v29 offset:0
    ds_read_b64_tr_b16 v[52:53], v12 offset:10240
    ds_read_b64_tr_b16 v[54:55], v12 offset:12800
    ds_read_b64_tr_b16 v[56:57], v12 offset:10272
    ds_read_b64_tr_b16 v[58:59], v12 offset:12832
    ds_read_b64_tr_b16 v[60:61], v12 offset:10304
    ds_read_b64_tr_b16 v[62:63], v12 offset:12864
    ds_read_b64_tr_b16 v[64:65], v12 offset:10336
    ds_read_b64_tr_b16 v[66:67], v12 offset:12896
    ds_read_b64_tr_b16 v[68:69], v12 offset:10368
    ds_read_b64_tr_b16 v[70:71], v12 offset:12928
    v_mfma_f32_16x16x32_bf16 v[32:35], v[72:75], v[112:115], v[32:35]
    v_mfma_f32_16x16x32_bf16 v[36:39], v[76:79], v[112:115], v[36:39]
    v_mfma_f32_16x16x32_bf16 v[40:43], v[80:83], v[112:115], v[40:43]
    v_mfma_f32_16x16x32_bf16 v[44:47], v[84:87], v[112:115], v[44:47]
    v_mfma_f32_16x16x32_bf16 v[48:51], v[88:91], v[112:115], v[48:51]
    s_waitcnt lgkmcnt(0)
    ds_read_b64 v[112:113], v30 offset:0
    ds_read_b64 v[114:115], v31 offset:0
    ds_read_b64_tr_b16 v[72:73], v12 offset:15360
    ds_read_b64_tr_b16 v[74:75], v12 offset:17920
    ds_read_b64_tr_b16 v[76:77], v12 offset:15392
    ds_read_b64_tr_b16 v[78:79], v12 offset:17952
    ds_read_b64_tr_b16 v[80:81], v12 offset:15424
    ds_read_b64_tr_b16 v[82:83], v12 offset:17984
    ds_read_b64_tr_b16 v[84:85], v12 offset:15456
    ds_read_b64_tr_b16 v[86:87], v12 offset:18016
    ds_read_b64_tr_b16 v[88:89], v12 offset:15488
    ds_read_b64_tr_b16 v[90:91], v12 offset:18048
    v_mfma_f32_16x16x32_bf16 v[32:35], v[52:55], v[108:111], v[32:35]
    v_mfma_f32_16x16x32_bf16 v[36:39], v[56:59], v[108:111], v[36:39]
    v_mfma_f32_16x16x32_bf16 v[40:43], v[60:63], v[108:111], v[40:43]
    v_mfma_f32_16x16x32_bf16 v[44:47], v[64:67], v[108:111], v[44:47]
    v_mfma_f32_16x16x32_bf16 v[48:51], v[68:71], v[108:111], v[48:51]
    s_waitcnt lgkmcnt(0)
    s_waitcnt vmcnt(0)
    s_barrier
    ds_read_b64 v[108:109], v24 offset:36864
    ds_read_b64 v[110:111], v25 offset:36864
    ds_read_b64_tr_b16 v[52:53], v12 offset:36864
    ds_read_b64_tr_b16 v[54:55], v12 offset:39424
    ds_read_b64_tr_b16 v[56:57], v12 offset:36896
    ds_read_b64_tr_b16 v[58:59], v12 offset:39456
    ds_read_b64_tr_b16 v[60:61], v12 offset:36928
    ds_read_b64_tr_b16 v[62:63], v12 offset:39488
    ds_read_b64_tr_b16 v[64:65], v12 offset:36960
    ds_read_b64_tr_b16 v[66:67], v12 offset:39520
    ds_read_b64_tr_b16 v[68:69], v12 offset:36992
    ds_read_b64_tr_b16 v[70:71], v12 offset:39552
    v_mfma_f32_16x16x32_bf16 v[32:35], v[72:75], v[112:115], v[32:35]
    v_mfma_f32_16x16x32_bf16 v[36:39], v[76:79], v[112:115], v[36:39]
    v_mfma_f32_16x16x32_bf16 v[40:43], v[80:83], v[112:115], v[40:43]
    v_mfma_f32_16x16x32_bf16 v[44:47], v[84:87], v[112:115], v[44:47]
    v_mfma_f32_16x16x32_bf16 v[48:51], v[88:91], v[112:115], v[48:51]
    s_waitcnt lgkmcnt(0)
    ds_read_b64 v[112:113], v26 offset:36864
    ds_read_b64 v[114:115], v27 offset:36864
    ds_read_b64_tr_b16 v[72:73], v12 offset:41984
    ds_read_b64_tr_b16 v[74:75], v12 offset:44544
    ds_read_b64_tr_b16 v[76:77], v12 offset:42016
    ds_read_b64_tr_b16 v[78:79], v12 offset:44576
    ds_read_b64_tr_b16 v[80:81], v12 offset:42048
    ds_read_b64_tr_b16 v[82:83], v12 offset:44608
    ds_read_b64_tr_b16 v[84:85], v12 offset:42080
    ds_read_b64_tr_b16 v[86:87], v12 offset:44640
    ds_read_b64_tr_b16 v[88:89], v12 offset:42112
    ds_read_b64_tr_b16 v[90:91], v12 offset:44672
    v_mfma_f32_16x16x32_bf16 v[32:35], v[52:55], v[108:111], v[32:35]
    v_mfma_f32_16x16x32_bf16 v[36:39], v[56:59], v[108:111], v[36:39]
    v_mfma_f32_16x16x32_bf16 v[40:43], v[60:63], v[108:111], v[40:43]
    v_mfma_f32_16x16x32_bf16 v[44:47], v[64:67], v[108:111], v[44:47]
    v_mfma_f32_16x16x32_bf16 v[48:51], v[68:71], v[108:111], v[48:51]
    s_waitcnt lgkmcnt(0)
    v_mfma_f32_16x16x32_bf16 v[32:35], v[72:75], v[112:115], v[32:35]
    v_mfma_f32_16x16x32_bf16 v[36:39], v[76:79], v[112:115], v[36:39]
    v_mfma_f32_16x16x32_bf16 v[40:43], v[80:83], v[112:115], v[40:43]
    v_mfma_f32_16x16x32_bf16 v[44:47], v[84:87], v[112:115], v[44:47]
    v_mfma_f32_16x16x32_bf16 v[48:51], v[88:91], v[112:115], v[48:51]
    s_nop 7
    s_nop 7
    v_cvt_pk_bf16_f32 v92, v32, v33
    v_cvt_pk_bf16_f32 v93, v34, v35
    v_lshlrev_b32 v116, 16, v92
    v_and_b32 v117, 0xffff0000, v92
    v_lshlrev_b32 v118, 16, v96
    v_and_b32 v119, 0xffff0000, v96
    v_pk_add_f32 v[116:117], v[116:117], v[118:119]
    v_cvt_pk_bf16_f32 v94, v116, v117
    v_lshlrev_b32 v116, 16, v93
    v_and_b32 v117, 0xffff0000, v93
    v_lshlrev_b32 v118, 16, v97
    v_and_b32 v119, 0xffff0000, v97
    v_pk_add_f32 v[116:117], v[116:117], v[118:119]
    v_cvt_pk_bf16_f32 v95, v116, v117
    buffer_store_dwordx2 v[94:95], v11, s[20:23], 0 offen offset:0
    s_nop 1
    v_cvt_pk_bf16_f32 v92, v36, v37
    v_cvt_pk_bf16_f32 v93, v38, v39
    v_lshlrev_b32 v116, 16, v92
    v_and_b32 v117, 0xffff0000, v92
    v_lshlrev_b32 v118, 16, v98
    v_and_b32 v119, 0xffff0000, v98
    v_pk_add_f32 v[116:117], v[116:117], v[118:119]
    v_cvt_pk_bf16_f32 v94, v116, v117
    v_lshlrev_b32 v116, 16, v93
    v_and_b32 v117, 0xffff0000, v93
    v_lshlrev_b32 v118, 16, v99
    v_and_b32 v119, 0xffff0000, v99
    v_pk_add_f32 v[116:117], v[116:117], v[118:119]
    v_cvt_pk_bf16_f32 v95, v116, v117
    buffer_store_dwordx2 v[94:95], v11, s[20:23], 0 offen offset:32
    s_nop 1
    v_cvt_pk_bf16_f32 v92, v40, v41
    v_cvt_pk_bf16_f32 v93, v42, v43
    v_lshlrev_b32 v116, 16, v92
    v_and_b32 v117, 0xffff0000, v92
    v_lshlrev_b32 v118, 16, v100
    v_and_b32 v119, 0xffff0000, v100
    v_pk_add_f32 v[116:117], v[116:117], v[118:119]
    v_cvt_pk_bf16_f32 v94, v116, v117
    v_lshlrev_b32 v116, 16, v93
    v_and_b32 v117, 0xffff0000, v93
    v_lshlrev_b32 v118, 16, v101
    v_and_b32 v119, 0xffff0000, v101
    v_pk_add_f32 v[116:117], v[116:117], v[118:119]
    v_cvt_pk_bf16_f32 v95, v116, v117
    buffer_store_dwordx2 v[94:95], v11, s[20:23], 0 offen offset:64
    s_nop 1
    v_cvt_pk_bf16_f32 v92, v44, v45
    v_cvt_pk_bf16_f32 v93, v46, v47
    v_lshlrev_b32 v116, 16, v92
    v_and_b32 v117, 0xffff0000, v92
    v_lshlrev_b32 v118, 16, v102
    v_and_b32 v119, 0xffff0000, v102
    v_pk_add_f32 v[116:117], v[116:117], v[118:119]
    v_cvt_pk_bf16_f32 v94, v116, v117
    v_lshlrev_b32 v116, 16, v93
    v_and_b32 v117, 0xffff0000, v93
    v_lshlrev_b32 v118, 16, v103
    v_and_b32 v119, 0xffff0000, v103
    v_pk_add_f32 v[116:117], v[116:117], v[118:119]
    v_cvt_pk_bf16_f32 v95, v116, v117
    buffer_store_dwordx2 v[94:95], v11, s[20:23], 0 offen offset:96
    s_nop 1
    v_cvt_pk_bf16_f32 v92, v48, v49
    v_cvt_pk_bf16_f32 v93, v50, v51
    v_lshlrev_b32 v116, 16, v92
    v_and_b32 v117, 0xffff0000, v92
    v_lshlrev_b32 v118, 16, v104
    v_and_b32 v119, 0xffff0000, v104
    v_pk_add_f32 v[116:117], v[116:117], v[118:119]
    v_cvt_pk_bf16_f32 v94, v116, v117
    v_lshlrev_b32 v116, 16, v93
    v_and_b32 v117, 0xffff0000, v93
    v_lshlrev_b32 v118, 16, v105
    v_and_b32 v119, 0xffff0000, v105
    v_pk_add_f32 v[116:117], v[116:117], v[118:119]
    v_cvt_pk_bf16_f32 v95, v116, v117
    buffer_store_dwordx2 v[94:95], v11, s[20:23], 0 offen offset:128
    s_nop 1
L_hh_k4_kernel_end:
    s_endpgm

.section .rodata,"a"
.p2align 6
.amdhsa_kernel hh_k1_kernel
  .amdhsa_next_free_vgpr 256
  .amdhsa_next_free_sgpr 102
  .amdhsa_accum_offset 256
  .amdhsa_group_segment_fixed_size 0
  .amdhsa_kernarg_size 80
  .amdhsa_user_sgpr_count 2
  .amdhsa_user_sgpr_kernarg_segment_ptr 1
  .amdhsa_system_sgpr_workgroup_id_x 1
.end_amdhsa_kernel

.p2align 6
.amdhsa_kernel hh_kr_kernel
  .amdhsa_next_free_vgpr 192
  .amdhsa_next_free_sgpr 102
  .amdhsa_accum_offset 192
  .amdhsa_group_segment_fixed_size 0
  .amdhsa_kernarg_size 80
  .amdhsa_user_sgpr_count 2
  .amdhsa_user_sgpr_kernarg_segment_ptr 1
  .amdhsa_system_sgpr_workgroup_id_x 1
.end_amdhsa_kernel

.p2align 6
.amdhsa_kernel hh_k2_kernel
  .amdhsa_next_free_vgpr 128
  .amdhsa_next_free_sgpr 102
  .amdhsa_accum_offset 128
  .amdhsa_group_segment_fixed_size 0
  .amdhsa_kernarg_size 80
  .amdhsa_user_sgpr_count 2
  .amdhsa_user_sgpr_kernarg_segment_ptr 1
  .amdhsa_system_sgpr_workgroup_id_x 1
.end_amdhsa_kernel

.p2align 6
.amdhsa_kernel hh_k3_kernel
  .amdhsa_next_free_vgpr 256
  .amdhsa_next_free_sgpr 102
  .amdhsa_accum_offset 256
  .amdhsa_group_segment_fixed_size 0
  .amdhsa_kernarg_size 80
  .amdhsa_user_sgpr_count 2
  .amdhsa_user_sgpr_kernarg_segment_ptr 1
  .amdhsa_system_sgpr_workgroup_id_x 1
.end_amdhsa_kernel

.p2align 6
.amdhsa_kernel hh_k4_kernel
  .amdhsa_next_free_vgpr 128
  .amdhsa_next_free_sgpr 102
  .amdhsa_accum_offset 128
  .amdhsa_group_segment_fixed_size 0
  .amdhsa_kernarg_size 80
  .amdhsa_user_sgpr_count 2
  .amdhsa_user_sgpr_kernarg_segment_ptr 1
  .amdhsa_system_sgpr_workgroup_id_x 1
.end_amdhsa_kernel
```
